```python
import torch

def _softmax(x, axis=-1):
    return torch.softmax(x, dim=axis)

def _gelu(x):
    return torch.nn.functional.gelu(x, approximate='tanh')

def _silu(x):
    return torch.nn.functional.silu(x)

def _sigmoid(x):
    return torch.sigmoid(x)

def _layernorm(x, axis=-1, eps=1e-05):
    m = x.mean(dim=axis, keepdim=True)
    v = x.var(dim=axis, keepdim=True, unbiased=False)
    return (x - m) / torch.sqrt(v + eps)

def _scatter_add(tgt, idx, src, axis=0):
    return tgt.clone().index_add_(axis, idx, src)

def _segment_sum(src, seg, n):
    out = torch.zeros((n,) + src.shape[1:], dtype=src.dtype)
    return out.index_add_(0, seg, src)

def _pad(x, pw):
    flat = tuple((v for pair in reversed(pw) for v in pair))
    return torch.nn.functional.pad(x, flat)
kernel_name = 'parallel_sum__memory_aug_recurrent_mem_tr__dense_activation_gelu__prompt'

def setup_inputs():

    _w = lambda a: (lambda t: t.to(torch.bfloat16) if t.is_floating_point() else t)(torch.as_tensor(a))

    def _A_setup():
        B, S, Dm = (1, 2048, 448)
        H, Dh = (16, 256)
        M, seg = (8, 32)
        seg = min(seg, S)
        S = S // seg * seg
        return {'x': _w((lambda *s: torch.randn(*s, dtype=torch.bfloat16) * 0.05)(B, S, Dm)), 'mem0': _w((lambda *s: torch.randn(*s, dtype=torch.bfloat16) * 0.2)(B, M, Dm)), 'Wq': _w((lambda *s: torch.randn(*s, dtype=torch.bfloat16) * 1.6)(Dm, H, Dh) * Dm ** (-0.5)), 'Wk': _w((lambda *s: torch.randn(*s, dtype=torch.bfloat16) * 1.6)(Dm, H, Dh) * Dm ** (-0.5)), 'Wv': _w((lambda *s: torch.randn(*s, dtype=torch.bfloat16) * 0.2)(Dm, H, Dh) * Dm ** (-0.5)), 'Wo': _w((lambda *s: torch.randn(*s, dtype=torch.bfloat16) * 0.2)(H, Dh, Dm) * (H * Dh) ** (-0.5)), 'seg_len': seg}
    _A_in = _A_setup()

    def _B_setup():
        B, S, D, F = (1, 2048, 448, 1792)
        return {'x': _w((lambda *s: torch.randn(*s, dtype=torch.bfloat16) * 0.05)(B, S, D)), 'w1': _w((lambda *s: torch.randn(*s, dtype=torch.bfloat16) * 0.4)(D, F) * D ** (-0.5)), 'b1': _w((lambda *s: torch.randn(*s, dtype=torch.bfloat16) * 12.8)(F) * 0.01), 'w2': _w((lambda *s: torch.randn(*s, dtype=torch.bfloat16) * 0.1)(F, D) * F ** (-0.5)), 'b2': _w((lambda *s: torch.randn(*s, dtype=torch.bfloat16) * 1.6)(D) * 0.01)}
    _B_in = _B_setup()
    return {'A_x': _A_in['x'], 'A_mem0': _A_in['mem0'], 'A_Wq': _A_in['Wq'], 'A_Wk': _A_in['Wk'], 'A_Wv': _A_in['Wv'], 'A_Wo': _A_in['Wo'], 'A_seg_len': _A_in['seg_len'], 'B_x': _B_in['x'], 'B_w1': _B_in['w1'], 'B_b1': _B_in['b1'], 'B_w2': _B_in['w2'], 'B_b2': _B_in['b2']}

def reference(A_x, A_mem0, A_Wq, A_Wk, A_Wv, A_Wo, A_seg_len, B_x, B_w1, B_b1, B_w2, B_b2):

    def _A_ref(x, mem0, Wq, Wk, Wv, Wo, seg_len):
        B, S, Dm = x.shape
        H, Dh = (Wq.shape[1], Wq.shape[2])
        M = mem0.shape[1]
        scale = Dh ** (-0.5)
        n_seg = S // seg_len
        L = M + seg_len
        idx = torch.arange(L)
        mask = (idx[:, None] < M) | (idx[:, None] >= idx[None, :])
        mem = mem0
        outs = []
        for s in range(n_seg):
            xs = x[:, s * seg_len:(s + 1) * seg_len, :].clone()
            h = torch.concatenate([mem, xs], axis=1)
            q = torch.einsum('btd,dhe->bhte', h, Wq)
            k = torch.einsum('btd,dhe->bhte', h, Wk)
            v = torch.einsum('btd,dhe->bhte', h, Wv)
            scores = torch.einsum('bhqe,bhke->bhqk', q, k) * scale
            scores = torch.where(mask[None, None], scores, -1000000000.0)
            p = _softmax(scores, axis=-1)
            o = torch.einsum('bhqk,bhke->bhqe', p, v)
            o = torch.einsum('bhte,hed->btd', o, Wo)
            mem = o[:, :M, :].clone()
            outs.append(o[:, M:, :])
        return torch.concatenate(outs, axis=1)

    def _B_ref(x, w1, b1, w2, b2):
        h = torch.einsum('bsd,df->bsf', x, w1) + b1
        h = _gelu(h)
        return torch.einsum('bsf,fd->bsd', h, w2) + b2
    x = A_x
    xn = _layernorm(x, axis=-1)
    return x + _A_ref(xn, A_mem0, A_Wq, A_Wk, A_Wv, A_Wo, A_seg_len) + _B_ref(xn, B_w1, B_b1, B_w2, B_b2)
```

```asm
; @launch kernel=prep_kernel grid=(1608,1,1) block=(256,1,1) lds=9216
; @launch kernel=g1_kernel grid=(1792,1,1) block=(256,1,1) lds=73728
; @launch kernel=chain_kernel grid=(2060,1,1) block=(256,1,1) lds=102400
; @launch kernel=parallel_sum__memory_aug_recurrent_mem_tr__dense_activation_gelu__prompt_kernel grid=(256,1,1) block=(256,1,1) lds=59392
.amdgcn_target "amdgcn-amd-amdhsa--gfx950"
.text
.globl prep_kernel
.p2align 8
.type prep_kernel,@function
prep_kernel:
    s_cmp_ge_u32 s2, 1608
    s_cbranch_scc1 prep_kernel_done
    s_cmp_ge_u32 s2, 512
    s_cbranch_scc1 prep_kernel_tr
    s_load_dwordx2 s[8:9], s[0:1], 0
    s_waitcnt lgkmcnt(0)
    s_and_b32 s9, s9, 0xffff
    s_mov_b32 s10, 0x1c0000
    s_mov_b32 s11, 0x00020000
    s_load_dwordx2 s[12:13], s[0:1], 112
    s_waitcnt lgkmcnt(0)
    s_and_b32 s13, s13, 0xffff
    s_mov_b32 s14, 0x1c0000
    s_mov_b32 s15, 0x00020000
    v_lshrrev_b32 v1, 6, v0
    s_lshl_b32 s3, s2, 2
    v_add_u32 v1, s3, v1
    v_and_b32 v2, 63, v0
    v_mul_u32_u24 v3, 896, v1
    v_lshl_add_u32 v3, v2, 4, v3
    v_cmp_gt_u32 vcc, 56, v2
    s_mov_b64 s[20:21], exec
    v_mov_b32 v4, 0
    v_mov_b32 v5, 0
    v_mov_b32 v6, 0
    v_mov_b32 v7, 0
    s_and_b64 exec, exec, vcc
    buffer_load_dwordx4 v[4:7], v3, s[8:11], 0 offen
    s_waitcnt vmcnt(0)
    s_mov_b64 exec, s[20:21]
    v_lshlrev_b32 v8, 16, v4
    v_and_b32 v9, 0xffff0000, v4
    v_lshlrev_b32 v10, 16, v5
    v_and_b32 v11, 0xffff0000, v5
    v_lshlrev_b32 v12, 16, v6
    v_and_b32 v13, 0xffff0000, v6
    v_lshlrev_b32 v14, 16, v7
    v_and_b32 v15, 0xffff0000, v7
    v_add_f32 v20, v8, v9
    v_add_f32 v20, v20, v10
    v_add_f32 v20, v20, v11
    v_add_f32 v20, v20, v12
    v_add_f32 v20, v20, v13
    v_add_f32 v20, v20, v14
    v_add_f32 v20, v20, v15
    v_xor_b32 v21, 1, v2
    v_lshlrev_b32 v21, 2, v21
    ds_bpermute_b32 v22, v21, v20
    s_waitcnt lgkmcnt(0)
    v_add_f32 v20, v20, v22
    v_xor_b32 v21, 2, v2
    v_lshlrev_b32 v21, 2, v21
    ds_bpermute_b32 v22, v21, v20
    s_waitcnt lgkmcnt(0)
    v_add_f32 v20, v20, v22
    v_xor_b32 v21, 4, v2
    v_lshlrev_b32 v21, 2, v21
    ds_bpermute_b32 v22, v21, v20
    s_waitcnt lgkmcnt(0)
    v_add_f32 v20, v20, v22
    v_xor_b32 v21, 8, v2
    v_lshlrev_b32 v21, 2, v21
    ds_bpermute_b32 v22, v21, v20
    s_waitcnt lgkmcnt(0)
    v_add_f32 v20, v20, v22
    v_xor_b32 v21, 16, v2
    v_lshlrev_b32 v21, 2, v21
    ds_bpermute_b32 v22, v21, v20
    s_waitcnt lgkmcnt(0)
    v_add_f32 v20, v20, v22
    v_xor_b32 v21, 32, v2
    v_lshlrev_b32 v21, 2, v21
    ds_bpermute_b32 v22, v21, v20
    s_waitcnt lgkmcnt(0)
    v_add_f32 v20, v20, v22
    v_mul_f32 v23, 0x3b124925, v20
    v_sub_f32 v24, v8, v23
    v_mul_f32 v24, v24, v24
    v_cndmask_b32 v24, 0, v24, vcc
    v_sub_f32 v25, v9, v23
    v_mul_f32 v25, v25, v25
    v_cndmask_b32 v25, 0, v25, vcc
    v_sub_f32 v26, v10, v23
    v_mul_f32 v26, v26, v26
    v_cndmask_b32 v26, 0, v26, vcc
    v_sub_f32 v27, v11, v23
    v_mul_f32 v27, v27, v27
    v_cndmask_b32 v27, 0, v27, vcc
    v_sub_f32 v28, v12, v23
    v_mul_f32 v28, v28, v28
    v_cndmask_b32 v28, 0, v28, vcc
    v_sub_f32 v29, v13, v23
    v_mul_f32 v29, v29, v29
    v_cndmask_b32 v29, 0, v29, vcc
    v_sub_f32 v30, v14, v23
    v_mul_f32 v30, v30, v30
    v_cndmask_b32 v30, 0, v30, vcc
    v_sub_f32 v31, v15, v23
    v_mul_f32 v31, v31, v31
    v_cndmask_b32 v31, 0, v31, vcc
    v_add_f32 v20, v24, v25
    v_add_f32 v20, v20, v26
    v_add_f32 v20, v20, v27
    v_add_f32 v20, v20, v28
    v_add_f32 v20, v20, v29
    v_add_f32 v20, v20, v30
    v_add_f32 v20, v20, v31
    v_xor_b32 v21, 1, v2
    v_lshlrev_b32 v21, 2, v21
    ds_bpermute_b32 v22, v21, v20
    s_waitcnt lgkmcnt(0)
    v_add_f32 v20, v20, v22
    v_xor_b32 v21, 2, v2
    v_lshlrev_b32 v21, 2, v21
    ds_bpermute_b32 v22, v21, v20
    s_waitcnt lgkmcnt(0)
    v_add_f32 v20, v20, v22
    v_xor_b32 v21, 4, v2
    v_lshlrev_b32 v21, 2, v21
    ds_bpermute_b32 v22, v21, v20
    s_waitcnt lgkmcnt(0)
    v_add_f32 v20, v20, v22
    v_xor_b32 v21, 8, v2
    v_lshlrev_b32 v21, 2, v21
    ds_bpermute_b32 v22, v21, v20
    s_waitcnt lgkmcnt(0)
    v_add_f32 v20, v20, v22
    v_xor_b32 v21, 16, v2
    v_lshlrev_b32 v21, 2, v21
    ds_bpermute_b32 v22, v21, v20
    s_waitcnt lgkmcnt(0)
    v_add_f32 v20, v20, v22
    v_xor_b32 v21, 32, v2
    v_lshlrev_b32 v21, 2, v21
    ds_bpermute_b32 v22, v21, v20
    s_waitcnt lgkmcnt(0)
    v_add_f32 v20, v20, v22
    v_mul_f32 v20, 0x3b124925, v20
    v_cvt_pk_bf16_f32 v20, v20, v23
    v_and_b32 v23, 0xffff0000, v20
    v_lshlrev_b32 v20, 16, v20
    v_add_f32 v20, 0x3727c5ac, v20
    v_cvt_pk_bf16_f32 v20, v20, v20
    v_lshlrev_b32 v20, 16, v20
    v_sqrt_f32 v20, v20
    s_nop 0
    v_cvt_pk_bf16_f32 v20, v20, v20
    v_lshlrev_b32 v20, 16, v20
    v_rcp_f32 v20, v20
    s_nop 0
    v_sub_f32 v8, v8, v23
    v_sub_f32 v9, v9, v23
    v_sub_f32 v10, v10, v23
    v_sub_f32 v11, v11, v23
    v_sub_f32 v12, v12, v23
    v_sub_f32 v13, v13, v23
    v_sub_f32 v14, v14, v23
    v_sub_f32 v15, v15, v23
    v_cvt_pk_bf16_f32 v4, v8, v9
    v_lshlrev_b32 v8, 16, v4
    v_and_b32 v9, 0xffff0000, v4
    v_mul_f32 v8, v8, v20
    v_mul_f32 v9, v9, v20
    v_cvt_pk_bf16_f32 v4, v10, v11
    v_lshlrev_b32 v10, 16, v4
    v_and_b32 v11, 0xffff0000, v4
    v_mul_f32 v10, v10, v20
    v_mul_f32 v11, v11, v20
    v_cvt_pk_bf16_f32 v4, v12, v13
    v_lshlrev_b32 v12, 16, v4
    v_and_b32 v13, 0xffff0000, v4
    v_mul_f32 v12, v12, v20
    v_mul_f32 v13, v13, v20
    v_cvt_pk_bf16_f32 v4, v14, v15
    v_lshlrev_b32 v14, 16, v4
    v_and_b32 v15, 0xffff0000, v4
    v_mul_f32 v14, v14, v20
    v_mul_f32 v15, v15, v20
    v_cvt_pk_bf16_f32 v4, v8, v9
    v_cvt_pk_bf16_f32 v5, v10, v11
    v_cvt_pk_bf16_f32 v6, v12, v13
    v_cvt_pk_bf16_f32 v7, v14, v15
    s_and_b64 exec, exec, vcc
    buffer_store_dwordx4 v[4:7], v3, s[12:15], 0 offen
    s_branch prep_kernel_done
prep_kernel_tr:
    s_sub_u32 s3, s2, 512
    s_cmp_ge_u32 s3, 448
    s_cbranch_scc1 prep_kernel_tr1
    s_sub_u32 s4, s3, 0
    s_mul_hi_u32 s20, s4, 0x924924a
    s_mul_i32 s24, s20, 28
    s_sub_u32 s23, s4, s24
    s_mul_hi_u32 s21, s23, 0x24924925
    s_mul_i32 s24, s21, 7
    s_sub_u32 s22, s23, s24
    s_load_dwordx2 s[8:9], s[0:1], 40
    s_waitcnt lgkmcnt(0)
    s_and_b32 s9, s9, 0xffff
    s_mov_b32 s10, 0x380000
    s_mov_b32 s11, 0x00020000
    s_load_dwordx2 s[12:13], s[0:1], 112
    s_waitcnt lgkmcnt(0)
    s_add_u32 s12, s12, 0x1000000
    s_addc_u32 s13, s13, 0
    s_and_b32 s13, s13, 0xffff
    s_mov_b32 s14, 0x380000
    s_mov_b32 s15, 0x00020000
    s_mul_i32 s24, s20, 229376
    s_mul_i32 s25, s21, 57344
    s_add_u32 s24, s24, s25
    s_lshl_b32 s25, s22, 7
    s_add_u32 s24, s24, s25
    v_lshrrev_b32 v1, 3, v0
    v_and_b32 v2, 7, v0
    v_lshlrev_b32 v2, 4, v2
    s_mov_b32 s26, 896
    v_mul_lo_u32 v3, v1, s26
    v_add_u32 v3, v3, v2
    v_add_u32 v3, s24, v3
    v_add_u32 v4, 28672, v3
    buffer_load_dwordx4 v[8:11], v3, s[8:11], 0 offen
    buffer_load_dwordx4 v[12:15], v4, s[8:11], 0 offen
    v_mul_u32_u24 v5, 144, v1
    v_add_u32 v5, v5, v2
    s_waitcnt vmcnt(0)
    ds_write_b128 v5, v[8:11]
    ds_write_b128 v5, v[12:15] offset:4608
    s_waitcnt lgkmcnt(0)
    s_barrier
    v_lshrrev_b32 v1, 2, v0
    v_and_b32 v2, 3, v0
    v_mul_u32_u24 v5, 2304, v2
    v_lshl_add_u32 v5, v1, 1, v5
    ds_read_u16 v16, v5 offset:0
    ds_read_u16 v17, v5 offset:144
    ds_read_u16 v18, v5 offset:288
    ds_read_u16 v19, v5 offset:432
    ds_read_u16 v20, v5 offset:576
    ds_read_u16 v21, v5 offset:720
    ds_read_u16 v22, v5 offset:864
    ds_read_u16 v23, v5 offset:1008
    ds_read_u16 v24, v5 offset:1152
    ds_read_u16 v25, v5 offset:1296
    ds_read_u16 v26, v5 offset:1440
    ds_read_u16 v27, v5 offset:1584
    ds_read_u16 v28, v5 offset:1728
    ds_read_u16 v29, v5 offset:1872
    ds_read_u16 v30, v5 offset:2016
    ds_read_u16 v31, v5 offset:2160
    s_mul_i32 s24, s20, 229376
    s_mul_i32 s25, s22, 32768
    s_add_u32 s24, s24, s25
    s_lshl_b32 s25, s21, 7
    s_add_u32 s24, s24, s25
    s_mov_b32 s26, 512
    v_mul_lo_u32 v3, v1, s26
    v_lshl_add_u32 v3, v2, 5, v3
    v_add_u32 v3, s24, v3
    s_waitcnt lgkmcnt(0)
    v_lshl_or_b32 v8, v17, 16, v16
    v_lshl_or_b32 v9, v19, 16, v18
    v_lshl_or_b32 v10, v21, 16, v20
    v_lshl_or_b32 v11, v23, 16, v22
    v_lshl_or_b32 v12, v25, 16, v24
    v_lshl_or_b32 v13, v27, 16, v26
    v_lshl_or_b32 v14, v29, 16, v28
    v_lshl_or_b32 v15, v31, 16, v30
    buffer_store_dwordx4 v[8:11], v3, s[12:15], 0 offen
    buffer_store_dwordx4 v[12:15], v3, s[12:15], 0 offen offset:16
    s_branch prep_kernel_done
prep_kernel_tr1:
    s_cmp_ge_u32 s3, 644
    s_cbranch_scc1 prep_kernel_tr2
    s_sub_u32 s4, s3, 448
    s_mul_hi_u32 s20, s4, 0x14e5e0b
    s_mul_i32 s24, s20, 196
    s_sub_u32 s23, s4, s24
    s_mul_hi_u32 s21, s23, 0x924924a
    s_mul_i32 s24, s21, 28
    s_sub_u32 s22, s23, s24
    s_load_dwordx2 s[8:9], s[0:1], 64
    s_waitcnt lgkmcnt(0)
    s_and_b32 s9, s9, 0xffff
    s_mov_b32 s10, 0x188000
    s_mov_b32 s11, 0x00020000
    s_load_dwordx2 s[12:13], s[0:1], 112
    s_waitcnt lgkmcnt(0)
    s_add_u32 s12, s12, 0x1400000
    s_addc_u32 s13, s13, 0
    s_and_b32 s13, s13, 0xffff
    s_mov_b32 s14, 0x188000
    s_mov_b32 s15, 0x00020000
    s_mul_i32 s24, s20, 1605632
    s_mul_i32 s25, s21, 229376
    s_add_u32 s24, s24, s25
    s_lshl_b32 s25, s22, 7
    s_add_u32 s24, s24, s25
    v_lshrrev_b32 v1, 3, v0
    v_and_b32 v2, 7, v0
    v_lshlrev_b32 v2, 4, v2
    s_mov_b32 s26, 3584
    v_mul_lo_u32 v3, v1, s26
    v_add_u32 v3, v3, v2
    v_add_u32 v3, s24, v3
    v_add_u32 v4, 114688, v3
    buffer_load_dwordx4 v[8:11], v3, s[8:11], 0 offen
    buffer_load_dwordx4 v[12:15], v4, s[8:11], 0 offen
    v_mul_u32_u24 v5, 144, v1
    v_add_u32 v5, v5, v2
    s_waitcnt vmcnt(0)
    ds_write_b128 v5, v[8:11]
    ds_write_b128 v5, v[12:15] offset:4608
    s_waitcnt lgkmcnt(0)
    s_barrier
    v_lshrrev_b32 v1, 2, v0
    v_and_b32 v2, 3, v0
    v_mul_u32_u24 v5, 2304, v2
    v_lshl_add_u32 v5, v1, 1, v5
    ds_read_u16 v16, v5 offset:0
    ds_read_u16 v17, v5 offset:144
    ds_read_u16 v18, v5 offset:288
    ds_read_u16 v19, v5 offset:432
    ds_read_u16 v20, v5 offset:576
    ds_read_u16 v21, v5 offset:720
    ds_read_u16 v22, v5 offset:864
    ds_read_u16 v23, v5 offset:1008
    ds_read_u16 v24, v5 offset:1152
    ds_read_u16 v25, v5 offset:1296
    ds_read_u16 v26, v5 offset:1440
    ds_read_u16 v27, v5 offset:1584
    ds_read_u16 v28, v5 offset:1728
    ds_read_u16 v29, v5 offset:1872
    ds_read_u16 v30, v5 offset:2016
    ds_read_u16 v31, v5 offset:2160
    s_mul_i32 s24, s20, 1605632
    s_mul_i32 s25, s22, 57344
    s_add_u32 s24, s24, s25
    s_lshl_b32 s25, s21, 7
    s_add_u32 s24, s24, s25
    s_mov_b32 s26, 896
    v_mul_lo_u32 v3, v1, s26
    v_lshl_add_u32 v3, v2, 5, v3
    v_add_u32 v3, s24, v3
    s_waitcnt lgkmcnt(0)
    v_lshl_or_b32 v8, v17, 16, v16
    v_lshl_or_b32 v9, v19, 16, v18
    v_lshl_or_b32 v10, v21, 16, v20
    v_lshl_or_b32 v11, v23, 16, v22
    v_lshl_or_b32 v12, v25, 16, v24
    v_lshl_or_b32 v13, v27, 16, v26
    v_lshl_or_b32 v14, v29, 16, v28
    v_lshl_or_b32 v15, v31, 16, v30
    buffer_store_dwordx4 v[8:11], v3, s[12:15], 0 offen
    buffer_store_dwordx4 v[12:15], v3, s[12:15], 0 offen offset:16
    s_branch prep_kernel_done
prep_kernel_tr2:
    s_cmp_ge_u32 s3, 840
    s_cbranch_scc1 prep_kernel_tr3
    s_sub_u32 s4, s3, 644
    s_mul_hi_u32 s20, s4, 0x14e5e0b
    s_mul_i32 s24, s20, 196
    s_sub_u32 s23, s4, s24
    s_mul_hi_u32 s21, s23, 0x24924925
    s_mul_i32 s24, s21, 7
    s_sub_u32 s22, s23, s24
    s_load_dwordx2 s[8:9], s[0:1], 80
    s_waitcnt lgkmcnt(0)
    s_and_b32 s9, s9, 0xffff
    s_mov_b32 s10, 0x188000
    s_mov_b32 s11, 0x00020000
    s_load_dwordx2 s[12:13], s[0:1], 112
    s_waitcnt lgkmcnt(0)
    s_add_u32 s12, s12, 0x1600000
    s_addc_u32 s13, s13, 0
    s_and_b32 s13, s13, 0xffff
    s_mov_b32 s14, 0x188000
    s_mov_b32 s15, 0x00020000
    s_mul_i32 s24, s20, 1605632
    s_mul_i32 s25, s21, 57344
    s_add_u32 s24, s24, s25
    s_lshl_b32 s25, s22, 7
    s_add_u32 s24, s24, s25
    v_lshrrev_b32 v1, 3, v0
    v_and_b32 v2, 7, v0
    v_lshlrev_b32 v2, 4, v2
    s_mov_b32 s26, 896
    v_mul_lo_u32 v3, v1, s26
    v_add_u32 v3, v3, v2
    v_add_u32 v3, s24, v3
    v_add_u32 v4, 28672, v3
    buffer_load_dwordx4 v[8:11], v3, s[8:11], 0 offen
    buffer_load_dwordx4 v[12:15], v4, s[8:11], 0 offen
    v_mul_u32_u24 v5, 144, v1
    v_add_u32 v5, v5, v2
    s_waitcnt vmcnt(0)
    ds_write_b128 v5, v[8:11]
    ds_write_b128 v5, v[12:15] offset:4608
    s_waitcnt lgkmcnt(0)
    s_barrier
    v_lshrrev_b32 v1, 2, v0
    v_and_b32 v2, 3, v0
    v_mul_u32_u24 v5, 2304, v2
    v_lshl_add_u32 v5, v1, 1, v5
    ds_read_u16 v16, v5 offset:0
    ds_read_u16 v17, v5 offset:144
    ds_read_u16 v18, v5 offset:288
    ds_read_u16 v19, v5 offset:432
    ds_read_u16 v20, v5 offset:576
    ds_read_u16 v21, v5 offset:720
    ds_read_u16 v22, v5 offset:864
    ds_read_u16 v23, v5 offset:1008
    ds_read_u16 v24, v5 offset:1152
    ds_read_u16 v25, v5 offset:1296
    ds_read_u16 v26, v5 offset:1440
    ds_read_u16 v27, v5 offset:1584
    ds_read_u16 v28, v5 offset:1728
    ds_read_u16 v29, v5 offset:1872
    ds_read_u16 v30, v5 offset:2016
    ds_read_u16 v31, v5 offset:2160
    s_mul_i32 s24, s20, 1605632
    s_mul_i32 s25, s22, 229376
    s_add_u32 s24, s24, s25
    s_lshl_b32 s25, s21, 7
    s_add_u32 s24, s24, s25
    s_mov_b32 s26, 3584
    v_mul_lo_u32 v3, v1, s26
    v_lshl_add_u32 v3, v2, 5, v3
    v_add_u32 v3, s24, v3
    s_waitcnt lgkmcnt(0)
    v_lshl_or_b32 v8, v17, 16, v16
    v_lshl_or_b32 v9, v19, 16, v18
    v_lshl_or_b32 v10, v21, 16, v20
    v_lshl_or_b32 v11, v23, 16, v22
    v_lshl_or_b32 v12, v25, 16, v24
    v_lshl_or_b32 v13, v27, 16, v26
    v_lshl_or_b32 v14, v29, 16, v28
    v_lshl_or_b32 v15, v31, 16, v30
    buffer_store_dwordx4 v[8:11], v3, s[12:15], 0 offen
    buffer_store_dwordx4 v[12:15], v3, s[12:15], 0 offen offset:16
    s_branch prep_kernel_done
prep_kernel_tr3:
    s_sub_u32 s4, s3, 840
    s_load_dwordx2 s[12:13], s[0:1], 112
    s_waitcnt lgkmcnt(0)
    s_add_u32 s12, s12, 0x6000000
    s_addc_u32 s13, s13, 0
    s_and_b32 s13, s13, 0xffff
    s_mov_b32 s14, 0x400000
    s_mov_b32 s15, 0x00020000
    s_lshl_b32 s4, s4, 14
    v_lshlrev_b32 v1, 4, v0
    v_add_u32 v1, s4, v1
    v_mov_b32 v4, 0
    v_mov_b32 v5, 0
    v_mov_b32 v6, 0
    v_mov_b32 v7, 0
    buffer_store_dwordx4 v[4:7], v1, s[12:15], 0 offen offset:0
    v_add_u32 v1, 4096, v1
    buffer_store_dwordx4 v[4:7], v1, s[12:15], 0 offen
    v_add_u32 v1, 4096, v1
    buffer_store_dwordx4 v[4:7], v1, s[12:15], 0 offen
    v_add_u32 v1, 4096, v1
    buffer_store_dwordx4 v[4:7], v1, s[12:15], 0 offen
prep_kernel_done:
    s_endpgm
.text
.globl g1_kernel
.p2align 8
.type g1_kernel,@function
g1_kernel:
y_f1:
    s_sub_u32 s2, s2, 0
    s_cmp_ge_u32 s2, 224
    s_cbranch_scc1 y_at
    s_mul_hi_u32 s20, s2, 0x124924a
    s_mul_i32 s24, s20, 224
    s_sub_u32 s23, s2, s24
    s_mul_hi_u32 s22, s23, 0x12492493
    s_mul_i32 s24, s22, 14
    s_sub_u32 s21, s23, s24
    s_load_dwordx2 s[8:9], s[0:1], 112
    s_waitcnt lgkmcnt(0)
    s_add_u32 s8, s8, 0x1400000
    s_addc_u32 s9, s9, 0
    s_and_b32 s9, s9, 0xffff
    s_mov_b32 s10, 0xec00000
    s_mov_b32 s11, 0x00020000
    s_load_dwordx2 s[12:13], s[0:1], 112
    s_waitcnt lgkmcnt(0)
    s_and_b32 s13, s13, 0xffff
    s_mov_b32 s14, 0x10000000
    s_mov_b32 s15, 0x00020000
    s_load_dwordx2 s[16:17], s[0:1], 112
    s_waitcnt lgkmcnt(0)
    s_add_u32 s16, s16, 0x1800000
    s_addc_u32 s17, s17, 0
    s_and_b32 s17, s17, 0xffff
    s_mov_b32 s18, 0xe800000
    s_mov_b32 s19, 0x00020000
    s_load_dwordx2 s[28:29], s[0:1], 72
    s_waitcnt lgkmcnt(0)
    s_and_b32 s29, s29, 0xffff
    s_mov_b32 s30, 0xe00
    s_mov_b32 s31, 0x00020000
    v_lshrrev_b32 v4, 3, v0
    v_and_b32 v5, 7, v0
    v_lshlrev_b32 v5, 4, v5
    s_mul_i32 s24, s21, 114688
    s_mul_i32 s25, s20, 0
    s_add_u32 s24, s24, s25
    s_mov_b32 s26, 896
    v_mul_lo_u32 v1, v4, s26
    v_add_u32 v1, v1, v5
    v_add_u32 v1, s24, v1
    s_mul_i32 s24, s22, 114688
    s_mul_i32 s25, s20, 0
    s_add_u32 s24, s24, s25
    s_mov_b32 s26, 896
    v_mul_lo_u32 v2, v4, s26
    v_add_u32 v2, v2, v5
    v_add_u32 v2, s24, v2
    v_mul_u32_u24 v3, 144, v4
    v_add_u32 v3, v3, v5
    v_lshrrev_b32 v6, 6, v0
    v_and_b32 v7, 1, v6
    v_lshrrev_b32 v6, 1, v6
    v_and_b32 v8, 31, v0
    v_bfe_u32 v9, v0, 5, 1
    v_lshlrev_b32 v10, 4, v9
    v_mul_u32_u24 v11, 64, v7
    v_add_u32 v11, v11, v8
    v_mul_u32_u24 v11, 144, v11
    v_add_u32 v11, v11, v10
    v_mul_u32_u24 v12, 64, v6
    v_add_u32 v12, v12, v8
    v_mul_u32_u24 v12, 144, v12
    v_add_u32 v12, v12, v10
    v_add_u32 v12, 18432, v12
    v_add_u32 v15, 36864, v3
    v_add_u32 v16, 36864, v11
    v_add_u32 v17, 36864, v12
    v_mov_b32 v20, 0
    v_mov_b32 v21, 0
    v_mov_b32 v22, 0
    v_mov_b32 v23, 0
    v_mov_b32 v24, 0
    v_mov_b32 v25, 0
    v_mov_b32 v26, 0
    v_mov_b32 v27, 0
    v_mov_b32 v28, 0
    v_mov_b32 v29, 0
    v_mov_b32 v30, 0
    v_mov_b32 v31, 0
    v_mov_b32 v32, 0
    v_mov_b32 v33, 0
    v_mov_b32 v34, 0
    v_mov_b32 v35, 0
    v_mov_b32 v36, 0
    v_mov_b32 v37, 0
    v_mov_b32 v38, 0
    v_mov_b32 v39, 0
    v_mov_b32 v40, 0
    v_mov_b32 v41, 0
    v_mov_b32 v42, 0
    v_mov_b32 v43, 0
    v_mov_b32 v44, 0
    v_mov_b32 v45, 0
    v_mov_b32 v46, 0
    v_mov_b32 v47, 0
    v_mov_b32 v48, 0
    v_mov_b32 v49, 0
    v_mov_b32 v50, 0
    v_mov_b32 v51, 0
    v_mov_b32 v52, 0
    v_mov_b32 v53, 0
    v_mov_b32 v54, 0
    v_mov_b32 v55, 0
    v_mov_b32 v56, 0
    v_mov_b32 v57, 0
    v_mov_b32 v58, 0
    v_mov_b32 v59, 0
    v_mov_b32 v60, 0
    v_mov_b32 v61, 0
    v_mov_b32 v62, 0
    v_mov_b32 v63, 0
    v_mov_b32 v64, 0
    v_mov_b32 v65, 0
    v_mov_b32 v66, 0
    v_mov_b32 v67, 0
    v_mov_b32 v68, 0
    v_mov_b32 v69, 0
    v_mov_b32 v70, 0
    v_mov_b32 v71, 0
    v_mov_b32 v72, 0
    v_mov_b32 v73, 0
    v_mov_b32 v74, 0
    v_mov_b32 v75, 0
    v_mov_b32 v76, 0
    v_mov_b32 v77, 0
    v_mov_b32 v78, 0
    v_mov_b32 v79, 0
    v_mov_b32 v80, 0
    v_mov_b32 v81, 0
    v_mov_b32 v82, 0
    v_mov_b32 v83, 0
    s_mov_b32 s27, 0
    buffer_load_dwordx4 v[100:103], v1, s[8:11], s27 offen
    v_add_u32 v13, 28672, v1
    buffer_load_dwordx4 v[104:107], v13, s[8:11], s27 offen
    v_add_u32 v13, 57344, v1
    buffer_load_dwordx4 v[108:111], v13, s[8:11], s27 offen
    v_add_u32 v13, 86016, v1
    buffer_load_dwordx4 v[112:115], v13, s[8:11], s27 offen
    buffer_load_dwordx4 v[116:119], v2, s[12:15], s27 offen
    v_add_u32 v14, 28672, v2
    buffer_load_dwordx4 v[120:123], v14, s[12:15], s27 offen
    v_add_u32 v14, 57344, v2
    buffer_load_dwordx4 v[124:127], v14, s[12:15], s27 offen
    v_add_u32 v14, 86016, v2
    buffer_load_dwordx4 v[128:131], v14, s[12:15], s27 offen
    s_waitcnt vmcnt(0)
    ds_write_b128 v3, v[100:103] offset:0
    ds_write_b128 v3, v[104:107] offset:4608
    ds_write_b128 v3, v[108:111] offset:9216
    ds_write_b128 v3, v[112:115] offset:13824
    ds_write_b128 v3, v[116:119] offset:18432
    ds_write_b128 v3, v[120:123] offset:23040
    ds_write_b128 v3, v[124:127] offset:27648
    ds_write_b128 v3, v[128:131] offset:32256
    s_waitcnt lgkmcnt(0)
    s_barrier
    s_mov_b32 s27, 128
    buffer_load_dwordx4 v[100:103], v1, s[8:11], s27 offen
    v_add_u32 v13, 28672, v1
    buffer_load_dwordx4 v[104:107], v13, s[8:11], s27 offen
    v_add_u32 v13, 57344, v1
    buffer_load_dwordx4 v[108:111], v13, s[8:11], s27 offen
    v_add_u32 v13, 86016, v1
    buffer_load_dwordx4 v[112:115], v13, s[8:11], s27 offen
    buffer_load_dwordx4 v[116:119], v2, s[12:15], s27 offen
    v_add_u32 v14, 28672, v2
    buffer_load_dwordx4 v[120:123], v14, s[12:15], s27 offen
    v_add_u32 v14, 57344, v2
    buffer_load_dwordx4 v[124:127], v14, s[12:15], s27 offen
    v_add_u32 v14, 86016, v2
    buffer_load_dwordx4 v[128:131], v14, s[12:15], s27 offen
    ds_read_b128 v[84:87], v11 offset:0
    ds_read_b128 v[88:91], v11 offset:4608
    ds_read_b128 v[92:95], v12 offset:0
    ds_read_b128 v[96:99], v12 offset:4608
    s_waitcnt lgkmcnt(0)
    v_mfma_f32_32x32x16_bf16 v[20:35], v[84:87], v[92:95], v[20:35]
    v_mfma_f32_32x32x16_bf16 v[36:51], v[84:87], v[96:99], v[36:51]
    v_mfma_f32_32x32x16_bf16 v[52:67], v[88:91], v[92:95], v[52:67]
    v_mfma_f32_32x32x16_bf16 v[68:83], v[88:91], v[96:99], v[68:83]
    ds_read_b128 v[84:87], v11 offset:32
    ds_read_b128 v[88:91], v11 offset:4640
    ds_read_b128 v[92:95], v12 offset:32
    ds_read_b128 v[96:99], v12 offset:4640
    s_waitcnt lgkmcnt(0)
    v_mfma_f32_32x32x16_bf16 v[20:35], v[84:87], v[92:95], v[20:35]
    v_mfma_f32_32x32x16_bf16 v[36:51], v[84:87], v[96:99], v[36:51]
    v_mfma_f32_32x32x16_bf16 v[52:67], v[88:91], v[92:95], v[52:67]
    v_mfma_f32_32x32x16_bf16 v[68:83], v[88:91], v[96:99], v[68:83]
    ds_read_b128 v[84:87], v11 offset:64
    ds_read_b128 v[88:91], v11 offset:4672
    ds_read_b128 v[92:95], v12 offset:64
    ds_read_b128 v[96:99], v12 offset:4672
    s_waitcnt lgkmcnt(0)
    v_mfma_f32_32x32x16_bf16 v[20:35], v[84:87], v[92:95], v[20:35]
    v_mfma_f32_32x32x16_bf16 v[36:51], v[84:87], v[96:99], v[36:51]
    v_mfma_f32_32x32x16_bf16 v[52:67], v[88:91], v[92:95], v[52:67]
    v_mfma_f32_32x32x16_bf16 v[68:83], v[88:91], v[96:99], v[68:83]
    ds_read_b128 v[84:87], v11 offset:96
    ds_read_b128 v[88:91], v11 offset:4704
    ds_read_b128 v[92:95], v12 offset:96
    ds_read_b128 v[96:99], v12 offset:4704
    s_waitcnt lgkmcnt(0)
    v_mfma_f32_32x32x16_bf16 v[20:35], v[84:87], v[92:95], v[20:35]
    v_mfma_f32_32x32x16_bf16 v[36:51], v[84:87], v[96:99], v[36:51]
    v_mfma_f32_32x32x16_bf16 v[52:67], v[88:91], v[92:95], v[52:67]
    v_mfma_f32_32x32x16_bf16 v[68:83], v[88:91], v[96:99], v[68:83]
    s_waitcnt vmcnt(0)
    ds_write_b128 v15, v[100:103] offset:0
    ds_write_b128 v15, v[104:107] offset:4608
    ds_write_b128 v15, v[108:111] offset:9216
    ds_write_b128 v15, v[112:115] offset:13824
    ds_write_b128 v15, v[116:119] offset:18432
    ds_write_b128 v15, v[120:123] offset:23040
    ds_write_b128 v15, v[124:127] offset:27648
    ds_write_b128 v15, v[128:131] offset:32256
    s_waitcnt lgkmcnt(0)
    s_barrier
    s_mov_b32 s27, 256
    buffer_load_dwordx4 v[100:103], v1, s[8:11], s27 offen
    v_add_u32 v13, 28672, v1
    buffer_load_dwordx4 v[104:107], v13, s[8:11], s27 offen
    v_add_u32 v13, 57344, v1
    buffer_load_dwordx4 v[108:111], v13, s[8:11], s27 offen
    v_add_u32 v13, 86016, v1
    buffer_load_dwordx4 v[112:115], v13, s[8:11], s27 offen
    buffer_load_dwordx4 v[116:119], v2, s[12:15], s27 offen
    v_add_u32 v14, 28672, v2
    buffer_load_dwordx4 v[120:123], v14, s[12:15], s27 offen
    v_add_u32 v14, 57344, v2
    buffer_load_dwordx4 v[124:127], v14, s[12:15], s27 offen
    v_add_u32 v14, 86016, v2
    buffer_load_dwordx4 v[128:131], v14, s[12:15], s27 offen
    ds_read_b128 v[84:87], v16 offset:0
    ds_read_b128 v[88:91], v16 offset:4608
    ds_read_b128 v[92:95], v17 offset:0
    ds_read_b128 v[96:99], v17 offset:4608
    s_waitcnt lgkmcnt(0)
    v_mfma_f32_32x32x16_bf16 v[20:35], v[84:87], v[92:95], v[20:35]
    v_mfma_f32_32x32x16_bf16 v[36:51], v[84:87], v[96:99], v[36:51]
    v_mfma_f32_32x32x16_bf16 v[52:67], v[88:91], v[92:95], v[52:67]
    v_mfma_f32_32x32x16_bf16 v[68:83], v[88:91], v[96:99], v[68:83]
    ds_read_b128 v[84:87], v16 offset:32
    ds_read_b128 v[88:91], v16 offset:4640
    ds_read_b128 v[92:95], v17 offset:32
    ds_read_b128 v[96:99], v17 offset:4640
    s_waitcnt lgkmcnt(0)
    v_mfma_f32_32x32x16_bf16 v[20:35], v[84:87], v[92:95], v[20:35]
    v_mfma_f32_32x32x16_bf16 v[36:51], v[84:87], v[96:99], v[36:51]
    v_mfma_f32_32x32x16_bf16 v[52:67], v[88:91], v[92:95], v[52:67]
    v_mfma_f32_32x32x16_bf16 v[68:83], v[88:91], v[96:99], v[68:83]
    ds_read_b128 v[84:87], v16 offset:64
    ds_read_b128 v[88:91], v16 offset:4672
    ds_read_b128 v[92:95], v17 offset:64
    ds_read_b128 v[96:99], v17 offset:4672
    s_waitcnt lgkmcnt(0)
    v_mfma_f32_32x32x16_bf16 v[20:35], v[84:87], v[92:95], v[20:35]
    v_mfma_f32_32x32x16_bf16 v[36:51], v[84:87], v[96:99], v[36:51]
    v_mfma_f32_32x32x16_bf16 v[52:67], v[88:91], v[92:95], v[52:67]
    v_mfma_f32_32x32x16_bf16 v[68:83], v[88:91], v[96:99], v[68:83]
    ds_read_b128 v[84:87], v16 offset:96
    ds_read_b128 v[88:91], v16 offset:4704
    ds_read_b128 v[92:95], v17 offset:96
    ds_read_b128 v[96:99], v17 offset:4704
    s_waitcnt lgkmcnt(0)
    v_mfma_f32_32x32x16_bf16 v[20:35], v[84:87], v[92:95], v[20:35]
    v_mfma_f32_32x32x16_bf16 v[36:51], v[84:87], v[96:99], v[36:51]
    v_mfma_f32_32x32x16_bf16 v[52:67], v[88:91], v[92:95], v[52:67]
    v_mfma_f32_32x32x16_bf16 v[68:83], v[88:91], v[96:99], v[68:83]
    s_waitcnt vmcnt(0)
    ds_write_b128 v3, v[100:103] offset:0
    ds_write_b128 v3, v[104:107] offset:4608
    ds_write_b128 v3, v[108:111] offset:9216
    ds_write_b128 v3, v[112:115] offset:13824
    ds_write_b128 v3, v[116:119] offset:18432
    ds_write_b128 v3, v[120:123] offset:23040
    ds_write_b128 v3, v[124:127] offset:27648
    ds_write_b128 v3, v[128:131] offset:32256
    s_waitcnt lgkmcnt(0)
    s_barrier
    s_mov_b32 s27, 384
    buffer_load_dwordx4 v[100:103], v1, s[8:11], s27 offen
    v_add_u32 v13, 28672, v1
    buffer_load_dwordx4 v[104:107], v13, s[8:11], s27 offen
    v_add_u32 v13, 57344, v1
    buffer_load_dwordx4 v[108:111], v13, s[8:11], s27 offen
    v_add_u32 v13, 86016, v1
    buffer_load_dwordx4 v[112:115], v13, s[8:11], s27 offen
    buffer_load_dwordx4 v[116:119], v2, s[12:15], s27 offen
    v_add_u32 v14, 28672, v2
    buffer_load_dwordx4 v[120:123], v14, s[12:15], s27 offen
    v_add_u32 v14, 57344, v2
    buffer_load_dwordx4 v[124:127], v14, s[12:15], s27 offen
    v_add_u32 v14, 86016, v2
    buffer_load_dwordx4 v[128:131], v14, s[12:15], s27 offen
    ds_read_b128 v[84:87], v11 offset:0
    ds_read_b128 v[88:91], v11 offset:4608
    ds_read_b128 v[92:95], v12 offset:0
    ds_read_b128 v[96:99], v12 offset:4608
    s_waitcnt lgkmcnt(0)
    v_mfma_f32_32x32x16_bf16 v[20:35], v[84:87], v[92:95], v[20:35]
    v_mfma_f32_32x32x16_bf16 v[36:51], v[84:87], v[96:99], v[36:51]
    v_mfma_f32_32x32x16_bf16 v[52:67], v[88:91], v[92:95], v[52:67]
    v_mfma_f32_32x32x16_bf16 v[68:83], v[88:91], v[96:99], v[68:83]
    ds_read_b128 v[84:87], v11 offset:32
    ds_read_b128 v[88:91], v11 offset:4640
    ds_read_b128 v[92:95], v12 offset:32
    ds_read_b128 v[96:99], v12 offset:4640
    s_waitcnt lgkmcnt(0)
    v_mfma_f32_32x32x16_bf16 v[20:35], v[84:87], v[92:95], v[20:35]
    v_mfma_f32_32x32x16_bf16 v[36:51], v[84:87], v[96:99], v[36:51]
    v_mfma_f32_32x32x16_bf16 v[52:67], v[88:91], v[92:95], v[52:67]
    v_mfma_f32_32x32x16_bf16 v[68:83], v[88:91], v[96:99], v[68:83]
    ds_read_b128 v[84:87], v11 offset:64
    ds_read_b128 v[88:91], v11 offset:4672
    ds_read_b128 v[92:95], v12 offset:64
    ds_read_b128 v[96:99], v12 offset:4672
    s_waitcnt lgkmcnt(0)
    v_mfma_f32_32x32x16_bf16 v[20:35], v[84:87], v[92:95], v[20:35]
    v_mfma_f32_32x32x16_bf16 v[36:51], v[84:87], v[96:99], v[36:51]
    v_mfma_f32_32x32x16_bf16 v[52:67], v[88:91], v[92:95], v[52:67]
    v_mfma_f32_32x32x16_bf16 v[68:83], v[88:91], v[96:99], v[68:83]
    ds_read_b128 v[84:87], v11 offset:96
    ds_read_b128 v[88:91], v11 offset:4704
    ds_read_b128 v[92:95], v12 offset:96
    ds_read_b128 v[96:99], v12 offset:4704
    s_waitcnt lgkmcnt(0)
    v_mfma_f32_32x32x16_bf16 v[20:35], v[84:87], v[92:95], v[20:35]
    v_mfma_f32_32x32x16_bf16 v[36:51], v[84:87], v[96:99], v[36:51]
    v_mfma_f32_32x32x16_bf16 v[52:67], v[88:91], v[92:95], v[52:67]
    v_mfma_f32_32x32x16_bf16 v[68:83], v[88:91], v[96:99], v[68:83]
    s_waitcnt vmcnt(0)
    ds_write_b128 v15, v[100:103] offset:0
    ds_write_b128 v15, v[104:107] offset:4608
    ds_write_b128 v15, v[108:111] offset:9216
    ds_write_b128 v15, v[112:115] offset:13824
    ds_write_b128 v15, v[116:119] offset:18432
    ds_write_b128 v15, v[120:123] offset:23040
    ds_write_b128 v15, v[124:127] offset:27648
    ds_write_b128 v15, v[128:131] offset:32256
    s_waitcnt lgkmcnt(0)
    s_barrier
    s_mov_b32 s27, 512
    buffer_load_dwordx4 v[100:103], v1, s[8:11], s27 offen
    v_add_u32 v13, 28672, v1
    buffer_load_dwordx4 v[104:107], v13, s[8:11], s27 offen
    v_add_u32 v13, 57344, v1
    buffer_load_dwordx4 v[108:111], v13, s[8:11], s27 offen
    v_add_u32 v13, 86016, v1
    buffer_load_dwordx4 v[112:115], v13, s[8:11], s27 offen
    buffer_load_dwordx4 v[116:119], v2, s[12:15], s27 offen
    v_add_u32 v14, 28672, v2
    buffer_load_dwordx4 v[120:123], v14, s[12:15], s27 offen
    v_add_u32 v14, 57344, v2
    buffer_load_dwordx4 v[124:127], v14, s[12:15], s27 offen
    v_add_u32 v14, 86016, v2
    buffer_load_dwordx4 v[128:131], v14, s[12:15], s27 offen
    ds_read_b128 v[84:87], v16 offset:0
    ds_read_b128 v[88:91], v16 offset:4608
    ds_read_b128 v[92:95], v17 offset:0
    ds_read_b128 v[96:99], v17 offset:4608
    s_waitcnt lgkmcnt(0)
    v_mfma_f32_32x32x16_bf16 v[20:35], v[84:87], v[92:95], v[20:35]
    v_mfma_f32_32x32x16_bf16 v[36:51], v[84:87], v[96:99], v[36:51]
    v_mfma_f32_32x32x16_bf16 v[52:67], v[88:91], v[92:95], v[52:67]
    v_mfma_f32_32x32x16_bf16 v[68:83], v[88:91], v[96:99], v[68:83]
    ds_read_b128 v[84:87], v16 offset:32
    ds_read_b128 v[88:91], v16 offset:4640
    ds_read_b128 v[92:95], v17 offset:32
    ds_read_b128 v[96:99], v17 offset:4640
    s_waitcnt lgkmcnt(0)
    v_mfma_f32_32x32x16_bf16 v[20:35], v[84:87], v[92:95], v[20:35]
    v_mfma_f32_32x32x16_bf16 v[36:51], v[84:87], v[96:99], v[36:51]
    v_mfma_f32_32x32x16_bf16 v[52:67], v[88:91], v[92:95], v[52:67]
    v_mfma_f32_32x32x16_bf16 v[68:83], v[88:91], v[96:99], v[68:83]
    ds_read_b128 v[84:87], v16 offset:64
    ds_read_b128 v[88:91], v16 offset:4672
    ds_read_b128 v[92:95], v17 offset:64
    ds_read_b128 v[96:99], v17 offset:4672
    s_waitcnt lgkmcnt(0)
    v_mfma_f32_32x32x16_bf16 v[20:35], v[84:87], v[92:95], v[20:35]
    v_mfma_f32_32x32x16_bf16 v[36:51], v[84:87], v[96:99], v[36:51]
    v_mfma_f32_32x32x16_bf16 v[52:67], v[88:91], v[92:95], v[52:67]
    v_mfma_f32_32x32x16_bf16 v[68:83], v[88:91], v[96:99], v[68:83]
    ds_read_b128 v[84:87], v16 offset:96
    ds_read_b128 v[88:91], v16 offset:4704
    ds_read_b128 v[92:95], v17 offset:96
    ds_read_b128 v[96:99], v17 offset:4704
    s_waitcnt lgkmcnt(0)
    v_mfma_f32_32x32x16_bf16 v[20:35], v[84:87], v[92:95], v[20:35]
    v_mfma_f32_32x32x16_bf16 v[36:51], v[84:87], v[96:99], v[36:51]
    v_mfma_f32_32x32x16_bf16 v[52:67], v[88:91], v[92:95], v[52:67]
    v_mfma_f32_32x32x16_bf16 v[68:83], v[88:91], v[96:99], v[68:83]
    s_waitcnt vmcnt(0)
    ds_write_b128 v3, v[100:103] offset:0
    ds_write_b128 v3, v[104:107] offset:4608
    ds_write_b128 v3, v[108:111] offset:9216
    ds_write_b128 v3, v[112:115] offset:13824
    ds_write_b128 v3, v[116:119] offset:18432
    ds_write_b128 v3, v[120:123] offset:23040
    ds_write_b128 v3, v[124:127] offset:27648
    ds_write_b128 v3, v[128:131] offset:32256
    s_waitcnt lgkmcnt(0)
    s_barrier
    s_mov_b32 s27, 640
    buffer_load_dwordx4 v[100:103], v1, s[8:11], s27 offen
    v_add_u32 v13, 28672, v1
    buffer_load_dwordx4 v[104:107], v13, s[8:11], s27 offen
    v_add_u32 v13, 57344, v1
    buffer_load_dwordx4 v[108:111], v13, s[8:11], s27 offen
    v_add_u32 v13, 86016, v1
    buffer_load_dwordx4 v[112:115], v13, s[8:11], s27 offen
    buffer_load_dwordx4 v[116:119], v2, s[12:15], s27 offen
    v_add_u32 v14, 28672, v2
    buffer_load_dwordx4 v[120:123], v14, s[12:15], s27 offen
    v_add_u32 v14, 57344, v2
    buffer_load_dwordx4 v[124:127], v14, s[12:15], s27 offen
    v_add_u32 v14, 86016, v2
    buffer_load_dwordx4 v[128:131], v14, s[12:15], s27 offen
    ds_read_b128 v[84:87], v11 offset:0
    ds_read_b128 v[88:91], v11 offset:4608
    ds_read_b128 v[92:95], v12 offset:0
    ds_read_b128 v[96:99], v12 offset:4608
    s_waitcnt lgkmcnt(0)
    v_mfma_f32_32x32x16_bf16 v[20:35], v[84:87], v[92:95], v[20:35]
    v_mfma_f32_32x32x16_bf16 v[36:51], v[84:87], v[96:99], v[36:51]
    v_mfma_f32_32x32x16_bf16 v[52:67], v[88:91], v[92:95], v[52:67]
    v_mfma_f32_32x32x16_bf16 v[68:83], v[88:91], v[96:99], v[68:83]
    ds_read_b128 v[84:87], v11 offset:32
    ds_read_b128 v[88:91], v11 offset:4640
    ds_read_b128 v[92:95], v12 offset:32
    ds_read_b128 v[96:99], v12 offset:4640
    s_waitcnt lgkmcnt(0)
    v_mfma_f32_32x32x16_bf16 v[20:35], v[84:87], v[92:95], v[20:35]
    v_mfma_f32_32x32x16_bf16 v[36:51], v[84:87], v[96:99], v[36:51]
    v_mfma_f32_32x32x16_bf16 v[52:67], v[88:91], v[92:95], v[52:67]
    v_mfma_f32_32x32x16_bf16 v[68:83], v[88:91], v[96:99], v[68:83]
    ds_read_b128 v[84:87], v11 offset:64
    ds_read_b128 v[88:91], v11 offset:4672
    ds_read_b128 v[92:95], v12 offset:64
    ds_read_b128 v[96:99], v12 offset:4672
    s_waitcnt lgkmcnt(0)
    v_mfma_f32_32x32x16_bf16 v[20:35], v[84:87], v[92:95], v[20:35]
    v_mfma_f32_32x32x16_bf16 v[36:51], v[84:87], v[96:99], v[36:51]
    v_mfma_f32_32x32x16_bf16 v[52:67], v[88:91], v[92:95], v[52:67]
    v_mfma_f32_32x32x16_bf16 v[68:83], v[88:91], v[96:99], v[68:83]
    ds_read_b128 v[84:87], v11 offset:96
    ds_read_b128 v[88:91], v11 offset:4704
    ds_read_b128 v[92:95], v12 offset:96
    ds_read_b128 v[96:99], v12 offset:4704
    s_waitcnt lgkmcnt(0)
    v_mfma_f32_32x32x16_bf16 v[20:35], v[84:87], v[92:95], v[20:35]
    v_mfma_f32_32x32x16_bf16 v[36:51], v[84:87], v[96:99], v[36:51]
    v_mfma_f32_32x32x16_bf16 v[52:67], v[88:91], v[92:95], v[52:67]
    v_mfma_f32_32x32x16_bf16 v[68:83], v[88:91], v[96:99], v[68:83]
    s_waitcnt vmcnt(0)
    ds_write_b128 v15, v[100:103] offset:0
    ds_write_b128 v15, v[104:107] offset:4608
    ds_write_b128 v15, v[108:111] offset:9216
    ds_write_b128 v15, v[112:115] offset:13824
    ds_write_b128 v15, v[116:119] offset:18432
    ds_write_b128 v15, v[120:123] offset:23040
    ds_write_b128 v15, v[124:127] offset:27648
    ds_write_b128 v15, v[128:131] offset:32256
    s_waitcnt lgkmcnt(0)
    s_barrier
    s_mov_b32 s27, 768
    buffer_load_dwordx4 v[100:103], v1, s[8:11], s27 offen
    v_add_u32 v13, 28672, v1
    buffer_load_dwordx4 v[104:107], v13, s[8:11], s27 offen
    v_add_u32 v13, 57344, v1
    buffer_load_dwordx4 v[108:111], v13, s[8:11], s27 offen
    v_add_u32 v13, 86016, v1
    buffer_load_dwordx4 v[112:115], v13, s[8:11], s27 offen
    buffer_load_dwordx4 v[116:119], v2, s[12:15], s27 offen
    v_add_u32 v14, 28672, v2
    buffer_load_dwordx4 v[120:123], v14, s[12:15], s27 offen
    v_add_u32 v14, 57344, v2
    buffer_load_dwordx4 v[124:127], v14, s[12:15], s27 offen
    v_add_u32 v14, 86016, v2
    buffer_load_dwordx4 v[128:131], v14, s[12:15], s27 offen
    ds_read_b128 v[84:87], v16 offset:0
    ds_read_b128 v[88:91], v16 offset:4608
    ds_read_b128 v[92:95], v17 offset:0
    ds_read_b128 v[96:99], v17 offset:4608
    s_waitcnt lgkmcnt(0)
    v_mfma_f32_32x32x16_bf16 v[20:35], v[84:87], v[92:95], v[20:35]
    v_mfma_f32_32x32x16_bf16 v[36:51], v[84:87], v[96:99], v[36:51]
    v_mfma_f32_32x32x16_bf16 v[52:67], v[88:91], v[92:95], v[52:67]
    v_mfma_f32_32x32x16_bf16 v[68:83], v[88:91], v[96:99], v[68:83]
    ds_read_b128 v[84:87], v16 offset:32
    ds_read_b128 v[88:91], v16 offset:4640
    ds_read_b128 v[92:95], v17 offset:32
    ds_read_b128 v[96:99], v17 offset:4640
    s_waitcnt lgkmcnt(0)
    v_mfma_f32_32x32x16_bf16 v[20:35], v[84:87], v[92:95], v[20:35]
    v_mfma_f32_32x32x16_bf16 v[36:51], v[84:87], v[96:99], v[36:51]
    v_mfma_f32_32x32x16_bf16 v[52:67], v[88:91], v[92:95], v[52:67]
    v_mfma_f32_32x32x16_bf16 v[68:83], v[88:91], v[96:99], v[68:83]
    ds_read_b128 v[84:87], v16 offset:64
    ds_read_b128 v[88:91], v16 offset:4672
    ds_read_b128 v[92:95], v17 offset:64
    ds_read_b128 v[96:99], v17 offset:4672
    s_waitcnt lgkmcnt(0)
    v_mfma_f32_32x32x16_bf16 v[20:35], v[84:87], v[92:95], v[20:35]
    v_mfma_f32_32x32x16_bf16 v[36:51], v[84:87], v[96:99], v[36:51]
    v_mfma_f32_32x32x16_bf16 v[52:67], v[88:91], v[92:95], v[52:67]
    v_mfma_f32_32x32x16_bf16 v[68:83], v[88:91], v[96:99], v[68:83]
    ds_read_b128 v[84:87], v16 offset:96
    ds_read_b128 v[88:91], v16 offset:4704
    ds_read_b128 v[92:95], v17 offset:96
    ds_read_b128 v[96:99], v17 offset:4704
    s_waitcnt lgkmcnt(0)
    v_mfma_f32_32x32x16_bf16 v[20:35], v[84:87], v[92:95], v[20:35]
    v_mfma_f32_32x32x16_bf16 v[36:51], v[84:87], v[96:99], v[36:51]
    v_mfma_f32_32x32x16_bf16 v[52:67], v[88:91], v[92:95], v[52:67]
    v_mfma_f32_32x32x16_bf16 v[68:83], v[88:91], v[96:99], v[68:83]
    s_waitcnt vmcnt(0)
    ds_write_b128 v3, v[100:103] offset:0
    ds_write_b128 v3, v[104:107] offset:4608
    ds_write_b128 v3, v[108:111] offset:9216
    ds_write_b128 v3, v[112:115] offset:13824
    ds_write_b128 v3, v[116:119] offset:18432
    ds_write_b128 v3, v[120:123] offset:23040
    ds_write_b128 v3, v[124:127] offset:27648
    ds_write_b128 v3, v[128:131] offset:32256
    s_waitcnt lgkmcnt(0)
    s_barrier
    ds_read_b128 v[84:87], v11 offset:0
    ds_read_b128 v[88:91], v11 offset:4608
    ds_read_b128 v[92:95], v12 offset:0
    ds_read_b128 v[96:99], v12 offset:4608
    s_waitcnt lgkmcnt(0)
    v_mfma_f32_32x32x16_bf16 v[20:35], v[84:87], v[92:95], v[20:35]
    v_mfma_f32_32x32x16_bf16 v[36:51], v[84:87], v[96:99], v[36:51]
    v_mfma_f32_32x32x16_bf16 v[52:67], v[88:91], v[92:95], v[52:67]
    v_mfma_f32_32x32x16_bf16 v[68:83], v[88:91], v[96:99], v[68:83]
    ds_read_b128 v[84:87], v11 offset:32
    ds_read_b128 v[88:91], v11 offset:4640
    ds_read_b128 v[92:95], v12 offset:32
    ds_read_b128 v[96:99], v12 offset:4640
    s_waitcnt lgkmcnt(0)
    v_mfma_f32_32x32x16_bf16 v[20:35], v[84:87], v[92:95], v[20:35]
    v_mfma_f32_32x32x16_bf16 v[36:51], v[84:87], v[96:99], v[36:51]
    v_mfma_f32_32x32x16_bf16 v[52:67], v[88:91], v[92:95], v[52:67]
    v_mfma_f32_32x32x16_bf16 v[68:83], v[88:91], v[96:99], v[68:83]
    ds_read_b128 v[84:87], v11 offset:64
    ds_read_b128 v[88:91], v11 offset:4672
    ds_read_b128 v[92:95], v12 offset:64
    ds_read_b128 v[96:99], v12 offset:4672
    s_waitcnt lgkmcnt(0)
    v_mfma_f32_32x32x16_bf16 v[20:35], v[84:87], v[92:95], v[20:35]
    v_mfma_f32_32x32x16_bf16 v[36:51], v[84:87], v[96:99], v[36:51]
    v_mfma_f32_32x32x16_bf16 v[52:67], v[88:91], v[92:95], v[52:67]
    v_mfma_f32_32x32x16_bf16 v[68:83], v[88:91], v[96:99], v[68:83]
    ds_read_b128 v[84:87], v11 offset:96
    ds_read_b128 v[88:91], v11 offset:4704
    ds_read_b128 v[92:95], v12 offset:96
    ds_read_b128 v[96:99], v12 offset:4704
    s_waitcnt lgkmcnt(0)
    v_mfma_f32_32x32x16_bf16 v[20:35], v[84:87], v[92:95], v[20:35]
    v_mfma_f32_32x32x16_bf16 v[36:51], v[84:87], v[96:99], v[36:51]
    v_mfma_f32_32x32x16_bf16 v[52:67], v[88:91], v[92:95], v[52:67]
    v_mfma_f32_32x32x16_bf16 v[68:83], v[88:91], v[96:99], v[68:83]
    s_nop 15
    s_nop 7
    s_mul_i32 s24, s22, 128
    v_mul_u32_u24 v1, 64, v6
    v_add_u32 v1, v1, v8
    v_add_u32 v1, s24, v1
    s_mov_b32 s26, 3584
    v_mul_lo_u32 v1, v1, s26
    s_mul_i32 s24, s21, 128
    v_mul_u32_u24 v2, 64, v7
    v_lshl_add_u32 v2, v9, 2, v2
    v_add_u32 v2, s24, v2
    v_lshlrev_b32 v2, 1, v2
    s_mul_i32 s25, s20, 0
    v_add_u32 v1, v1, v2
    v_add_u32 v1, s25, v1
    buffer_load_dwordx2 v[84:85], v2, s[28:31], 0 offen offset:0
    v_cvt_pk_bf16_f32 v86, v20, v21
    v_cvt_pk_bf16_f32 v87, v22, v23
    s_waitcnt vmcnt(0)
    v_lshlrev_b32 v20, 16, v86
    v_lshlrev_b32 v88, 16, v84
    v_add_f32 v20, v20, v88
    v_and_b32 v21, 0xffff0000, v86
    v_and_b32 v88, 0xffff0000, v84
    v_add_f32 v21, v21, v88
    v_lshlrev_b32 v22, 16, v87
    v_lshlrev_b32 v88, 16, v85
    v_add_f32 v22, v22, v88
    v_and_b32 v23, 0xffff0000, v87
    v_and_b32 v88, 0xffff0000, v85
    v_add_f32 v23, v23, v88
    v_cvt_pk_bf16_f32 v86, v20, v21
    v_cvt_pk_bf16_f32 v87, v22, v23
    v_lshlrev_b32 v20, 16, v86
    v_mul_f32 v88, v20, v20
    v_mul_f32 v88, 0x3d372713, v88
    v_fma_f32 v88, v88, v20, v20
    v_mul_f32 v88, 0xc0135761, v88
    v_exp_f32 v88, v88
    s_nop 0
    v_add_f32 v88, 1.0, v88
    v_rcp_f32 v88, v88
    s_nop 0
    v_mul_f32 v20, v20, v88
    v_and_b32 v21, 0xffff0000, v86
    v_mul_f32 v88, v21, v21
    v_mul_f32 v88, 0x3d372713, v88
    v_fma_f32 v88, v88, v21, v21
    v_mul_f32 v88, 0xc0135761, v88
    v_exp_f32 v88, v88
    s_nop 0
    v_add_f32 v88, 1.0, v88
    v_rcp_f32 v88, v88
    s_nop 0
    v_mul_f32 v21, v21, v88
    v_lshlrev_b32 v22, 16, v87
    v_mul_f32 v88, v22, v22
    v_mul_f32 v88, 0x3d372713, v88
    v_fma_f32 v88, v88, v22, v22
    v_mul_f32 v88, 0xc0135761, v88
    v_exp_f32 v88, v88
    s_nop 0
    v_add_f32 v88, 1.0, v88
    v_rcp_f32 v88, v88
    s_nop 0
    v_mul_f32 v22, v22, v88
    v_and_b32 v23, 0xffff0000, v87
    v_mul_f32 v88, v23, v23
    v_mul_f32 v88, 0x3d372713, v88
    v_fma_f32 v88, v88, v23, v23
    v_mul_f32 v88, 0xc0135761, v88
    v_exp_f32 v88, v88
    s_nop 0
    v_add_f32 v88, 1.0, v88
    v_rcp_f32 v88, v88
    s_nop 0
    v_mul_f32 v23, v23, v88
    v_cvt_pk_bf16_f32 v86, v20, v21
    v_cvt_pk_bf16_f32 v87, v22, v23
    buffer_store_dwordx2 v[86:87], v1, s[16:19], 0 offen offset:0
    s_waitcnt vmcnt(0)
    buffer_load_dwordx2 v[84:85], v2, s[28:31], 0 offen offset:16
    v_cvt_pk_bf16_f32 v86, v24, v25
    v_cvt_pk_bf16_f32 v87, v26, v27
    s_waitcnt vmcnt(0)
    v_lshlrev_b32 v24, 16, v86
    v_lshlrev_b32 v88, 16, v84
    v_add_f32 v24, v24, v88
    v_and_b32 v25, 0xffff0000, v86
    v_and_b32 v88, 0xffff0000, v84
    v_add_f32 v25, v25, v88
    v_lshlrev_b32 v26, 16, v87
    v_lshlrev_b32 v88, 16, v85
    v_add_f32 v26, v26, v88
    v_and_b32 v27, 0xffff0000, v87
    v_and_b32 v88, 0xffff0000, v85
    v_add_f32 v27, v27, v88
    v_cvt_pk_bf16_f32 v86, v24, v25
    v_cvt_pk_bf16_f32 v87, v26, v27
    v_lshlrev_b32 v24, 16, v86
    v_mul_f32 v88, v24, v24
    v_mul_f32 v88, 0x3d372713, v88
    v_fma_f32 v88, v88, v24, v24
    v_mul_f32 v88, 0xc0135761, v88
    v_exp_f32 v88, v88
    s_nop 0
    v_add_f32 v88, 1.0, v88
    v_rcp_f32 v88, v88
    s_nop 0
    v_mul_f32 v24, v24, v88
    v_and_b32 v25, 0xffff0000, v86
    v_mul_f32 v88, v25, v25
    v_mul_f32 v88, 0x3d372713, v88
    v_fma_f32 v88, v88, v25, v25
    v_mul_f32 v88, 0xc0135761, v88
    v_exp_f32 v88, v88
    s_nop 0
    v_add_f32 v88, 1.0, v88
    v_rcp_f32 v88, v88
    s_nop 0
    v_mul_f32 v25, v25, v88
    v_lshlrev_b32 v26, 16, v87
    v_mul_f32 v88, v26, v26
    v_mul_f32 v88, 0x3d372713, v88
    v_fma_f32 v88, v88, v26, v26
    v_mul_f32 v88, 0xc0135761, v88
    v_exp_f32 v88, v88
    s_nop 0
    v_add_f32 v88, 1.0, v88
    v_rcp_f32 v88, v88
    s_nop 0
    v_mul_f32 v26, v26, v88
    v_and_b32 v27, 0xffff0000, v87
    v_mul_f32 v88, v27, v27
    v_mul_f32 v88, 0x3d372713, v88
    v_fma_f32 v88, v88, v27, v27
    v_mul_f32 v88, 0xc0135761, v88
    v_exp_f32 v88, v88
    s_nop 0
    v_add_f32 v88, 1.0, v88
    v_rcp_f32 v88, v88
    s_nop 0
    v_mul_f32 v27, v27, v88
    v_cvt_pk_bf16_f32 v86, v24, v25
    v_cvt_pk_bf16_f32 v87, v26, v27
    buffer_store_dwordx2 v[86:87], v1, s[16:19], 0 offen offset:16
    s_waitcnt vmcnt(0)
    buffer_load_dwordx2 v[84:85], v2, s[28:31], 0 offen offset:32
    v_cvt_pk_bf16_f32 v86, v28, v29
    v_cvt_pk_bf16_f32 v87, v30, v31
    s_waitcnt vmcnt(0)
    v_lshlrev_b32 v28, 16, v86
    v_lshlrev_b32 v88, 16, v84
    v_add_f32 v28, v28, v88
    v_and_b32 v29, 0xffff0000, v86
    v_and_b32 v88, 0xffff0000, v84
    v_add_f32 v29, v29, v88
    v_lshlrev_b32 v30, 16, v87
    v_lshlrev_b32 v88, 16, v85
    v_add_f32 v30, v30, v88
    v_and_b32 v31, 0xffff0000, v87
    v_and_b32 v88, 0xffff0000, v85
    v_add_f32 v31, v31, v88
    v_cvt_pk_bf16_f32 v86, v28, v29
    v_cvt_pk_bf16_f32 v87, v30, v31
    v_lshlrev_b32 v28, 16, v86
    v_mul_f32 v88, v28, v28
    v_mul_f32 v88, 0x3d372713, v88
    v_fma_f32 v88, v88, v28, v28
    v_mul_f32 v88, 0xc0135761, v88
    v_exp_f32 v88, v88
    s_nop 0
    v_add_f32 v88, 1.0, v88
    v_rcp_f32 v88, v88
    s_nop 0
    v_mul_f32 v28, v28, v88
    v_and_b32 v29, 0xffff0000, v86
    v_mul_f32 v88, v29, v29
    v_mul_f32 v88, 0x3d372713, v88
    v_fma_f32 v88, v88, v29, v29
    v_mul_f32 v88, 0xc0135761, v88
    v_exp_f32 v88, v88
    s_nop 0
    v_add_f32 v88, 1.0, v88
    v_rcp_f32 v88, v88
    s_nop 0
    v_mul_f32 v29, v29, v88
    v_lshlrev_b32 v30, 16, v87
    v_mul_f32 v88, v30, v30
    v_mul_f32 v88, 0x3d372713, v88
    v_fma_f32 v88, v88, v30, v30
    v_mul_f32 v88, 0xc0135761, v88
    v_exp_f32 v88, v88
    s_nop 0
    v_add_f32 v88, 1.0, v88
    v_rcp_f32 v88, v88
    s_nop 0
    v_mul_f32 v30, v30, v88
    v_and_b32 v31, 0xffff0000, v87
    v_mul_f32 v88, v31, v31
    v_mul_f32 v88, 0x3d372713, v88
    v_fma_f32 v88, v88, v31, v31
    v_mul_f32 v88, 0xc0135761, v88
    v_exp_f32 v88, v88
    s_nop 0
    v_add_f32 v88, 1.0, v88
    v_rcp_f32 v88, v88
    s_nop 0
    v_mul_f32 v31, v31, v88
    v_cvt_pk_bf16_f32 v86, v28, v29
    v_cvt_pk_bf16_f32 v87, v30, v31
    buffer_store_dwordx2 v[86:87], v1, s[16:19], 0 offen offset:32
    s_waitcnt vmcnt(0)
    buffer_load_dwordx2 v[84:85], v2, s[28:31], 0 offen offset:48
    v_cvt_pk_bf16_f32 v86, v32, v33
    v_cvt_pk_bf16_f32 v87, v34, v35
    s_waitcnt vmcnt(0)
    v_lshlrev_b32 v32, 16, v86
    v_lshlrev_b32 v88, 16, v84
    v_add_f32 v32, v32, v88
    v_and_b32 v33, 0xffff0000, v86
    v_and_b32 v88, 0xffff0000, v84
    v_add_f32 v33, v33, v88
    v_lshlrev_b32 v34, 16, v87
    v_lshlrev_b32 v88, 16, v85
    v_add_f32 v34, v34, v88
    v_and_b32 v35, 0xffff0000, v87
    v_and_b32 v88, 0xffff0000, v85
    v_add_f32 v35, v35, v88
    v_cvt_pk_bf16_f32 v86, v32, v33
    v_cvt_pk_bf16_f32 v87, v34, v35
    v_lshlrev_b32 v32, 16, v86
    v_mul_f32 v88, v32, v32
    v_mul_f32 v88, 0x3d372713, v88
    v_fma_f32 v88, v88, v32, v32
    v_mul_f32 v88, 0xc0135761, v88
    v_exp_f32 v88, v88
    s_nop 0
    v_add_f32 v88, 1.0, v88
    v_rcp_f32 v88, v88
    s_nop 0
    v_mul_f32 v32, v32, v88
    v_and_b32 v33, 0xffff0000, v86
    v_mul_f32 v88, v33, v33
    v_mul_f32 v88, 0x3d372713, v88
    v_fma_f32 v88, v88, v33, v33
    v_mul_f32 v88, 0xc0135761, v88
    v_exp_f32 v88, v88
    s_nop 0
    v_add_f32 v88, 1.0, v88
    v_rcp_f32 v88, v88
    s_nop 0
    v_mul_f32 v33, v33, v88
    v_lshlrev_b32 v34, 16, v87
    v_mul_f32 v88, v34, v34
    v_mul_f32 v88, 0x3d372713, v88
    v_fma_f32 v88, v88, v34, v34
    v_mul_f32 v88, 0xc0135761, v88
    v_exp_f32 v88, v88
    s_nop 0
    v_add_f32 v88, 1.0, v88
    v_rcp_f32 v88, v88
    s_nop 0
    v_mul_f32 v34, v34, v88
    v_and_b32 v35, 0xffff0000, v87
    v_mul_f32 v88, v35, v35
    v_mul_f32 v88, 0x3d372713, v88
    v_fma_f32 v88, v88, v35, v35
    v_mul_f32 v88, 0xc0135761, v88
    v_exp_f32 v88, v88
    s_nop 0
    v_add_f32 v88, 1.0, v88
    v_rcp_f32 v88, v88
    s_nop 0
    v_mul_f32 v35, v35, v88
    v_cvt_pk_bf16_f32 v86, v32, v33
    v_cvt_pk_bf16_f32 v87, v34, v35
    buffer_store_dwordx2 v[86:87], v1, s[16:19], 0 offen offset:48
    s_waitcnt vmcnt(0)
    buffer_load_dwordx2 v[84:85], v2, s[28:31], 0 offen offset:0
    v_cvt_pk_bf16_f32 v86, v36, v37
    v_cvt_pk_bf16_f32 v87, v38, v39
    s_waitcnt vmcnt(0)
    v_lshlrev_b32 v36, 16, v86
    v_lshlrev_b32 v88, 16, v84
    v_add_f32 v36, v36, v88
    v_and_b32 v37, 0xffff0000, v86
    v_and_b32 v88, 0xffff0000, v84
    v_add_f32 v37, v37, v88
    v_lshlrev_b32 v38, 16, v87
    v_lshlrev_b32 v88, 16, v85
    v_add_f32 v38, v38, v88
    v_and_b32 v39, 0xffff0000, v87
    v_and_b32 v88, 0xffff0000, v85
    v_add_f32 v39, v39, v88
    v_cvt_pk_bf16_f32 v86, v36, v37
    v_cvt_pk_bf16_f32 v87, v38, v39
    v_lshlrev_b32 v36, 16, v86
    v_mul_f32 v88, v36, v36
    v_mul_f32 v88, 0x3d372713, v88
    v_fma_f32 v88, v88, v36, v36
    v_mul_f32 v88, 0xc0135761, v88
    v_exp_f32 v88, v88
    s_nop 0
    v_add_f32 v88, 1.0, v88
    v_rcp_f32 v88, v88
    s_nop 0
    v_mul_f32 v36, v36, v88
    v_and_b32 v37, 0xffff0000, v86
    v_mul_f32 v88, v37, v37
    v_mul_f32 v88, 0x3d372713, v88
    v_fma_f32 v88, v88, v37, v37
    v_mul_f32 v88, 0xc0135761, v88
    v_exp_f32 v88, v88
    s_nop 0
    v_add_f32 v88, 1.0, v88
    v_rcp_f32 v88, v88
    s_nop 0
    v_mul_f32 v37, v37, v88
    v_lshlrev_b32 v38, 16, v87
    v_mul_f32 v88, v38, v38
    v_mul_f32 v88, 0x3d372713, v88
    v_fma_f32 v88, v88, v38, v38
    v_mul_f32 v88, 0xc0135761, v88
    v_exp_f32 v88, v88
    s_nop 0
    v_add_f32 v88, 1.0, v88
    v_rcp_f32 v88, v88
    s_nop 0
    v_mul_f32 v38, v38, v88
    v_and_b32 v39, 0xffff0000, v87
    v_mul_f32 v88, v39, v39
    v_mul_f32 v88, 0x3d372713, v88
    v_fma_f32 v88, v88, v39, v39
    v_mul_f32 v88, 0xc0135761, v88
    v_exp_f32 v88, v88
    s_nop 0
    v_add_f32 v88, 1.0, v88
    v_rcp_f32 v88, v88
    s_nop 0
    v_mul_f32 v39, v39, v88
    v_cvt_pk_bf16_f32 v86, v36, v37
    v_cvt_pk_bf16_f32 v87, v38, v39
    s_mov_b32 s26, 114688
    buffer_store_dwordx2 v[86:87], v1, s[16:19], s26 offen offset:0
    s_waitcnt vmcnt(0)
    buffer_load_dwordx2 v[84:85], v2, s[28:31], 0 offen offset:16
    v_cvt_pk_bf16_f32 v86, v40, v41
    v_cvt_pk_bf16_f32 v87, v42, v43
    s_waitcnt vmcnt(0)
    v_lshlrev_b32 v40, 16, v86
    v_lshlrev_b32 v88, 16, v84
    v_add_f32 v40, v40, v88
    v_and_b32 v41, 0xffff0000, v86
    v_and_b32 v88, 0xffff0000, v84
    v_add_f32 v41, v41, v88
    v_lshlrev_b32 v42, 16, v87
    v_lshlrev_b32 v88, 16, v85
    v_add_f32 v42, v42, v88
    v_and_b32 v43, 0xffff0000, v87
    v_and_b32 v88, 0xffff0000, v85
    v_add_f32 v43, v43, v88
    v_cvt_pk_bf16_f32 v86, v40, v41
    v_cvt_pk_bf16_f32 v87, v42, v43
    v_lshlrev_b32 v40, 16, v86
    v_mul_f32 v88, v40, v40
    v_mul_f32 v88, 0x3d372713, v88
    v_fma_f32 v88, v88, v40, v40
    v_mul_f32 v88, 0xc0135761, v88
    v_exp_f32 v88, v88
    s_nop 0
    v_add_f32 v88, 1.0, v88
    v_rcp_f32 v88, v88
    s_nop 0
    v_mul_f32 v40, v40, v88
    v_and_b32 v41, 0xffff0000, v86
    v_mul_f32 v88, v41, v41
    v_mul_f32 v88, 0x3d372713, v88
    v_fma_f32 v88, v88, v41, v41
    v_mul_f32 v88, 0xc0135761, v88
    v_exp_f32 v88, v88
    s_nop 0
    v_add_f32 v88, 1.0, v88
    v_rcp_f32 v88, v88
    s_nop 0
    v_mul_f32 v41, v41, v88
    v_lshlrev_b32 v42, 16, v87
    v_mul_f32 v88, v42, v42
    v_mul_f32 v88, 0x3d372713, v88
    v_fma_f32 v88, v88, v42, v42
    v_mul_f32 v88, 0xc0135761, v88
    v_exp_f32 v88, v88
    s_nop 0
    v_add_f32 v88, 1.0, v88
    v_rcp_f32 v88, v88
    s_nop 0
    v_mul_f32 v42, v42, v88
    v_and_b32 v43, 0xffff0000, v87
    v_mul_f32 v88, v43, v43
    v_mul_f32 v88, 0x3d372713, v88
    v_fma_f32 v88, v88, v43, v43
    v_mul_f32 v88, 0xc0135761, v88
    v_exp_f32 v88, v88
    s_nop 0
    v_add_f32 v88, 1.0, v88
    v_rcp_f32 v88, v88
    s_nop 0
    v_mul_f32 v43, v43, v88
    v_cvt_pk_bf16_f32 v86, v40, v41
    v_cvt_pk_bf16_f32 v87, v42, v43
    s_mov_b32 s26, 114688
    buffer_store_dwordx2 v[86:87], v1, s[16:19], s26 offen offset:16
    s_waitcnt vmcnt(0)
    buffer_load_dwordx2 v[84:85], v2, s[28:31], 0 offen offset:32
    v_cvt_pk_bf16_f32 v86, v44, v45
    v_cvt_pk_bf16_f32 v87, v46, v47
    s_waitcnt vmcnt(0)
    v_lshlrev_b32 v44, 16, v86
    v_lshlrev_b32 v88, 16, v84
    v_add_f32 v44, v44, v88
    v_and_b32 v45, 0xffff0000, v86
    v_and_b32 v88, 0xffff0000, v84
    v_add_f32 v45, v45, v88
    v_lshlrev_b32 v46, 16, v87
    v_lshlrev_b32 v88, 16, v85
    v_add_f32 v46, v46, v88
    v_and_b32 v47, 0xffff0000, v87
    v_and_b32 v88, 0xffff0000, v85
    v_add_f32 v47, v47, v88
    v_cvt_pk_bf16_f32 v86, v44, v45
    v_cvt_pk_bf16_f32 v87, v46, v47
    v_lshlrev_b32 v44, 16, v86
    v_mul_f32 v88, v44, v44
    v_mul_f32 v88, 0x3d372713, v88
    v_fma_f32 v88, v88, v44, v44
    v_mul_f32 v88, 0xc0135761, v88
    v_exp_f32 v88, v88
    s_nop 0
    v_add_f32 v88, 1.0, v88
    v_rcp_f32 v88, v88
    s_nop 0
    v_mul_f32 v44, v44, v88
    v_and_b32 v45, 0xffff0000, v86
    v_mul_f32 v88, v45, v45
    v_mul_f32 v88, 0x3d372713, v88
    v_fma_f32 v88, v88, v45, v45
    v_mul_f32 v88, 0xc0135761, v88
    v_exp_f32 v88, v88
    s_nop 0
    v_add_f32 v88, 1.0, v88
    v_rcp_f32 v88, v88
    s_nop 0
    v_mul_f32 v45, v45, v88
    v_lshlrev_b32 v46, 16, v87
    v_mul_f32 v88, v46, v46
    v_mul_f32 v88, 0x3d372713, v88
    v_fma_f32 v88, v88, v46, v46
    v_mul_f32 v88, 0xc0135761, v88
    v_exp_f32 v88, v88
    s_nop 0
    v_add_f32 v88, 1.0, v88
    v_rcp_f32 v88, v88
    s_nop 0
    v_mul_f32 v46, v46, v88
    v_and_b32 v47, 0xffff0000, v87
    v_mul_f32 v88, v47, v47
    v_mul_f32 v88, 0x3d372713, v88
    v_fma_f32 v88, v88, v47, v47
    v_mul_f32 v88, 0xc0135761, v88
    v_exp_f32 v88, v88
    s_nop 0
    v_add_f32 v88, 1.0, v88
    v_rcp_f32 v88, v88
    s_nop 0
    v_mul_f32 v47, v47, v88
    v_cvt_pk_bf16_f32 v86, v44, v45
    v_cvt_pk_bf16_f32 v87, v46, v47
    s_mov_b32 s26, 114688
    buffer_store_dwordx2 v[86:87], v1, s[16:19], s26 offen offset:32
    s_waitcnt vmcnt(0)
    buffer_load_dwordx2 v[84:85], v2, s[28:31], 0 offen offset:48
    v_cvt_pk_bf16_f32 v86, v48, v49
    v_cvt_pk_bf16_f32 v87, v50, v51
    s_waitcnt vmcnt(0)
    v_lshlrev_b32 v48, 16, v86
    v_lshlrev_b32 v88, 16, v84
    v_add_f32 v48, v48, v88
    v_and_b32 v49, 0xffff0000, v86
    v_and_b32 v88, 0xffff0000, v84
    v_add_f32 v49, v49, v88
    v_lshlrev_b32 v50, 16, v87
    v_lshlrev_b32 v88, 16, v85
    v_add_f32 v50, v50, v88
    v_and_b32 v51, 0xffff0000, v87
    v_and_b32 v88, 0xffff0000, v85
    v_add_f32 v51, v51, v88
    v_cvt_pk_bf16_f32 v86, v48, v49
    v_cvt_pk_bf16_f32 v87, v50, v51
    v_lshlrev_b32 v48, 16, v86
    v_mul_f32 v88, v48, v48
    v_mul_f32 v88, 0x3d372713, v88
    v_fma_f32 v88, v88, v48, v48
    v_mul_f32 v88, 0xc0135761, v88
    v_exp_f32 v88, v88
    s_nop 0
    v_add_f32 v88, 1.0, v88
    v_rcp_f32 v88, v88
    s_nop 0
    v_mul_f32 v48, v48, v88
    v_and_b32 v49, 0xffff0000, v86
    v_mul_f32 v88, v49, v49
    v_mul_f32 v88, 0x3d372713, v88
    v_fma_f32 v88, v88, v49, v49
    v_mul_f32 v88, 0xc0135761, v88
    v_exp_f32 v88, v88
    s_nop 0
    v_add_f32 v88, 1.0, v88
    v_rcp_f32 v88, v88
    s_nop 0
    v_mul_f32 v49, v49, v88
    v_lshlrev_b32 v50, 16, v87
    v_mul_f32 v88, v50, v50
    v_mul_f32 v88, 0x3d372713, v88
    v_fma_f32 v88, v88, v50, v50
    v_mul_f32 v88, 0xc0135761, v88
    v_exp_f32 v88, v88
    s_nop 0
    v_add_f32 v88, 1.0, v88
    v_rcp_f32 v88, v88
    s_nop 0
    v_mul_f32 v50, v50, v88
    v_and_b32 v51, 0xffff0000, v87
    v_mul_f32 v88, v51, v51
    v_mul_f32 v88, 0x3d372713, v88
    v_fma_f32 v88, v88, v51, v51
    v_mul_f32 v88, 0xc0135761, v88
    v_exp_f32 v88, v88
    s_nop 0
    v_add_f32 v88, 1.0, v88
    v_rcp_f32 v88, v88
    s_nop 0
    v_mul_f32 v51, v51, v88
    v_cvt_pk_bf16_f32 v86, v48, v49
    v_cvt_pk_bf16_f32 v87, v50, v51
    s_mov_b32 s26, 114688
    buffer_store_dwordx2 v[86:87], v1, s[16:19], s26 offen offset:48
    s_waitcnt vmcnt(0)
    buffer_load_dwordx2 v[84:85], v2, s[28:31], 0 offen offset:64
    v_cvt_pk_bf16_f32 v86, v52, v53
    v_cvt_pk_bf16_f32 v87, v54, v55
    s_waitcnt vmcnt(0)
    v_lshlrev_b32 v52, 16, v86
    v_lshlrev_b32 v88, 16, v84
    v_add_f32 v52, v52, v88
    v_and_b32 v53, 0xffff0000, v86
    v_and_b32 v88, 0xffff0000, v84
    v_add_f32 v53, v53, v88
    v_lshlrev_b32 v54, 16, v87
    v_lshlrev_b32 v88, 16, v85
    v_add_f32 v54, v54, v88
    v_and_b32 v55, 0xffff0000, v87
    v_and_b32 v88, 0xffff0000, v85
    v_add_f32 v55, v55, v88
    v_cvt_pk_bf16_f32 v86, v52, v53
    v_cvt_pk_bf16_f32 v87, v54, v55
    v_lshlrev_b32 v52, 16, v86
    v_mul_f32 v88, v52, v52
    v_mul_f32 v88, 0x3d372713, v88
    v_fma_f32 v88, v88, v52, v52
    v_mul_f32 v88, 0xc0135761, v88
    v_exp_f32 v88, v88
    s_nop 0
    v_add_f32 v88, 1.0, v88
    v_rcp_f32 v88, v88
    s_nop 0
    v_mul_f32 v52, v52, v88
    v_and_b32 v53, 0xffff0000, v86
    v_mul_f32 v88, v53, v53
    v_mul_f32 v88, 0x3d372713, v88
    v_fma_f32 v88, v88, v53, v53
    v_mul_f32 v88, 0xc0135761, v88
    v_exp_f32 v88, v88
    s_nop 0
    v_add_f32 v88, 1.0, v88
    v_rcp_f32 v88, v88
    s_nop 0
    v_mul_f32 v53, v53, v88
    v_lshlrev_b32 v54, 16, v87
    v_mul_f32 v88, v54, v54
    v_mul_f32 v88, 0x3d372713, v88
    v_fma_f32 v88, v88, v54, v54
    v_mul_f32 v88, 0xc0135761, v88
    v_exp_f32 v88, v88
    s_nop 0
    v_add_f32 v88, 1.0, v88
    v_rcp_f32 v88, v88
    s_nop 0
    v_mul_f32 v54, v54, v88
    v_and_b32 v55, 0xffff0000, v87
    v_mul_f32 v88, v55, v55
    v_mul_f32 v88, 0x3d372713, v88
    v_fma_f32 v88, v88, v55, v55
    v_mul_f32 v88, 0xc0135761, v88
    v_exp_f32 v88, v88
    s_nop 0
    v_add_f32 v88, 1.0, v88
    v_rcp_f32 v88, v88
    s_nop 0
    v_mul_f32 v55, v55, v88
    v_cvt_pk_bf16_f32 v86, v52, v53
    v_cvt_pk_bf16_f32 v87, v54, v55
    buffer_store_dwordx2 v[86:87], v1, s[16:19], 0 offen offset:64
    s_waitcnt vmcnt(0)
    buffer_load_dwordx2 v[84:85], v2, s[28:31], 0 offen offset:80
    v_cvt_pk_bf16_f32 v86, v56, v57
    v_cvt_pk_bf16_f32 v87, v58, v59
    s_waitcnt vmcnt(0)
    v_lshlrev_b32 v56, 16, v86
    v_lshlrev_b32 v88, 16, v84
    v_add_f32 v56, v56, v88
    v_and_b32 v57, 0xffff0000, v86
    v_and_b32 v88, 0xffff0000, v84
    v_add_f32 v57, v57, v88
    v_lshlrev_b32 v58, 16, v87
    v_lshlrev_b32 v88, 16, v85
    v_add_f32 v58, v58, v88
    v_and_b32 v59, 0xffff0000, v87
    v_and_b32 v88, 0xffff0000, v85
    v_add_f32 v59, v59, v88
    v_cvt_pk_bf16_f32 v86, v56, v57
    v_cvt_pk_bf16_f32 v87, v58, v59
    v_lshlrev_b32 v56, 16, v86
    v_mul_f32 v88, v56, v56
    v_mul_f32 v88, 0x3d372713, v88
    v_fma_f32 v88, v88, v56, v56
    v_mul_f32 v88, 0xc0135761, v88
    v_exp_f32 v88, v88
    s_nop 0
    v_add_f32 v88, 1.0, v88
    v_rcp_f32 v88, v88
    s_nop 0
    v_mul_f32 v56, v56, v88
    v_and_b32 v57, 0xffff0000, v86
    v_mul_f32 v88, v57, v57
    v_mul_f32 v88, 0x3d372713, v88
    v_fma_f32 v88, v88, v57, v57
    v_mul_f32 v88, 0xc0135761, v88
    v_exp_f32 v88, v88
    s_nop 0
    v_add_f32 v88, 1.0, v88
    v_rcp_f32 v88, v88
    s_nop 0
    v_mul_f32 v57, v57, v88
    v_lshlrev_b32 v58, 16, v87
    v_mul_f32 v88, v58, v58
    v_mul_f32 v88, 0x3d372713, v88
    v_fma_f32 v88, v88, v58, v58
    v_mul_f32 v88, 0xc0135761, v88
    v_exp_f32 v88, v88
    s_nop 0
    v_add_f32 v88, 1.0, v88
    v_rcp_f32 v88, v88
    s_nop 0
    v_mul_f32 v58, v58, v88
    v_and_b32 v59, 0xffff0000, v87
    v_mul_f32 v88, v59, v59
    v_mul_f32 v88, 0x3d372713, v88
    v_fma_f32 v88, v88, v59, v59
    v_mul_f32 v88, 0xc0135761, v88
    v_exp_f32 v88, v88
    s_nop 0
    v_add_f32 v88, 1.0, v88
    v_rcp_f32 v88, v88
    s_nop 0
    v_mul_f32 v59, v59, v88
    v_cvt_pk_bf16_f32 v86, v56, v57
    v_cvt_pk_bf16_f32 v87, v58, v59
    buffer_store_dwordx2 v[86:87], v1, s[16:19], 0 offen offset:80
    s_waitcnt vmcnt(0)
    buffer_load_dwordx2 v[84:85], v2, s[28:31], 0 offen offset:96
    v_cvt_pk_bf16_f32 v86, v60, v61
    v_cvt_pk_bf16_f32 v87, v62, v63
    s_waitcnt vmcnt(0)
    v_lshlrev_b32 v60, 16, v86
    v_lshlrev_b32 v88, 16, v84
    v_add_f32 v60, v60, v88
    v_and_b32 v61, 0xffff0000, v86
    v_and_b32 v88, 0xffff0000, v84
    v_add_f32 v61, v61, v88
    v_lshlrev_b32 v62, 16, v87
    v_lshlrev_b32 v88, 16, v85
    v_add_f32 v62, v62, v88
    v_and_b32 v63, 0xffff0000, v87
    v_and_b32 v88, 0xffff0000, v85
    v_add_f32 v63, v63, v88
    v_cvt_pk_bf16_f32 v86, v60, v61
    v_cvt_pk_bf16_f32 v87, v62, v63
    v_lshlrev_b32 v60, 16, v86
    v_mul_f32 v88, v60, v60
    v_mul_f32 v88, 0x3d372713, v88
    v_fma_f32 v88, v88, v60, v60
    v_mul_f32 v88, 0xc0135761, v88
    v_exp_f32 v88, v88
    s_nop 0
    v_add_f32 v88, 1.0, v88
    v_rcp_f32 v88, v88
    s_nop 0
    v_mul_f32 v60, v60, v88
    v_and_b32 v61, 0xffff0000, v86
    v_mul_f32 v88, v61, v61
    v_mul_f32 v88, 0x3d372713, v88
    v_fma_f32 v88, v88, v61, v61
    v_mul_f32 v88, 0xc0135761, v88
    v_exp_f32 v88, v88
    s_nop 0
    v_add_f32 v88, 1.0, v88
    v_rcp_f32 v88, v88
    s_nop 0
    v_mul_f32 v61, v61, v88
    v_lshlrev_b32 v62, 16, v87
    v_mul_f32 v88, v62, v62
    v_mul_f32 v88, 0x3d372713, v88
    v_fma_f32 v88, v88, v62, v62
    v_mul_f32 v88, 0xc0135761, v88
    v_exp_f32 v88, v88
    s_nop 0
    v_add_f32 v88, 1.0, v88
    v_rcp_f32 v88, v88
    s_nop 0
    v_mul_f32 v62, v62, v88
    v_and_b32 v63, 0xffff0000, v87
    v_mul_f32 v88, v63, v63
    v_mul_f32 v88, 0x3d372713, v88
    v_fma_f32 v88, v88, v63, v63
    v_mul_f32 v88, 0xc0135761, v88
    v_exp_f32 v88, v88
    s_nop 0
    v_add_f32 v88, 1.0, v88
    v_rcp_f32 v88, v88
    s_nop 0
    v_mul_f32 v63, v63, v88
    v_cvt_pk_bf16_f32 v86, v60, v61
    v_cvt_pk_bf16_f32 v87, v62, v63
    buffer_store_dwordx2 v[86:87], v1, s[16:19], 0 offen offset:96
    s_waitcnt vmcnt(0)
    buffer_load_dwordx2 v[84:85], v2, s[28:31], 0 offen offset:112
    v_cvt_pk_bf16_f32 v86, v64, v65
    v_cvt_pk_bf16_f32 v87, v66, v67
    s_waitcnt vmcnt(0)
    v_lshlrev_b32 v64, 16, v86
    v_lshlrev_b32 v88, 16, v84
    v_add_f32 v64, v64, v88
    v_and_b32 v65, 0xffff0000, v86
    v_and_b32 v88, 0xffff0000, v84
    v_add_f32 v65, v65, v88
    v_lshlrev_b32 v66, 16, v87
    v_lshlrev_b32 v88, 16, v85
    v_add_f32 v66, v66, v88
    v_and_b32 v67, 0xffff0000, v87
    v_and_b32 v88, 0xffff0000, v85
    v_add_f32 v67, v67, v88
    v_cvt_pk_bf16_f32 v86, v64, v65
    v_cvt_pk_bf16_f32 v87, v66, v67
    v_lshlrev_b32 v64, 16, v86
    v_mul_f32 v88, v64, v64
    v_mul_f32 v88, 0x3d372713, v88
    v_fma_f32 v88, v88, v64, v64
    v_mul_f32 v88, 0xc0135761, v88
    v_exp_f32 v88, v88
    s_nop 0
    v_add_f32 v88, 1.0, v88
    v_rcp_f32 v88, v88
    s_nop 0
    v_mul_f32 v64, v64, v88
    v_and_b32 v65, 0xffff0000, v86
    v_mul_f32 v88, v65, v65
    v_mul_f32 v88, 0x3d372713, v88
    v_fma_f32 v88, v88, v65, v65
    v_mul_f32 v88, 0xc0135761, v88
    v_exp_f32 v88, v88
    s_nop 0
    v_add_f32 v88, 1.0, v88
    v_rcp_f32 v88, v88
    s_nop 0
    v_mul_f32 v65, v65, v88
    v_lshlrev_b32 v66, 16, v87
    v_mul_f32 v88, v66, v66
    v_mul_f32 v88, 0x3d372713, v88
    v_fma_f32 v88, v88, v66, v66
    v_mul_f32 v88, 0xc0135761, v88
    v_exp_f32 v88, v88
    s_nop 0
    v_add_f32 v88, 1.0, v88
    v_rcp_f32 v88, v88
    s_nop 0
    v_mul_f32 v66, v66, v88
    v_and_b32 v67, 0xffff0000, v87
    v_mul_f32 v88, v67, v67
    v_mul_f32 v88, 0x3d372713, v88
    v_fma_f32 v88, v88, v67, v67
    v_mul_f32 v88, 0xc0135761, v88
    v_exp_f32 v88, v88
    s_nop 0
    v_add_f32 v88, 1.0, v88
    v_rcp_f32 v88, v88
    s_nop 0
    v_mul_f32 v67, v67, v88
    v_cvt_pk_bf16_f32 v86, v64, v65
    v_cvt_pk_bf16_f32 v87, v66, v67
    buffer_store_dwordx2 v[86:87], v1, s[16:19], 0 offen offset:112
    s_waitcnt vmcnt(0)
    buffer_load_dwordx2 v[84:85], v2, s[28:31], 0 offen offset:64
    v_cvt_pk_bf16_f32 v86, v68, v69
    v_cvt_pk_bf16_f32 v87, v70, v71
    s_waitcnt vmcnt(0)
    v_lshlrev_b32 v68, 16, v86
    v_lshlrev_b32 v88, 16, v84
    v_add_f32 v68, v68, v88
    v_and_b32 v69, 0xffff0000, v86
    v_and_b32 v88, 0xffff0000, v84
    v_add_f32 v69, v69, v88
    v_lshlrev_b32 v70, 16, v87
    v_lshlrev_b32 v88, 16, v85
    v_add_f32 v70, v70, v88
    v_and_b32 v71, 0xffff0000, v87
    v_and_b32 v88, 0xffff0000, v85
    v_add_f32 v71, v71, v88
    v_cvt_pk_bf16_f32 v86, v68, v69
    v_cvt_pk_bf16_f32 v87, v70, v71
    v_lshlrev_b32 v68, 16, v86
    v_mul_f32 v88, v68, v68
    v_mul_f32 v88, 0x3d372713, v88
    v_fma_f32 v88, v88, v68, v68
    v_mul_f32 v88, 0xc0135761, v88
    v_exp_f32 v88, v88
    s_nop 0
    v_add_f32 v88, 1.0, v88
    v_rcp_f32 v88, v88
    s_nop 0
    v_mul_f32 v68, v68, v88
    v_and_b32 v69, 0xffff0000, v86
    v_mul_f32 v88, v69, v69
    v_mul_f32 v88, 0x3d372713, v88
    v_fma_f32 v88, v88, v69, v69
    v_mul_f32 v88, 0xc0135761, v88
    v_exp_f32 v88, v88
    s_nop 0
    v_add_f32 v88, 1.0, v88
    v_rcp_f32 v88, v88
    s_nop 0
    v_mul_f32 v69, v69, v88
    v_lshlrev_b32 v70, 16, v87
    v_mul_f32 v88, v70, v70
    v_mul_f32 v88, 0x3d372713, v88
    v_fma_f32 v88, v88, v70, v70
    v_mul_f32 v88, 0xc0135761, v88
    v_exp_f32 v88, v88
    s_nop 0
    v_add_f32 v88, 1.0, v88
    v_rcp_f32 v88, v88
    s_nop 0
    v_mul_f32 v70, v70, v88
    v_and_b32 v71, 0xffff0000, v87
    v_mul_f32 v88, v71, v71
    v_mul_f32 v88, 0x3d372713, v88
    v_fma_f32 v88, v88, v71, v71
    v_mul_f32 v88, 0xc0135761, v88
    v_exp_f32 v88, v88
    s_nop 0
    v_add_f32 v88, 1.0, v88
    v_rcp_f32 v88, v88
    s_nop 0
    v_mul_f32 v71, v71, v88
    v_cvt_pk_bf16_f32 v86, v68, v69
    v_cvt_pk_bf16_f32 v87, v70, v71
    s_mov_b32 s26, 114688
    buffer_store_dwordx2 v[86:87], v1, s[16:19], s26 offen offset:64
    s_waitcnt vmcnt(0)
    buffer_load_dwordx2 v[84:85], v2, s[28:31], 0 offen offset:80
    v_cvt_pk_bf16_f32 v86, v72, v73
    v_cvt_pk_bf16_f32 v87, v74, v75
    s_waitcnt vmcnt(0)
    v_lshlrev_b32 v72, 16, v86
    v_lshlrev_b32 v88, 16, v84
    v_add_f32 v72, v72, v88
    v_and_b32 v73, 0xffff0000, v86
    v_and_b32 v88, 0xffff0000, v84
    v_add_f32 v73, v73, v88
    v_lshlrev_b32 v74, 16, v87
    v_lshlrev_b32 v88, 16, v85
    v_add_f32 v74, v74, v88
    v_and_b32 v75, 0xffff0000, v87
    v_and_b32 v88, 0xffff0000, v85
    v_add_f32 v75, v75, v88
    v_cvt_pk_bf16_f32 v86, v72, v73
    v_cvt_pk_bf16_f32 v87, v74, v75
    v_lshlrev_b32 v72, 16, v86
    v_mul_f32 v88, v72, v72
    v_mul_f32 v88, 0x3d372713, v88
    v_fma_f32 v88, v88, v72, v72
    v_mul_f32 v88, 0xc0135761, v88
    v_exp_f32 v88, v88
    s_nop 0
    v_add_f32 v88, 1.0, v88
    v_rcp_f32 v88, v88
    s_nop 0
    v_mul_f32 v72, v72, v88
    v_and_b32 v73, 0xffff0000, v86
    v_mul_f32 v88, v73, v73
    v_mul_f32 v88, 0x3d372713, v88
    v_fma_f32 v88, v88, v73, v73
    v_mul_f32 v88, 0xc0135761, v88
    v_exp_f32 v88, v88
    s_nop 0
    v_add_f32 v88, 1.0, v88
    v_rcp_f32 v88, v88
    s_nop 0
    v_mul_f32 v73, v73, v88
    v_lshlrev_b32 v74, 16, v87
    v_mul_f32 v88, v74, v74
    v_mul_f32 v88, 0x3d372713, v88
    v_fma_f32 v88, v88, v74, v74
    v_mul_f32 v88, 0xc0135761, v88
    v_exp_f32 v88, v88
    s_nop 0
    v_add_f32 v88, 1.0, v88
    v_rcp_f32 v88, v88
    s_nop 0
    v_mul_f32 v74, v74, v88
    v_and_b32 v75, 0xffff0000, v87
    v_mul_f32 v88, v75, v75
    v_mul_f32 v88, 0x3d372713, v88
    v_fma_f32 v88, v88, v75, v75
    v_mul_f32 v88, 0xc0135761, v88
    v_exp_f32 v88, v88
    s_nop 0
    v_add_f32 v88, 1.0, v88
    v_rcp_f32 v88, v88
    s_nop 0
    v_mul_f32 v75, v75, v88
    v_cvt_pk_bf16_f32 v86, v72, v73
    v_cvt_pk_bf16_f32 v87, v74, v75
    s_mov_b32 s26, 114688
    buffer_store_dwordx2 v[86:87], v1, s[16:19], s26 offen offset:80
    s_waitcnt vmcnt(0)
    buffer_load_dwordx2 v[84:85], v2, s[28:31], 0 offen offset:96
    v_cvt_pk_bf16_f32 v86, v76, v77
    v_cvt_pk_bf16_f32 v87, v78, v79
    s_waitcnt vmcnt(0)
    v_lshlrev_b32 v76, 16, v86
    v_lshlrev_b32 v88, 16, v84
    v_add_f32 v76, v76, v88
    v_and_b32 v77, 0xffff0000, v86
    v_and_b32 v88, 0xffff0000, v84
    v_add_f32 v77, v77, v88
    v_lshlrev_b32 v78, 16, v87
    v_lshlrev_b32 v88, 16, v85
    v_add_f32 v78, v78, v88
    v_and_b32 v79, 0xffff0000, v87
    v_and_b32 v88, 0xffff0000, v85
    v_add_f32 v79, v79, v88
    v_cvt_pk_bf16_f32 v86, v76, v77
    v_cvt_pk_bf16_f32 v87, v78, v79
    v_lshlrev_b32 v76, 16, v86
    v_mul_f32 v88, v76, v76
    v_mul_f32 v88, 0x3d372713, v88
    v_fma_f32 v88, v88, v76, v76
    v_mul_f32 v88, 0xc0135761, v88
    v_exp_f32 v88, v88
    s_nop 0
    v_add_f32 v88, 1.0, v88
    v_rcp_f32 v88, v88
    s_nop 0
    v_mul_f32 v76, v76, v88
    v_and_b32 v77, 0xffff0000, v86
    v_mul_f32 v88, v77, v77
    v_mul_f32 v88, 0x3d372713, v88
    v_fma_f32 v88, v88, v77, v77
    v_mul_f32 v88, 0xc0135761, v88
    v_exp_f32 v88, v88
    s_nop 0
    v_add_f32 v88, 1.0, v88
    v_rcp_f32 v88, v88
    s_nop 0
    v_mul_f32 v77, v77, v88
    v_lshlrev_b32 v78, 16, v87
    v_mul_f32 v88, v78, v78
    v_mul_f32 v88, 0x3d372713, v88
    v_fma_f32 v88, v88, v78, v78
    v_mul_f32 v88, 0xc0135761, v88
    v_exp_f32 v88, v88
    s_nop 0
    v_add_f32 v88, 1.0, v88
    v_rcp_f32 v88, v88
    s_nop 0
    v_mul_f32 v78, v78, v88
    v_and_b32 v79, 0xffff0000, v87
    v_mul_f32 v88, v79, v79
    v_mul_f32 v88, 0x3d372713, v88
    v_fma_f32 v88, v88, v79, v79
    v_mul_f32 v88, 0xc0135761, v88
    v_exp_f32 v88, v88
    s_nop 0
    v_add_f32 v88, 1.0, v88
    v_rcp_f32 v88, v88
    s_nop 0
    v_mul_f32 v79, v79, v88
    v_cvt_pk_bf16_f32 v86, v76, v77
    v_cvt_pk_bf16_f32 v87, v78, v79
    s_mov_b32 s26, 114688
    buffer_store_dwordx2 v[86:87], v1, s[16:19], s26 offen offset:96
    s_waitcnt vmcnt(0)
    buffer_load_dwordx2 v[84:85], v2, s[28:31], 0 offen offset:112
    v_cvt_pk_bf16_f32 v86, v80, v81
    v_cvt_pk_bf16_f32 v87, v82, v83
    s_waitcnt vmcnt(0)
    v_lshlrev_b32 v80, 16, v86
    v_lshlrev_b32 v88, 16, v84
    v_add_f32 v80, v80, v88
    v_and_b32 v81, 0xffff0000, v86
    v_and_b32 v88, 0xffff0000, v84
    v_add_f32 v81, v81, v88
    v_lshlrev_b32 v82, 16, v87
    v_lshlrev_b32 v88, 16, v85
    v_add_f32 v82, v82, v88
    v_and_b32 v83, 0xffff0000, v87
    v_and_b32 v88, 0xffff0000, v85
    v_add_f32 v83, v83, v88
    v_cvt_pk_bf16_f32 v86, v80, v81
    v_cvt_pk_bf16_f32 v87, v82, v83
    v_lshlrev_b32 v80, 16, v86
    v_mul_f32 v88, v80, v80
    v_mul_f32 v88, 0x3d372713, v88
    v_fma_f32 v88, v88, v80, v80
    v_mul_f32 v88, 0xc0135761, v88
    v_exp_f32 v88, v88
    s_nop 0
    v_add_f32 v88, 1.0, v88
    v_rcp_f32 v88, v88
    s_nop 0
    v_mul_f32 v80, v80, v88
    v_and_b32 v81, 0xffff0000, v86
    v_mul_f32 v88, v81, v81
    v_mul_f32 v88, 0x3d372713, v88
    v_fma_f32 v88, v88, v81, v81
    v_mul_f32 v88, 0xc0135761, v88
    v_exp_f32 v88, v88
    s_nop 0
    v_add_f32 v88, 1.0, v88
    v_rcp_f32 v88, v88
    s_nop 0
    v_mul_f32 v81, v81, v88
    v_lshlrev_b32 v82, 16, v87
    v_mul_f32 v88, v82, v82
    v_mul_f32 v88, 0x3d372713, v88
    v_fma_f32 v88, v88, v82, v82
    v_mul_f32 v88, 0xc0135761, v88
    v_exp_f32 v88, v88
    s_nop 0
    v_add_f32 v88, 1.0, v88
    v_rcp_f32 v88, v88
    s_nop 0
    v_mul_f32 v82, v82, v88
    v_and_b32 v83, 0xffff0000, v87
    v_mul_f32 v88, v83, v83
    v_mul_f32 v88, 0x3d372713, v88
    v_fma_f32 v88, v88, v83, v83
    v_mul_f32 v88, 0xc0135761, v88
    v_exp_f32 v88, v88
    s_nop 0
    v_add_f32 v88, 1.0, v88
    v_rcp_f32 v88, v88
    s_nop 0
    v_mul_f32 v83, v83, v88
    v_cvt_pk_bf16_f32 v86, v80, v81
    v_cvt_pk_bf16_f32 v87, v82, v83
    s_mov_b32 s26, 114688
    buffer_store_dwordx2 v[86:87], v1, s[16:19], s26 offen offset:112
    s_waitcnt vmcnt(0)
y_f1_done:
    s_endpgm
y_at:
    s_sub_u32 s2, s2, 224
    s_cmp_ge_u32 s2, 784
    s_cbranch_scc1 y_wv
    s_mul_hi_u32 s20, s2, 0x539782a
    s_mul_i32 s24, s20, 49
    s_sub_u32 s23, s2, s24
    s_mul_hi_u32 s22, s23, 0x24924925
    s_mul_i32 s24, s22, 7
    s_sub_u32 s21, s23, s24
    s_load_dwordx2 s[8:9], s[0:1], 16
    s_waitcnt lgkmcnt(0)
    s_and_b32 s9, s9, 0xffff
    s_mov_b32 s10, 0x380000
    s_mov_b32 s11, 0x00020000
    s_load_dwordx2 s[12:13], s[0:1], 24
    s_waitcnt lgkmcnt(0)
    s_and_b32 s13, s13, 0xffff
    s_mov_b32 s14, 0x380000
    s_mov_b32 s15, 0x00020000
    s_load_dwordx2 s[16:17], s[0:1], 112
    s_waitcnt lgkmcnt(0)
    s_add_u32 s16, s16, 0x200000
    s_addc_u32 s17, s17, 0
    s_and_b32 s17, s17, 0xffff
    s_mov_b32 s18, 0xfe00000
    s_mov_b32 s19, 0x00020000
    v_lshrrev_b32 v4, 3, v0
    v_and_b32 v5, 7, v0
    v_lshlrev_b32 v5, 4, v5
    s_mul_i32 s24, s21, 524288
    s_mul_i32 s25, s20, 512
    s_add_u32 s24, s24, s25
    s_mov_b32 s26, 8192
    v_mul_lo_u32 v1, v4, s26
    v_add_u32 v1, v1, v5
    v_add_u32 v1, s24, v1
    s_mul_i32 s24, s22, 524288
    s_mul_i32 s25, s20, 512
    s_add_u32 s24, s24, s25
    s_mov_b32 s26, 8192
    v_mul_lo_u32 v2, v4, s26
    v_add_u32 v2, v2, v5
    v_add_u32 v2, s24, v2
    v_mul_u32_u24 v3, 144, v4
    v_add_u32 v3, v3, v5
    v_lshrrev_b32 v6, 6, v0
    v_and_b32 v7, 1, v6
    v_lshrrev_b32 v6, 1, v6
    v_and_b32 v8, 31, v0
    v_bfe_u32 v9, v0, 5, 1
    v_lshlrev_b32 v10, 4, v9
    v_mul_u32_u24 v11, 32, v7
    v_add_u32 v11, v11, v8
    v_mul_u32_u24 v11, 144, v11
    v_add_u32 v11, v11, v10
    v_mul_u32_u24 v12, 32, v6
    v_add_u32 v12, v12, v8
    v_mul_u32_u24 v12, 144, v12
    v_add_u32 v12, v12, v10
    v_add_u32 v12, 9216, v12
    v_add_u32 v15, 18432, v3
    v_add_u32 v16, 18432, v11
    v_add_u32 v17, 18432, v12
    v_mov_b32 v20, 0
    v_mov_b32 v21, 0
    v_mov_b32 v22, 0
    v_mov_b32 v23, 0
    v_mov_b32 v24, 0
    v_mov_b32 v25, 0
    v_mov_b32 v26, 0
    v_mov_b32 v27, 0
    v_mov_b32 v28, 0
    v_mov_b32 v29, 0
    v_mov_b32 v30, 0
    v_mov_b32 v31, 0
    v_mov_b32 v32, 0
    v_mov_b32 v33, 0
    v_mov_b32 v34, 0
    v_mov_b32 v35, 0
    s_mov_b32 s27, 0
    buffer_load_dwordx4 v[44:47], v1, s[8:11], s27 offen
    v_add_u32 v13, 262144, v1
    buffer_load_dwordx4 v[48:51], v13, s[8:11], s27 offen
    buffer_load_dwordx4 v[52:55], v2, s[12:15], s27 offen
    v_add_u32 v14, 262144, v2
    buffer_load_dwordx4 v[56:59], v14, s[12:15], s27 offen
    s_waitcnt vmcnt(0)
    ds_write_b128 v3, v[44:47] offset:0
    ds_write_b128 v3, v[48:51] offset:4608
    ds_write_b128 v3, v[52:55] offset:9216
    ds_write_b128 v3, v[56:59] offset:13824
    s_waitcnt lgkmcnt(0)
    s_barrier
    s_mov_b32 s27, 128
    buffer_load_dwordx4 v[44:47], v1, s[8:11], s27 offen
    v_add_u32 v13, 262144, v1
    buffer_load_dwordx4 v[48:51], v13, s[8:11], s27 offen
    buffer_load_dwordx4 v[52:55], v2, s[12:15], s27 offen
    v_add_u32 v14, 262144, v2
    buffer_load_dwordx4 v[56:59], v14, s[12:15], s27 offen
    ds_read_b128 v[36:39], v11 offset:0
    ds_read_b128 v[40:43], v12 offset:0
    s_waitcnt lgkmcnt(0)
    v_mfma_f32_32x32x16_bf16 v[20:35], v[36:39], v[40:43], v[20:35]
    ds_read_b128 v[36:39], v11 offset:32
    ds_read_b128 v[40:43], v12 offset:32
    s_waitcnt lgkmcnt(0)
    v_mfma_f32_32x32x16_bf16 v[20:35], v[36:39], v[40:43], v[20:35]
    ds_read_b128 v[36:39], v11 offset:64
    ds_read_b128 v[40:43], v12 offset:64
    s_waitcnt lgkmcnt(0)
    v_mfma_f32_32x32x16_bf16 v[20:35], v[36:39], v[40:43], v[20:35]
    ds_read_b128 v[36:39], v11 offset:96
    ds_read_b128 v[40:43], v12 offset:96
    s_waitcnt lgkmcnt(0)
    v_mfma_f32_32x32x16_bf16 v[20:35], v[36:39], v[40:43], v[20:35]
    s_waitcnt vmcnt(0)
    ds_write_b128 v15, v[44:47] offset:0
    ds_write_b128 v15, v[48:51] offset:4608
    ds_write_b128 v15, v[52:55] offset:9216
    ds_write_b128 v15, v[56:59] offset:13824
    s_waitcnt lgkmcnt(0)
    s_barrier
    s_mov_b32 s27, 256
    buffer_load_dwordx4 v[44:47], v1, s[8:11], s27 offen
    v_add_u32 v13, 262144, v1
    buffer_load_dwordx4 v[48:51], v13, s[8:11], s27 offen
    buffer_load_dwordx4 v[52:55], v2, s[12:15], s27 offen
    v_add_u32 v14, 262144, v2
    buffer_load_dwordx4 v[56:59], v14, s[12:15], s27 offen
    ds_read_b128 v[36:39], v16 offset:0
    ds_read_b128 v[40:43], v17 offset:0
    s_waitcnt lgkmcnt(0)
    v_mfma_f32_32x32x16_bf16 v[20:35], v[36:39], v[40:43], v[20:35]
    ds_read_b128 v[36:39], v16 offset:32
    ds_read_b128 v[40:43], v17 offset:32
    s_waitcnt lgkmcnt(0)
    v_mfma_f32_32x32x16_bf16 v[20:35], v[36:39], v[40:43], v[20:35]
    ds_read_b128 v[36:39], v16 offset:64
    ds_read_b128 v[40:43], v17 offset:64
    s_waitcnt lgkmcnt(0)
    v_mfma_f32_32x32x16_bf16 v[20:35], v[36:39], v[40:43], v[20:35]
    ds_read_b128 v[36:39], v16 offset:96
    ds_read_b128 v[40:43], v17 offset:96
    s_waitcnt lgkmcnt(0)
    v_mfma_f32_32x32x16_bf16 v[20:35], v[36:39], v[40:43], v[20:35]
    s_waitcnt vmcnt(0)
    ds_write_b128 v3, v[44:47] offset:0
    ds_write_b128 v3, v[48:51] offset:4608
    ds_write_b128 v3, v[52:55] offset:9216
    ds_write_b128 v3, v[56:59] offset:13824
    s_waitcnt lgkmcnt(0)
    s_barrier
    s_mov_b32 s27, 384
    buffer_load_dwordx4 v[44:47], v1, s[8:11], s27 offen
    v_add_u32 v13, 262144, v1
    buffer_load_dwordx4 v[48:51], v13, s[8:11], s27 offen
    buffer_load_dwordx4 v[52:55], v2, s[12:15], s27 offen
    v_add_u32 v14, 262144, v2
    buffer_load_dwordx4 v[56:59], v14, s[12:15], s27 offen
    ds_read_b128 v[36:39], v11 offset:0
    ds_read_b128 v[40:43], v12 offset:0
    s_waitcnt lgkmcnt(0)
    v_mfma_f32_32x32x16_bf16 v[20:35], v[36:39], v[40:43], v[20:35]
    ds_read_b128 v[36:39], v11 offset:32
    ds_read_b128 v[40:43], v12 offset:32
    s_waitcnt lgkmcnt(0)
    v_mfma_f32_32x32x16_bf16 v[20:35], v[36:39], v[40:43], v[20:35]
    ds_read_b128 v[36:39], v11 offset:64
    ds_read_b128 v[40:43], v12 offset:64
    s_waitcnt lgkmcnt(0)
    v_mfma_f32_32x32x16_bf16 v[20:35], v[36:39], v[40:43], v[20:35]
    ds_read_b128 v[36:39], v11 offset:96
    ds_read_b128 v[40:43], v12 offset:96
    s_waitcnt lgkmcnt(0)
    v_mfma_f32_32x32x16_bf16 v[20:35], v[36:39], v[40:43], v[20:35]
    s_waitcnt vmcnt(0)
    ds_write_b128 v15, v[44:47] offset:0
    ds_write_b128 v15, v[48:51] offset:4608
    ds_write_b128 v15, v[52:55] offset:9216
    ds_write_b128 v15, v[56:59] offset:13824
    s_waitcnt lgkmcnt(0)
    s_barrier
    ds_read_b128 v[36:39], v16 offset:0
    ds_read_b128 v[40:43], v17 offset:0
    s_waitcnt lgkmcnt(0)
    v_mfma_f32_32x32x16_bf16 v[20:35], v[36:39], v[40:43], v[20:35]
    ds_read_b128 v[36:39], v16 offset:32
    ds_read_b128 v[40:43], v17 offset:32
    s_waitcnt lgkmcnt(0)
    v_mfma_f32_32x32x16_bf16 v[20:35], v[36:39], v[40:43], v[20:35]
    ds_read_b128 v[36:39], v16 offset:64
    ds_read_b128 v[40:43], v17 offset:64
    s_waitcnt lgkmcnt(0)
    v_mfma_f32_32x32x16_bf16 v[20:35], v[36:39], v[40:43], v[20:35]
    ds_read_b128 v[36:39], v16 offset:96
    ds_read_b128 v[40:43], v17 offset:96
    s_waitcnt lgkmcnt(0)
    v_mfma_f32_32x32x16_bf16 v[20:35], v[36:39], v[40:43], v[20:35]
    s_nop 15
    s_nop 7
    s_mul_i32 s24, s22, 64
    v_mul_u32_u24 v1, 32, v6
    v_add_u32 v1, v1, v8
    v_add_u32 v1, s24, v1
    s_mov_b32 s26, 896
    v_mul_lo_u32 v1, v1, s26
    s_mul_i32 s24, s21, 64
    v_mul_u32_u24 v2, 32, v7
    v_lshl_add_u32 v2, v9, 2, v2
    v_add_u32 v2, s24, v2
    v_lshlrev_b32 v2, 1, v2
    s_mul_i32 s25, s20, 401408
    v_add_u32 v1, v1, v2
    v_add_u32 v1, s25, v1
    v_mul_f32 v20, 0x3d800000, v20
    v_mul_f32 v21, 0x3d800000, v21
    v_mul_f32 v22, 0x3d800000, v22
    v_mul_f32 v23, 0x3d800000, v23
    v_cvt_pk_bf16_f32 v38, v20, v21
    v_cvt_pk_bf16_f32 v39, v22, v23
    buffer_store_dwordx2 v[38:39], v1, s[16:19], 0 offen offset:0
    s_waitcnt vmcnt(0)
    v_mul_f32 v24, 0x3d800000, v24
    v_mul_f32 v25, 0x3d800000, v25
    v_mul_f32 v26, 0x3d800000, v26
    v_mul_f32 v27, 0x3d800000, v27
    v_cvt_pk_bf16_f32 v38, v24, v25
    v_cvt_pk_bf16_f32 v39, v26, v27
    buffer_store_dwordx2 v[38:39], v1, s[16:19], 0 offen offset:16
    s_waitcnt vmcnt(0)
    v_mul_f32 v28, 0x3d800000, v28
    v_mul_f32 v29, 0x3d800000, v29
    v_mul_f32 v30, 0x3d800000, v30
    v_mul_f32 v31, 0x3d800000, v31
    v_cvt_pk_bf16_f32 v38, v28, v29
    v_cvt_pk_bf16_f32 v39, v30, v31
    buffer_store_dwordx2 v[38:39], v1, s[16:19], 0 offen offset:32
    s_waitcnt vmcnt(0)
    v_mul_f32 v32, 0x3d800000, v32
    v_mul_f32 v33, 0x3d800000, v33
    v_mul_f32 v34, 0x3d800000, v34
    v_mul_f32 v35, 0x3d800000, v35
    v_cvt_pk_bf16_f32 v38, v32, v33
    v_cvt_pk_bf16_f32 v39, v34, v35
    buffer_store_dwordx2 v[38:39], v1, s[16:19], 0 offen offset:48
    s_waitcnt vmcnt(0)
y_at_done:
    s_endpgm
y_wv:
    s_sub_u32 s2, s2, 784
    s_cmp_ge_u32 s2, 784
    s_cbranch_scc1 y_end
    s_mul_hi_u32 s20, s2, 0x539782a
    s_mul_i32 s24, s20, 49
    s_sub_u32 s23, s2, s24
    s_mul_hi_u32 s22, s23, 0x24924925
    s_mul_i32 s24, s22, 7
    s_sub_u32 s21, s23, s24
    s_load_dwordx2 s[8:9], s[0:1], 32
    s_waitcnt lgkmcnt(0)
    s_and_b32 s9, s9, 0xffff
    s_mov_b32 s10, 0x380000
    s_mov_b32 s11, 0x00020000
    s_load_dwordx2 s[12:13], s[0:1], 112
    s_waitcnt lgkmcnt(0)
    s_add_u32 s12, s12, 0x1000000
    s_addc_u32 s13, s13, 0
    s_and_b32 s13, s13, 0xffff
    s_mov_b32 s14, 0xf000000
    s_mov_b32 s15, 0x00020000
    s_load_dwordx2 s[16:17], s[0:1], 112
    s_waitcnt lgkmcnt(0)
    s_add_u32 s16, s16, 0x900000
    s_addc_u32 s17, s17, 0
    s_and_b32 s17, s17, 0xffff
    s_mov_b32 s18, 0xf700000
    s_mov_b32 s19, 0x00020000
    v_lshrrev_b32 v4, 3, v0
    v_and_b32 v5, 7, v0
    v_lshlrev_b32 v5, 4, v5
    s_mul_i32 s24, s21, 524288
    s_mul_i32 s25, s20, 512
    s_add_u32 s24, s24, s25
    s_mov_b32 s26, 8192
    v_mul_lo_u32 v1, v4, s26
    v_add_u32 v1, v1, v5
    v_add_u32 v1, s24, v1
    s_mul_i32 s24, s22, 32768
    s_mul_i32 s25, s20, 229376
    s_add_u32 s24, s24, s25
    s_mov_b32 s26, 512
    v_mul_lo_u32 v2, v4, s26
    v_add_u32 v2, v2, v5
    v_add_u32 v2, s24, v2
    v_mul_u32_u24 v3, 144, v4
    v_add_u32 v3, v3, v5
    v_lshrrev_b32 v6, 6, v0
    v_and_b32 v7, 1, v6
    v_lshrrev_b32 v6, 1, v6
    v_and_b32 v8, 31, v0
    v_bfe_u32 v9, v0, 5, 1
    v_lshlrev_b32 v10, 4, v9
    v_mul_u32_u24 v11, 32, v7
    v_add_u32 v11, v11, v8
    v_mul_u32_u24 v11, 144, v11
    v_add_u32 v11, v11, v10
    v_mul_u32_u24 v12, 32, v6
    v_add_u32 v12, v12, v8
    v_mul_u32_u24 v12, 144, v12
    v_add_u32 v12, v12, v10
    v_add_u32 v12, 9216, v12
    v_add_u32 v15, 18432, v3
    v_add_u32 v16, 18432, v11
    v_add_u32 v17, 18432, v12
    v_mov_b32 v20, 0
    v_mov_b32 v21, 0
    v_mov_b32 v22, 0
    v_mov_b32 v23, 0
    v_mov_b32 v24, 0
    v_mov_b32 v25, 0
    v_mov_b32 v26, 0
    v_mov_b32 v27, 0
    v_mov_b32 v28, 0
    v_mov_b32 v29, 0
    v_mov_b32 v30, 0
    v_mov_b32 v31, 0
    v_mov_b32 v32, 0
    v_mov_b32 v33, 0
    v_mov_b32 v34, 0
    v_mov_b32 v35, 0
    s_mov_b32 s27, 0
    buffer_load_dwordx4 v[44:47], v1, s[8:11], s27 offen
    v_add_u32 v13, 262144, v1
    buffer_load_dwordx4 v[48:51], v13, s[8:11], s27 offen
    buffer_load_dwordx4 v[52:55], v2, s[12:15], s27 offen
    v_add_u32 v14, 16384, v2
    buffer_load_dwordx4 v[56:59], v14, s[12:15], s27 offen
    s_waitcnt vmcnt(0)
    ds_write_b128 v3, v[44:47] offset:0
    ds_write_b128 v3, v[48:51] offset:4608
    ds_write_b128 v3, v[52:55] offset:9216
    ds_write_b128 v3, v[56:59] offset:13824
    s_waitcnt lgkmcnt(0)
    s_barrier
    s_mov_b32 s27, 128
    buffer_load_dwordx4 v[44:47], v1, s[8:11], s27 offen
    v_add_u32 v13, 262144, v1
    buffer_load_dwordx4 v[48:51], v13, s[8:11], s27 offen
    buffer_load_dwordx4 v[52:55], v2, s[12:15], s27 offen
    v_add_u32 v14, 16384, v2
    buffer_load_dwordx4 v[56:59], v14, s[12:15], s27 offen
    ds_read_b128 v[36:39], v11 offset:0
    ds_read_b128 v[40:43], v12 offset:0
    s_waitcnt lgkmcnt(0)
    v_mfma_f32_32x32x16_bf16 v[20:35], v[36:39], v[40:43], v[20:35]
    ds_read_b128 v[36:39], v11 offset:32
    ds_read_b128 v[40:43], v12 offset:32
    s_waitcnt lgkmcnt(0)
    v_mfma_f32_32x32x16_bf16 v[20:35], v[36:39], v[40:43], v[20:35]
    ds_read_b128 v[36:39], v11 offset:64
    ds_read_b128 v[40:43], v12 offset:64
    s_waitcnt lgkmcnt(0)
    v_mfma_f32_32x32x16_bf16 v[20:35], v[36:39], v[40:43], v[20:35]
    ds_read_b128 v[36:39], v11 offset:96
    ds_read_b128 v[40:43], v12 offset:96
    s_waitcnt lgkmcnt(0)
    v_mfma_f32_32x32x16_bf16 v[20:35], v[36:39], v[40:43], v[20:35]
    s_waitcnt vmcnt(0)
    ds_write_b128 v15, v[44:47] offset:0
    ds_write_b128 v15, v[48:51] offset:4608
    ds_write_b128 v15, v[52:55] offset:9216
    ds_write_b128 v15, v[56:59] offset:13824
    s_waitcnt lgkmcnt(0)
    s_barrier
    s_mov_b32 s27, 256
    buffer_load_dwordx4 v[44:47], v1, s[8:11], s27 offen
    v_add_u32 v13, 262144, v1
    buffer_load_dwordx4 v[48:51], v13, s[8:11], s27 offen
    buffer_load_dwordx4 v[52:55], v2, s[12:15], s27 offen
    v_add_u32 v14, 16384, v2
    buffer_load_dwordx4 v[56:59], v14, s[12:15], s27 offen
    ds_read_b128 v[36:39], v16 offset:0
    ds_read_b128 v[40:43], v17 offset:0
    s_waitcnt lgkmcnt(0)
    v_mfma_f32_32x32x16_bf16 v[20:35], v[36:39], v[40:43], v[20:35]
    ds_read_b128 v[36:39], v16 offset:32
    ds_read_b128 v[40:43], v17 offset:32
    s_waitcnt lgkmcnt(0)
    v_mfma_f32_32x32x16_bf16 v[20:35], v[36:39], v[40:43], v[20:35]
    ds_read_b128 v[36:39], v16 offset:64
    ds_read_b128 v[40:43], v17 offset:64
    s_waitcnt lgkmcnt(0)
    v_mfma_f32_32x32x16_bf16 v[20:35], v[36:39], v[40:43], v[20:35]
    ds_read_b128 v[36:39], v16 offset:96
    ds_read_b128 v[40:43], v17 offset:96
    s_waitcnt lgkmcnt(0)
    v_mfma_f32_32x32x16_bf16 v[20:35], v[36:39], v[40:43], v[20:35]
    s_waitcnt vmcnt(0)
    ds_write_b128 v3, v[44:47] offset:0
    ds_write_b128 v3, v[48:51] offset:4608
    ds_write_b128 v3, v[52:55] offset:9216
    ds_write_b128 v3, v[56:59] offset:13824
    s_waitcnt lgkmcnt(0)
    s_barrier
    s_mov_b32 s27, 384
    buffer_load_dwordx4 v[44:47], v1, s[8:11], s27 offen
    v_add_u32 v13, 262144, v1
    buffer_load_dwordx4 v[48:51], v13, s[8:11], s27 offen
    buffer_load_dwordx4 v[52:55], v2, s[12:15], s27 offen
    v_add_u32 v14, 16384, v2
    buffer_load_dwordx4 v[56:59], v14, s[12:15], s27 offen
    ds_read_b128 v[36:39], v11 offset:0
    ds_read_b128 v[40:43], v12 offset:0
    s_waitcnt lgkmcnt(0)
    v_mfma_f32_32x32x16_bf16 v[20:35], v[36:39], v[40:43], v[20:35]
    ds_read_b128 v[36:39], v11 offset:32
    ds_read_b128 v[40:43], v12 offset:32
    s_waitcnt lgkmcnt(0)
    v_mfma_f32_32x32x16_bf16 v[20:35], v[36:39], v[40:43], v[20:35]
    ds_read_b128 v[36:39], v11 offset:64
    ds_read_b128 v[40:43], v12 offset:64
    s_waitcnt lgkmcnt(0)
    v_mfma_f32_32x32x16_bf16 v[20:35], v[36:39], v[40:43], v[20:35]
    ds_read_b128 v[36:39], v11 offset:96
    ds_read_b128 v[40:43], v12 offset:96
    s_waitcnt lgkmcnt(0)
    v_mfma_f32_32x32x16_bf16 v[20:35], v[36:39], v[40:43], v[20:35]
    s_waitcnt vmcnt(0)
    ds_write_b128 v15, v[44:47] offset:0
    ds_write_b128 v15, v[48:51] offset:4608
    ds_write_b128 v15, v[52:55] offset:9216
    ds_write_b128 v15, v[56:59] offset:13824
    s_waitcnt lgkmcnt(0)
    s_barrier
    ds_read_b128 v[36:39], v16 offset:0
    ds_read_b128 v[40:43], v17 offset:0
    s_waitcnt lgkmcnt(0)
    v_mfma_f32_32x32x16_bf16 v[20:35], v[36:39], v[40:43], v[20:35]
    ds_read_b128 v[36:39], v16 offset:32
    ds_read_b128 v[40:43], v17 offset:32
    s_waitcnt lgkmcnt(0)
    v_mfma_f32_32x32x16_bf16 v[20:35], v[36:39], v[40:43], v[20:35]
    ds_read_b128 v[36:39], v16 offset:64
    ds_read_b128 v[40:43], v17 offset:64
    s_waitcnt lgkmcnt(0)
    v_mfma_f32_32x32x16_bf16 v[20:35], v[36:39], v[40:43], v[20:35]
    ds_read_b128 v[36:39], v16 offset:96
    ds_read_b128 v[40:43], v17 offset:96
    s_waitcnt lgkmcnt(0)
    v_mfma_f32_32x32x16_bf16 v[20:35], v[36:39], v[40:43], v[20:35]
    s_nop 15
    s_nop 7
    s_mul_i32 s24, s22, 64
    v_mul_u32_u24 v1, 32, v6
    v_add_u32 v1, v1, v8
    v_add_u32 v1, s24, v1
    s_mov_b32 s26, 896
    v_mul_lo_u32 v1, v1, s26
    s_mul_i32 s24, s21, 64
    v_mul_u32_u24 v2, 32, v7
    v_lshl_add_u32 v2, v9, 2, v2
    v_add_u32 v2, s24, v2
    v_lshlrev_b32 v2, 1, v2
    s_mul_i32 s25, s20, 401408
    v_add_u32 v1, v1, v2
    v_add_u32 v1, s25, v1
    v_cvt_pk_bf16_f32 v38, v20, v21
    v_cvt_pk_bf16_f32 v39, v22, v23
    buffer_store_dwordx2 v[38:39], v1, s[16:19], 0 offen offset:0
    s_waitcnt vmcnt(0)
    v_cvt_pk_bf16_f32 v38, v24, v25
    v_cvt_pk_bf16_f32 v39, v26, v27
    buffer_store_dwordx2 v[38:39], v1, s[16:19], 0 offen offset:16
    s_waitcnt vmcnt(0)
    v_cvt_pk_bf16_f32 v38, v28, v29
    v_cvt_pk_bf16_f32 v39, v30, v31
    buffer_store_dwordx2 v[38:39], v1, s[16:19], 0 offen offset:32
    s_waitcnt vmcnt(0)
    v_cvt_pk_bf16_f32 v38, v32, v33
    v_cvt_pk_bf16_f32 v39, v34, v35
    buffer_store_dwordx2 v[38:39], v1, s[16:19], 0 offen offset:48
    s_waitcnt vmcnt(0)
y_wv_done:
    s_endpgm
y_end:
    s_endpgm
.text
.globl chain_kernel
.p2align 8
.type chain_kernel,@function
chain_kernel:
    s_cmp_ge_u32 s2, 44
    s_cbranch_scc1 x_gvo
    s_load_dwordx2 s[12:13], s[0:1], 112
    s_waitcnt lgkmcnt(0)
    s_add_u32 s12, s12, 0x6000000
    s_addc_u32 s13, s13, 0
    s_and_b32 s13, s13, 0xffff
    s_mov_b32 s14, 0x200000
    s_mov_b32 s15, 0x00020000
    s_load_dwordx2 s[16:17], s[0:1], 112
    s_waitcnt lgkmcnt(0)
    s_add_u32 s16, s16, 0x6200000
    s_addc_u32 s17, s17, 0
    s_and_b32 s17, s17, 0xffff
    s_mov_b32 s18, 0x200000
    s_mov_b32 s19, 0x00020000
    s_load_dwordx2 s[24:25], s[0:1], 8
    s_waitcnt lgkmcnt(0)
    s_and_b32 s25, s25, 0xffff
    s_mov_b32 s26, 0x1c00
    s_mov_b32 s27, 0x00020000
    v_lshlrev_b32 v50, 3, v0
    v_lshlrev_b32 v51, 2, v0
    v_and_b32 v1, 63, v0
    v_lshrrev_b32 v2, 6, v0
    v_and_b32 v3, 15, v0
    v_bfe_u32 v4, v0, 4, 2
    s_nop 0
    v_readfirstlane_b32 s43, v2
    v_lshlrev_b32 v5, 4, v0
    v_mov_b32 v8, 0
    v_mov_b32 v9, 0
    v_mov_b32 v10, 0
    v_mov_b32 v11, 0
    ds_write_b128 v5, v[8:11] offset:0
    ds_write_b128 v5, v[8:11] offset:4096
    ds_write_b128 v5, v[8:11] offset:8192
    ds_write_b128 v5, v[8:11] offset:12288
    ds_write_b128 v5, v[8:11] offset:16384
    ds_write_b128 v5, v[8:11] offset:20480
    ds_write_b128 v5, v[8:11] offset:24576
    ds_write_b128 v5, v[8:11] offset:28672
    ds_write_b128 v5, v[8:11] offset:32768
    ds_write_b128 v5, v[8:11] offset:36864
    ds_write_b128 v5, v[8:11] offset:40960
    ds_write_b128 v5, v[8:11] offset:45056
    ds_write_b128 v5, v[8:11] offset:49152
    ds_write_b128 v5, v[8:11] offset:53248
    ds_write_b128 v5, v[8:11] offset:57344
    ds_write_b128 v5, v[8:11] offset:61440
    v_add_u32 v5, 0x10000, v5
    ds_write_b128 v5, v[8:11] offset:0
    ds_write_b128 v5, v[8:11] offset:4096
    ds_write_b128 v5, v[8:11] offset:8192
    ds_write_b128 v5, v[8:11] offset:12288
    ds_write_b128 v5, v[8:11] offset:16384
    ds_write_b128 v5, v[8:11] offset:20480
    ds_write_b128 v5, v[8:11] offset:24576
    ds_write_b128 v5, v[8:11] offset:28672
    ds_write_b128 v5, v[8:11] offset:32768
    s_waitcnt lgkmcnt(0)
    s_barrier
    v_add_u32 v6, 0, v0
    s_mov_b32 s44, 0x124924a
    v_mul_hi_u32 v7, v6, s44
    v_mul_u32_u24 v8, 224, v7
    v_sub_u32 v8, v6, v8
    v_mul_u32_u24 v7, 912, v7
    v_lshl_add_u32 v52, v8, 2, v7
    v_add_u32 v6, 256, v0
    s_mov_b32 s44, 0x124924a
    v_mul_hi_u32 v7, v6, s44
    v_mul_u32_u24 v8, 224, v7
    v_sub_u32 v8, v6, v8
    v_mul_u32_u24 v7, 912, v7
    v_lshl_add_u32 v53, v8, 2, v7
    v_add_u32 v6, 512, v0
    s_mov_b32 s44, 0x124924a
    v_mul_hi_u32 v7, v6, s44
    v_mul_u32_u24 v8, 224, v7
    v_sub_u32 v8, v6, v8
    v_mul_u32_u24 v7, 912, v7
    v_lshl_add_u32 v54, v8, 2, v7
    v_add_u32 v6, 768, v0
    s_mov_b32 s44, 0x124924a
    v_mul_hi_u32 v7, v6, s44
    v_mul_u32_u24 v8, 224, v7
    v_sub_u32 v8, v6, v8
    v_mul_u32_u24 v7, 912, v7
    v_lshl_add_u32 v55, v8, 2, v7
    v_add_u32 v6, 1024, v0
    s_mov_b32 s44, 0x124924a
    v_mul_hi_u32 v7, v6, s44
    v_mul_u32_u24 v8, 224, v7
    v_sub_u32 v8, v6, v8
    v_mul_u32_u24 v7, 912, v7
    v_lshl_add_u32 v56, v8, 2, v7
    v_add_u32 v6, 1280, v0
    s_mov_b32 s44, 0x124924a
    v_mul_hi_u32 v7, v6, s44
    v_mul_u32_u24 v8, 224, v7
    v_sub_u32 v8, v6, v8
    v_mul_u32_u24 v7, 912, v7
    v_lshl_add_u32 v57, v8, 2, v7
    v_add_u32 v6, 1536, v0
    s_mov_b32 s44, 0x124924a
    v_mul_hi_u32 v7, v6, s44
    v_mul_u32_u24 v8, 224, v7
    v_sub_u32 v8, v6, v8
    v_mul_u32_u24 v7, 912, v7
    v_lshl_add_u32 v58, v8, 2, v7
    s_cmp_ge_u32 s2, 16
    s_cbranch_scc1 chain_kernel_val
    s_load_dwordx2 s[8:9], s[0:1], 112
    s_waitcnt lgkmcnt(0)
    s_add_u32 s8, s8, 0x200000
    s_addc_u32 s9, s9, 0
    s_and_b32 s9, s9, 0xffff
    s_mov_b32 s10, 0x620000
    s_mov_b32 s11, 0x00020000
    s_load_dwordx2 s[20:21], s[0:1], 112
    s_waitcnt lgkmcnt(0)
    s_and_b32 s21, s21, 0xffff
    s_mov_b32 s22, 0x1c0000
    s_mov_b32 s23, 0x00020000
    s_mul_i32 s44, s2, 401408
    s_mul_i32 s45, s43, 100352
    s_add_u32 s44, s44, s45
    v_mul_u32_u24 v6, 896, v3
    v_lshl_add_u32 v6, v4, 4, v6
    v_add_u32 v6, s44, v6
    buffer_load_dwordx4 a[0:3], v6, s[8:11], 0 offen offset:0
    buffer_load_dwordx4 a[4:7], v6, s[8:11], 0 offen offset:64
    buffer_load_dwordx4 a[8:11], v6, s[8:11], 0 offen offset:128
    buffer_load_dwordx4 a[12:15], v6, s[8:11], 0 offen offset:192
    buffer_load_dwordx4 a[16:19], v6, s[8:11], 0 offen offset:256
    buffer_load_dwordx4 a[20:23], v6, s[8:11], 0 offen offset:320
    buffer_load_dwordx4 a[24:27], v6, s[8:11], 0 offen offset:384
    buffer_load_dwordx4 a[28:31], v6, s[8:11], 0 offen offset:448
    buffer_load_dwordx4 a[32:35], v6, s[8:11], 0 offen offset:512
    buffer_load_dwordx4 a[36:39], v6, s[8:11], 0 offen offset:576
    buffer_load_dwordx4 a[40:43], v6, s[8:11], 0 offen offset:640
    buffer_load_dwordx4 a[44:47], v6, s[8:11], 0 offen offset:704
    buffer_load_dwordx4 a[48:51], v6, s[8:11], 0 offen offset:768
    buffer_load_dwordx4 a[52:55], v6, s[8:11], 0 offen offset:832
    v_add_u32 v6, 14336, v6
    buffer_load_dwordx4 a[56:59], v6, s[8:11], 0 offen offset:0
    buffer_load_dwordx4 a[60:63], v6, s[8:11], 0 offen offset:64
    buffer_load_dwordx4 a[64:67], v6, s[8:11], 0 offen offset:128
    buffer_load_dwordx4 a[68:71], v6, s[8:11], 0 offen offset:192
    buffer_load_dwordx4 a[72:75], v6, s[8:11], 0 offen offset:256
    buffer_load_dwordx4 a[76:79], v6, s[8:11], 0 offen offset:320
    buffer_load_dwordx4 a[80:83], v6, s[8:11], 0 offen offset:384
    buffer_load_dwordx4 a[84:87], v6, s[8:11], 0 offen offset:448
    buffer_load_dwordx4 a[88:91], v6, s[8:11], 0 offen offset:512
    buffer_load_dwordx4 a[92:95], v6, s[8:11], 0 offen offset:576
    buffer_load_dwordx4 a[96:99], v6, s[8:11], 0 offen offset:640
    buffer_load_dwordx4 a[100:103], v6, s[8:11], 0 offen offset:704
    buffer_load_dwordx4 a[104:107], v6, s[8:11], 0 offen offset:768
    buffer_load_dwordx4 a[108:111], v6, s[8:11], 0 offen offset:832
    v_add_u32 v6, 14336, v6
    buffer_load_dwordx4 a[112:115], v6, s[8:11], 0 offen offset:0
    buffer_load_dwordx4 a[116:119], v6, s[8:11], 0 offen offset:64
    buffer_load_dwordx4 a[120:123], v6, s[8:11], 0 offen offset:128
    buffer_load_dwordx4 a[124:127], v6, s[8:11], 0 offen offset:192
    buffer_load_dwordx4 a[128:131], v6, s[8:11], 0 offen offset:256
    buffer_load_dwordx4 a[132:135], v6, s[8:11], 0 offen offset:320
    buffer_load_dwordx4 a[136:139], v6, s[8:11], 0 offen offset:384
    buffer_load_dwordx4 a[140:143], v6, s[8:11], 0 offen offset:448
    buffer_load_dwordx4 a[144:147], v6, s[8:11], 0 offen offset:512
    buffer_load_dwordx4 a[148:151], v6, s[8:11], 0 offen offset:576
    buffer_load_dwordx4 a[152:155], v6, s[8:11], 0 offen offset:640
    buffer_load_dwordx4 a[156:159], v6, s[8:11], 0 offen offset:704
    buffer_load_dwordx4 a[160:163], v6, s[8:11], 0 offen offset:768
    buffer_load_dwordx4 a[164:167], v6, s[8:11], 0 offen offset:832
    v_add_u32 v6, 14336, v6
    buffer_load_dwordx4 a[168:171], v6, s[8:11], 0 offen offset:0
    buffer_load_dwordx4 a[172:175], v6, s[8:11], 0 offen offset:64
    buffer_load_dwordx4 a[176:179], v6, s[8:11], 0 offen offset:128
    buffer_load_dwordx4 a[180:183], v6, s[8:11], 0 offen offset:192
    buffer_load_dwordx4 a[184:187], v6, s[8:11], 0 offen offset:256
    buffer_load_dwordx4 a[188:191], v6, s[8:11], 0 offen offset:320
    buffer_load_dwordx4 a[192:195], v6, s[8:11], 0 offen offset:384
    buffer_load_dwordx4 a[196:199], v6, s[8:11], 0 offen offset:448
    buffer_load_dwordx4 a[200:203], v6, s[8:11], 0 offen offset:512
    buffer_load_dwordx4 a[204:207], v6, s[8:11], 0 offen offset:576
    buffer_load_dwordx4 a[208:211], v6, s[8:11], 0 offen offset:640
    buffer_load_dwordx4 a[212:215], v6, s[8:11], 0 offen offset:704
    buffer_load_dwordx4 a[216:219], v6, s[8:11], 0 offen offset:768
    buffer_load_dwordx4 a[220:223], v6, s[8:11], 0 offen offset:832
    v_add_u32 v6, 14336, v6
    buffer_load_dwordx4 a[224:227], v6, s[8:11], 0 offen offset:0
    buffer_load_dwordx4 a[228:231], v6, s[8:11], 0 offen offset:64
    buffer_load_dwordx4 a[232:235], v6, s[8:11], 0 offen offset:128
    buffer_load_dwordx4 a[236:239], v6, s[8:11], 0 offen offset:192
    buffer_load_dwordx4 a[240:243], v6, s[8:11], 0 offen offset:256
    buffer_load_dwordx4 a[244:247], v6, s[8:11], 0 offen offset:320
    buffer_load_dwordx4 a[248:251], v6, s[8:11], 0 offen offset:384
    buffer_load_dwordx4 a[252:255], v6, s[8:11], 0 offen offset:448
    buffer_load_dwordx4 v[120:123], v6, s[8:11], 0 offen offset:512
    buffer_load_dwordx4 v[124:127], v6, s[8:11], 0 offen offset:576
    buffer_load_dwordx4 v[128:131], v6, s[8:11], 0 offen offset:640
    buffer_load_dwordx4 v[132:135], v6, s[8:11], 0 offen offset:704
    buffer_load_dwordx4 v[136:139], v6, s[8:11], 0 offen offset:768
    buffer_load_dwordx4 v[140:143], v6, s[8:11], 0 offen offset:832
    v_add_u32 v6, 14336, v6
    buffer_load_dwordx4 v[144:147], v6, s[8:11], 0 offen offset:0
    buffer_load_dwordx4 v[148:151], v6, s[8:11], 0 offen offset:64
    buffer_load_dwordx4 v[152:155], v6, s[8:11], 0 offen offset:128
    buffer_load_dwordx4 v[156:159], v6, s[8:11], 0 offen offset:192
    buffer_load_dwordx4 v[160:163], v6, s[8:11], 0 offen offset:256
    buffer_load_dwordx4 v[164:167], v6, s[8:11], 0 offen offset:320
    buffer_load_dwordx4 v[168:171], v6, s[8:11], 0 offen offset:384
    buffer_load_dwordx4 v[172:175], v6, s[8:11], 0 offen offset:448
    buffer_load_dwordx4 v[176:179], v6, s[8:11], 0 offen offset:512
    buffer_load_dwordx4 v[180:183], v6, s[8:11], 0 offen offset:576
    buffer_load_dwordx4 v[184:187], v6, s[8:11], 0 offen offset:640
    buffer_load_dwordx4 v[188:191], v6, s[8:11], 0 offen offset:704
    buffer_load_dwordx4 v[192:195], v6, s[8:11], 0 offen offset:768
    buffer_load_dwordx4 v[196:199], v6, s[8:11], 0 offen offset:832
    v_add_u32 v6, 14336, v6
    buffer_load_dwordx4 v[200:203], v6, s[8:11], 0 offen offset:0
    buffer_load_dwordx4 v[204:207], v6, s[8:11], 0 offen offset:64
    buffer_load_dwordx4 v[208:211], v6, s[8:11], 0 offen offset:128
    buffer_load_dwordx4 v[212:215], v6, s[8:11], 0 offen offset:192
    buffer_load_dwordx4 v[216:219], v6, s[8:11], 0 offen offset:256
    buffer_load_dwordx4 v[220:223], v6, s[8:11], 0 offen offset:320
    buffer_load_dwordx4 v[224:227], v6, s[8:11], 0 offen offset:384
    buffer_load_dwordx4 v[228:231], v6, s[8:11], 0 offen offset:448
    buffer_load_dwordx4 v[232:235], v6, s[8:11], 0 offen offset:512
    buffer_load_dwordx4 v[236:239], v6, s[8:11], 0 offen offset:576
    buffer_load_dwordx4 v[240:243], v6, s[8:11], 0 offen offset:640
    buffer_load_dwordx4 v[244:247], v6, s[8:11], 0 offen offset:704
    buffer_load_dwordx4 v[248:251], v6, s[8:11], 0 offen offset:768
    buffer_load_dwordx4 v[252:255], v6, s[8:11], 0 offen offset:832
    v_add_u32 v6, 14336, v6
    v_add_u32 v52, 29184, v52
    v_add_u32 v53, 29184, v53
    v_add_u32 v54, 29184, v54
    v_add_u32 v55, 29184, v55
    v_add_u32 v56, 29184, v56
    v_add_u32 v57, 29184, v57
    v_add_u32 v58, 29184, v58
    v_add_u32 v6, 0, v0
    s_mov_b32 s44, 0x4924925
    v_mul_hi_u32 v7, v6, s44
    v_mul_u32_u24 v8, 56, v7
    v_sub_u32 v8, v6, v8
    v_mul_u32_u24 v7, 912, v7
    v_lshl_add_u32 v36, v8, 4, v7
    v_add_u32 v6, 256, v0
    s_mov_b32 s44, 0x4924925
    v_mul_hi_u32 v7, v6, s44
    v_mul_u32_u24 v8, 56, v7
    v_sub_u32 v8, v6, v8
    v_mul_u32_u24 v7, 912, v7
    v_lshl_add_u32 v37, v8, 4, v7
    v_add_u32 v6, 512, v0
    s_mov_b32 s44, 0x4924925
    v_mul_hi_u32 v7, v6, s44
    v_mul_u32_u24 v8, 56, v7
    v_sub_u32 v8, v6, v8
    v_mul_u32_u24 v7, 912, v7
    v_lshl_add_u32 v38, v8, 4, v7
    v_add_u32 v6, 768, v0
    s_mov_b32 s44, 0x4924925
    v_mul_hi_u32 v7, v6, s44
    v_mul_u32_u24 v8, 56, v7
    v_sub_u32 v8, v6, v8
    v_mul_u32_u24 v7, 912, v7
    v_lshl_add_u32 v39, v8, 4, v7
    v_add_u32 v6, 1024, v0
    s_mov_b32 s44, 0x4924925
    v_mul_hi_u32 v7, v6, s44
    v_mul_u32_u24 v8, 56, v7
    v_sub_u32 v8, v6, v8
    v_mul_u32_u24 v7, 912, v7
    v_lshl_add_u32 v47, v8, 4, v7
    v_add_u32 v6, 1280, v0
    s_mov_b32 s44, 0x4924925
    v_mul_hi_u32 v7, v6, s44
    v_mul_u32_u24 v8, 56, v7
    v_sub_u32 v8, v6, v8
    v_mul_u32_u24 v7, 912, v7
    v_lshl_add_u32 v48, v8, 4, v7
    v_add_u32 v6, 1536, v0
    s_mov_b32 s44, 0x4924925
    v_mul_hi_u32 v7, v6, s44
    v_mul_u32_u24 v8, 56, v7
    v_sub_u32 v8, v6, v8
    v_mul_u32_u24 v7, 912, v7
    v_lshl_add_u32 v59, v8, 4, v7
    v_lshlrev_b32 v49, 4, v0
    s_mov_b32 s46, 0
    buffer_load_dwordx4 v[88:91], v49, s[20:23], s46 offen offset:0
    s_add_u32 s39, s46, 4096
    buffer_load_dwordx4 v[92:95], v49, s[20:23], s39 offen offset:0
    s_add_u32 s39, s46, 8192
    buffer_load_dwordx4 v[96:99], v49, s[20:23], s39 offen offset:0
    s_add_u32 s39, s46, 12288
    buffer_load_dwordx4 v[100:103], v49, s[20:23], s39 offen offset:0
    s_add_u32 s39, s46, 16384
    buffer_load_dwordx4 v[104:107], v49, s[20:23], s39 offen offset:0
    s_add_u32 s39, s46, 20480
    buffer_load_dwordx4 v[108:111], v49, s[20:23], s39 offen offset:0
    s_add_u32 s39, s46, 24576
    buffer_load_dwordx4 v[112:115], v49, s[20:23], s39 offen offset:0
    s_waitcnt vmcnt(0)
    ds_write_b128 v36, v[88:91] offset:0
    ds_write_b128 v37, v[92:95] offset:0
    ds_write_b128 v38, v[96:99] offset:0
    ds_write_b128 v39, v[100:103] offset:0
    ds_write_b128 v47, v[104:107] offset:0
    ds_write_b128 v48, v[108:111] offset:0
    ds_write_b128 v59, v[112:115] offset:0
    s_mov_b32 s46, 28672
    buffer_load_dwordx4 v[88:91], v49, s[20:23], s46 offen offset:0
    s_add_u32 s39, s46, 4096
    buffer_load_dwordx4 v[92:95], v49, s[20:23], s39 offen offset:0
    s_add_u32 s39, s46, 8192
    buffer_load_dwordx4 v[96:99], v49, s[20:23], s39 offen offset:0
    s_add_u32 s39, s46, 12288
    buffer_load_dwordx4 v[100:103], v49, s[20:23], s39 offen offset:0
    s_add_u32 s39, s46, 16384
    buffer_load_dwordx4 v[104:107], v49, s[20:23], s39 offen offset:0
    s_add_u32 s39, s46, 20480
    buffer_load_dwordx4 v[108:111], v49, s[20:23], s39 offen offset:0
    s_add_u32 s39, s46, 24576
    buffer_load_dwordx4 v[112:115], v49, s[20:23], s39 offen offset:0
    v_add_u32 v40, 32, v3
    v_mul_u32_u24 v40, 912, v40
    v_lshl_add_u32 v40, v4, 4, v40
    v_mul_u32_u24 v41, 912, v3
    v_lshl_add_u32 v41, v4, 3, v41
    v_mul_u32_u24 v6, 224, v2
    v_add_u32 v41, v41, v6
    v_lshlrev_b32 v42, 2, v2
    v_lshl_add_u32 v42, v4, 10, v42
    v_lshl_add_u32 v42, v3, 4, v42
    v_add_u32 v42, 87552, v42
    v_and_b32 v43, 7, v1
    v_bfe_u32 v44, v1, 3, 2
    v_mul_u32_u24 v45, 2560, v44
    v_lshl_add_u32 v45, v43, 4, v45
    v_add_u32 v45, 87552, v45
    v_mul_u32_u24 v46, 20, v43
    v_mul_u32_u24 v6, 5, v44
    v_add_u32 v46, v46, v6
    s_mul_i32 s44, s2, 160
    v_add_u32 v46, s44, v46
    v_lshlrev_b32 v46, 3, v46
    s_mov_b32 s41, 0
chain_kernel_sloop:
    s_cmp_lg_u32 s41, 0
    s_cbranch_scc1 gm_1_p
    buffer_load_dword v60, v51, s[24:27], 0 offen offset:0
    buffer_load_dword v62, v51, s[24:27], 0 offen offset:1024
    buffer_load_dword v64, v51, s[24:27], 0 offen offset:2048
    buffer_load_dword v66, v51, s[24:27], 0 offen offset:3072
    s_add_u32 s39, 0, 4096
    buffer_load_dword v68, v51, s[24:27], s39 offen offset:0
    s_add_u32 s39, 0, 4096
    buffer_load_dword v70, v51, s[24:27], s39 offen offset:1024
    s_add_u32 s39, 0, 4096
    buffer_load_dword v72, v51, s[24:27], s39 offen offset:2048
    s_waitcnt vmcnt(0)
    s_branch gm_1_w
gm_1_p:
    s_lshl_b32 s42, s41, 14
    s_mov_b32 s40, 0
poll_2:
    buffer_load_dwordx2 v[60:61], v50, s[12:15], s42 offen offset:0 sc1
    buffer_load_dwordx2 v[62:63], v50, s[12:15], s42 offen offset:2048 sc1
    s_add_u32 s39, s42, 4096
    buffer_load_dwordx2 v[64:65], v50, s[12:15], s39 offen offset:0 sc1
    s_add_u32 s39, s42, 4096
    buffer_load_dwordx2 v[66:67], v50, s[12:15], s39 offen offset:2048 sc1
    s_add_u32 s39, s42, 8192
    buffer_load_dwordx2 v[68:69], v50, s[12:15], s39 offen offset:0 sc1
    s_add_u32 s39, s42, 8192
    buffer_load_dwordx2 v[70:71], v50, s[12:15], s39 offen offset:2048 sc1
    s_add_u32 s39, s42, 12288
    buffer_load_dwordx2 v[72:73], v50, s[12:15], s39 offen offset:0 sc1
    s_waitcnt vmcnt(0)
    v_mov_b32 v119, v61
    v_and_b32 v119, v119, v63
    v_and_b32 v119, v119, v65
    v_and_b32 v119, v119, v67
    v_and_b32 v119, v119, v69
    v_and_b32 v119, v119, v71
    v_and_b32 v119, v119, v73
    v_cmp_ne_u32 vcc, 1, v119
    s_add_u32 s40, s40, 1
    s_cmp_gt_u32 s40, 0x100000
    s_cbranch_scc1 poll_2_x
    s_cbranch_vccnz poll_2
poll_2_x:
gm_1_w:
    ds_write_b32 v52, v60 offset:0
    ds_write_b32 v53, v62 offset:0
    ds_write_b32 v54, v64 offset:0
    ds_write_b32 v55, v66 offset:0
    ds_write_b32 v56, v68 offset:0
    ds_write_b32 v57, v70 offset:0
    ds_write_b32 v58, v72 offset:0
    s_waitcnt lgkmcnt(0)
    s_barrier
    v_mov_b32 v8, 0
    v_mov_b32 v9, 0
    v_mov_b32 v10, 0
    v_mov_b32 v11, 0
    v_mov_b32 v12, 0
    v_mov_b32 v13, 0
    v_mov_b32 v14, 0
    v_mov_b32 v15, 0
    v_mov_b32 v16, 0
    v_mov_b32 v17, 0
    v_mov_b32 v18, 0
    v_mov_b32 v19, 0
    v_mov_b32 v20, 0
    v_mov_b32 v21, 0
    v_mov_b32 v22, 0
    v_mov_b32 v23, 0
    v_mov_b32 v24, 0
    v_mov_b32 v25, 0
    v_mov_b32 v26, 0
    v_mov_b32 v27, 0
    v_mov_b32 v28, 0
    v_mov_b32 v29, 0
    v_mov_b32 v30, 0
    v_mov_b32 v31, 0
    v_mov_b32 v32, 0
    v_mov_b32 v33, 0
    v_mov_b32 v34, 0
    v_mov_b32 v35, 0
    ds_read_b128 v[60:63], v40 offset:0
    ds_read_b128 v[64:67], v40 offset:64
    ds_read_b128 v[68:71], v40 offset:128
    ds_read_b128 v[72:75], v40 offset:192
    ds_read_b128 v[76:79], v40 offset:256
    ds_read_b128 v[80:83], v40 offset:320
    ds_read_b128 v[84:87], v40 offset:384
    s_waitcnt lgkmcnt(6)
    v_mfma_f32_16x16x32_bf16 v[8:11], a[0:3], v[60:63], v[8:11]
    v_mfma_f32_16x16x32_bf16 v[12:15], a[56:59], v[60:63], v[12:15]
    v_mfma_f32_16x16x32_bf16 v[16:19], a[112:115], v[60:63], v[16:19]
    v_mfma_f32_16x16x32_bf16 v[20:23], a[168:171], v[60:63], v[20:23]
    v_mfma_f32_16x16x32_bf16 v[24:27], a[224:227], v[60:63], v[24:27]
    v_mfma_f32_16x16x32_bf16 v[28:31], v[144:147], v[60:63], v[28:31]
    v_mfma_f32_16x16x32_bf16 v[32:35], v[200:203], v[60:63], v[32:35]
    s_waitcnt lgkmcnt(5)
    v_mfma_f32_16x16x32_bf16 v[8:11], a[4:7], v[64:67], v[8:11]
    v_mfma_f32_16x16x32_bf16 v[12:15], a[60:63], v[64:67], v[12:15]
    v_mfma_f32_16x16x32_bf16 v[16:19], a[116:119], v[64:67], v[16:19]
    v_mfma_f32_16x16x32_bf16 v[20:23], a[172:175], v[64:67], v[20:23]
    v_mfma_f32_16x16x32_bf16 v[24:27], a[228:231], v[64:67], v[24:27]
    v_mfma_f32_16x16x32_bf16 v[28:31], v[148:151], v[64:67], v[28:31]
    v_mfma_f32_16x16x32_bf16 v[32:35], v[204:207], v[64:67], v[32:35]
    s_waitcnt lgkmcnt(4)
    v_mfma_f32_16x16x32_bf16 v[8:11], a[8:11], v[68:71], v[8:11]
    v_mfma_f32_16x16x32_bf16 v[12:15], a[64:67], v[68:71], v[12:15]
    v_mfma_f32_16x16x32_bf16 v[16:19], a[120:123], v[68:71], v[16:19]
    v_mfma_f32_16x16x32_bf16 v[20:23], a[176:179], v[68:71], v[20:23]
    v_mfma_f32_16x16x32_bf16 v[24:27], a[232:235], v[68:71], v[24:27]
    v_mfma_f32_16x16x32_bf16 v[28:31], v[152:155], v[68:71], v[28:31]
    v_mfma_f32_16x16x32_bf16 v[32:35], v[208:211], v[68:71], v[32:35]
    s_waitcnt lgkmcnt(3)
    v_mfma_f32_16x16x32_bf16 v[8:11], a[12:15], v[72:75], v[8:11]
    v_mfma_f32_16x16x32_bf16 v[12:15], a[68:71], v[72:75], v[12:15]
    v_mfma_f32_16x16x32_bf16 v[16:19], a[124:127], v[72:75], v[16:19]
    v_mfma_f32_16x16x32_bf16 v[20:23], a[180:183], v[72:75], v[20:23]
    v_mfma_f32_16x16x32_bf16 v[24:27], a[236:239], v[72:75], v[24:27]
    v_mfma_f32_16x16x32_bf16 v[28:31], v[156:159], v[72:75], v[28:31]
    v_mfma_f32_16x16x32_bf16 v[32:35], v[212:215], v[72:75], v[32:35]
    s_waitcnt lgkmcnt(2)
    v_mfma_f32_16x16x32_bf16 v[8:11], a[16:19], v[76:79], v[8:11]
    v_mfma_f32_16x16x32_bf16 v[12:15], a[72:75], v[76:79], v[12:15]
    v_mfma_f32_16x16x32_bf16 v[16:19], a[128:131], v[76:79], v[16:19]
    v_mfma_f32_16x16x32_bf16 v[20:23], a[184:187], v[76:79], v[20:23]
    v_mfma_f32_16x16x32_bf16 v[24:27], a[240:243], v[76:79], v[24:27]
    v_mfma_f32_16x16x32_bf16 v[28:31], v[160:163], v[76:79], v[28:31]
    v_mfma_f32_16x16x32_bf16 v[32:35], v[216:219], v[76:79], v[32:35]
    s_waitcnt lgkmcnt(1)
    v_mfma_f32_16x16x32_bf16 v[8:11], a[20:23], v[80:83], v[8:11]
    v_mfma_f32_16x16x32_bf16 v[12:15], a[76:79], v[80:83], v[12:15]
    v_mfma_f32_16x16x32_bf16 v[16:19], a[132:135], v[80:83], v[16:19]
    v_mfma_f32_16x16x32_bf16 v[20:23], a[188:191], v[80:83], v[20:23]
    v_mfma_f32_16x16x32_bf16 v[24:27], a[244:247], v[80:83], v[24:27]
    v_mfma_f32_16x16x32_bf16 v[28:31], v[164:167], v[80:83], v[28:31]
    v_mfma_f32_16x16x32_bf16 v[32:35], v[220:223], v[80:83], v[32:35]
    s_waitcnt lgkmcnt(0)
    v_mfma_f32_16x16x32_bf16 v[8:11], a[24:27], v[84:87], v[8:11]
    v_mfma_f32_16x16x32_bf16 v[12:15], a[80:83], v[84:87], v[12:15]
    v_mfma_f32_16x16x32_bf16 v[16:19], a[136:139], v[84:87], v[16:19]
    v_mfma_f32_16x16x32_bf16 v[20:23], a[192:195], v[84:87], v[20:23]
    v_mfma_f32_16x16x32_bf16 v[24:27], a[248:251], v[84:87], v[24:27]
    v_mfma_f32_16x16x32_bf16 v[28:31], v[168:171], v[84:87], v[28:31]
    v_mfma_f32_16x16x32_bf16 v[32:35], v[224:227], v[84:87], v[32:35]
    ds_read_b128 v[60:63], v40 offset:448
    ds_read_b128 v[64:67], v40 offset:512
    ds_read_b128 v[68:71], v40 offset:576
    ds_read_b128 v[72:75], v40 offset:640
    ds_read_b128 v[76:79], v40 offset:704
    ds_read_b128 v[80:83], v40 offset:768
    ds_read_b128 v[84:87], v40 offset:832
    s_waitcnt lgkmcnt(6)
    v_mfma_f32_16x16x32_bf16 v[8:11], a[28:31], v[60:63], v[8:11]
    v_mfma_f32_16x16x32_bf16 v[12:15], a[84:87], v[60:63], v[12:15]
    v_mfma_f32_16x16x32_bf16 v[16:19], a[140:143], v[60:63], v[16:19]
    v_mfma_f32_16x16x32_bf16 v[20:23], a[196:199], v[60:63], v[20:23]
    v_mfma_f32_16x16x32_bf16 v[24:27], a[252:255], v[60:63], v[24:27]
    v_mfma_f32_16x16x32_bf16 v[28:31], v[172:175], v[60:63], v[28:31]
    v_mfma_f32_16x16x32_bf16 v[32:35], v[228:231], v[60:63], v[32:35]
    s_waitcnt lgkmcnt(5)
    v_mfma_f32_16x16x32_bf16 v[8:11], a[32:35], v[64:67], v[8:11]
    v_mfma_f32_16x16x32_bf16 v[12:15], a[88:91], v[64:67], v[12:15]
    v_mfma_f32_16x16x32_bf16 v[16:19], a[144:147], v[64:67], v[16:19]
    v_mfma_f32_16x16x32_bf16 v[20:23], a[200:203], v[64:67], v[20:23]
    v_mfma_f32_16x16x32_bf16 v[24:27], v[120:123], v[64:67], v[24:27]
    v_mfma_f32_16x16x32_bf16 v[28:31], v[176:179], v[64:67], v[28:31]
    v_mfma_f32_16x16x32_bf16 v[32:35], v[232:235], v[64:67], v[32:35]
    s_waitcnt lgkmcnt(4)
    v_mfma_f32_16x16x32_bf16 v[8:11], a[36:39], v[68:71], v[8:11]
    v_mfma_f32_16x16x32_bf16 v[12:15], a[92:95], v[68:71], v[12:15]
    v_mfma_f32_16x16x32_bf16 v[16:19], a[148:151], v[68:71], v[16:19]
    v_mfma_f32_16x16x32_bf16 v[20:23], a[204:207], v[68:71], v[20:23]
    v_mfma_f32_16x16x32_bf16 v[24:27], v[124:127], v[68:71], v[24:27]
    v_mfma_f32_16x16x32_bf16 v[28:31], v[180:183], v[68:71], v[28:31]
    v_mfma_f32_16x16x32_bf16 v[32:35], v[236:239], v[68:71], v[32:35]
    s_waitcnt lgkmcnt(3)
    v_mfma_f32_16x16x32_bf16 v[8:11], a[40:43], v[72:75], v[8:11]
    v_mfma_f32_16x16x32_bf16 v[12:15], a[96:99], v[72:75], v[12:15]
    v_mfma_f32_16x16x32_bf16 v[16:19], a[152:155], v[72:75], v[16:19]
    v_mfma_f32_16x16x32_bf16 v[20:23], a[208:211], v[72:75], v[20:23]
    v_mfma_f32_16x16x32_bf16 v[24:27], v[128:131], v[72:75], v[24:27]
    v_mfma_f32_16x16x32_bf16 v[28:31], v[184:187], v[72:75], v[28:31]
    v_mfma_f32_16x16x32_bf16 v[32:35], v[240:243], v[72:75], v[32:35]
    s_waitcnt lgkmcnt(2)
    v_mfma_f32_16x16x32_bf16 v[8:11], a[44:47], v[76:79], v[8:11]
    v_mfma_f32_16x16x32_bf16 v[12:15], a[100:103], v[76:79], v[12:15]
    v_mfma_f32_16x16x32_bf16 v[16:19], a[156:159], v[76:79], v[16:19]
    v_mfma_f32_16x16x32_bf16 v[20:23], a[212:215], v[76:79], v[20:23]
    v_mfma_f32_16x16x32_bf16 v[24:27], v[132:135], v[76:79], v[24:27]
    v_mfma_f32_16x16x32_bf16 v[28:31], v[188:191], v[76:79], v[28:31]
    v_mfma_f32_16x16x32_bf16 v[32:35], v[244:247], v[76:79], v[32:35]
    s_waitcnt lgkmcnt(1)
    v_mfma_f32_16x16x32_bf16 v[8:11], a[48:51], v[80:83], v[8:11]
    v_mfma_f32_16x16x32_bf16 v[12:15], a[104:107], v[80:83], v[12:15]
    v_mfma_f32_16x16x32_bf16 v[16:19], a[160:163], v[80:83], v[16:19]
    v_mfma_f32_16x16x32_bf16 v[20:23], a[216:219], v[80:83], v[20:23]
    v_mfma_f32_16x16x32_bf16 v[24:27], v[136:139], v[80:83], v[24:27]
    v_mfma_f32_16x16x32_bf16 v[28:31], v[192:195], v[80:83], v[28:31]
    v_mfma_f32_16x16x32_bf16 v[32:35], v[248:251], v[80:83], v[32:35]
    s_waitcnt lgkmcnt(0)
    v_mfma_f32_16x16x32_bf16 v[8:11], a[52:55], v[84:87], v[8:11]
    v_mfma_f32_16x16x32_bf16 v[12:15], a[108:111], v[84:87], v[12:15]
    v_mfma_f32_16x16x32_bf16 v[16:19], a[164:167], v[84:87], v[16:19]
    v_mfma_f32_16x16x32_bf16 v[20:23], a[220:223], v[84:87], v[20:23]
    v_mfma_f32_16x16x32_bf16 v[24:27], v[140:143], v[84:87], v[24:27]
    v_mfma_f32_16x16x32_bf16 v[28:31], v[196:199], v[84:87], v[28:31]
    v_mfma_f32_16x16x32_bf16 v[32:35], v[252:255], v[84:87], v[32:35]
    s_nop 7
    v_cvt_pk_bf16_f32 v8, v8, v9
    v_cvt_pk_bf16_f32 v9, v10, v11
    v_cvt_pk_bf16_f32 v12, v12, v13
    v_cvt_pk_bf16_f32 v13, v14, v15
    v_cvt_pk_bf16_f32 v16, v16, v17
    v_cvt_pk_bf16_f32 v17, v18, v19
    v_cvt_pk_bf16_f32 v20, v20, v21
    v_cvt_pk_bf16_f32 v21, v22, v23
    v_cvt_pk_bf16_f32 v24, v24, v25
    v_cvt_pk_bf16_f32 v25, v26, v27
    v_cvt_pk_bf16_f32 v28, v28, v29
    v_cvt_pk_bf16_f32 v29, v30, v31
    v_cvt_pk_bf16_f32 v32, v32, v33
    v_cvt_pk_bf16_f32 v33, v34, v35
    v_mov_b32 v10, v12
    v_mov_b32 v11, v13
    v_mov_b32 v18, v20
    v_mov_b32 v19, v21
    v_mov_b32 v26, v28
    v_mov_b32 v27, v29
    v_mov_b32 v34, 0
    v_mov_b32 v35, 0
    v_mov_b32 v76, 0
    v_mov_b32 v77, 0
    v_mov_b32 v78, 0
    v_mov_b32 v79, 0
    v_mov_b32 v80, 0
    v_mov_b32 v81, 0
    v_mov_b32 v82, 0
    v_mov_b32 v83, 0
    v_mov_b32 v84, 0
    v_mov_b32 v85, 0
    v_mov_b32 v86, 0
    v_mov_b32 v87, 0
    v_add_u32 v41, 0, v41
    ds_read_b64 v[60:61], v41 offset:0
    ds_read_b64 v[62:63], v41 offset:32
    ds_read_b64 v[64:65], v41 offset:64
    ds_read_b64 v[66:67], v41 offset:96
    ds_read_b64 v[68:69], v41 offset:128
    ds_read_b64 v[70:71], v41 offset:160
    ds_read_b64 v[72:73], v41 offset:192
    ds_read_b64 v[74:75], v41 offset:224
    s_waitcnt lgkmcnt(0)
    v_mfma_f32_16x16x32_bf16 v[76:79], v[60:63], v[8:11], v[76:79]
    v_mfma_f32_16x16x32_bf16 v[76:79], v[64:67], v[16:19], v[76:79]
    v_mfma_f32_16x16x32_bf16 v[76:79], v[68:71], v[24:27], v[76:79]
    v_mfma_f32_16x16x32_bf16 v[76:79], v[72:75], v[32:35], v[76:79]
    ds_read_b64 v[60:61], v41 offset:14592
    ds_read_b64 v[62:63], v41 offset:14624
    ds_read_b64 v[64:65], v41 offset:14656
    ds_read_b64 v[66:67], v41 offset:14688
    ds_read_b64 v[68:69], v41 offset:14720
    ds_read_b64 v[70:71], v41 offset:14752
    ds_read_b64 v[72:73], v41 offset:14784
    ds_read_b64 v[74:75], v41 offset:14816
    s_waitcnt lgkmcnt(0)
    v_mfma_f32_16x16x32_bf16 v[80:83], v[60:63], v[8:11], v[80:83]
    v_mfma_f32_16x16x32_bf16 v[80:83], v[64:67], v[16:19], v[80:83]
    v_mfma_f32_16x16x32_bf16 v[80:83], v[68:71], v[24:27], v[80:83]
    v_mfma_f32_16x16x32_bf16 v[80:83], v[72:75], v[32:35], v[80:83]
    ds_read_b64 v[60:61], v41 offset:29184
    ds_read_b64 v[62:63], v41 offset:29216
    ds_read_b64 v[64:65], v41 offset:29248
    ds_read_b64 v[66:67], v41 offset:29280
    ds_read_b64 v[68:69], v41 offset:29312
    ds_read_b64 v[70:71], v41 offset:29344
    ds_read_b64 v[72:73], v41 offset:29376
    ds_read_b64 v[74:75], v41 offset:29408
    s_waitcnt lgkmcnt(0)
    v_mfma_f32_16x16x32_bf16 v[84:87], v[60:63], v[8:11], v[84:87]
    v_mfma_f32_16x16x32_bf16 v[84:87], v[64:67], v[16:19], v[84:87]
    v_mfma_f32_16x16x32_bf16 v[84:87], v[68:71], v[24:27], v[84:87]
    v_mfma_f32_16x16x32_bf16 v[84:87], v[72:75], v[32:35], v[84:87]
    v_subrev_u32 v41, 0, v41
    s_nop 7
    s_nop 3
    ds_write_b32 v42, v76 offset:0
    ds_write_b32 v42, v77 offset:256
    ds_write_b32 v42, v78 offset:512
    ds_write_b32 v42, v79 offset:768
    ds_write_b32 v42, v80 offset:4096
    ds_write_b32 v42, v81 offset:4352
    ds_write_b32 v42, v82 offset:4608
    ds_write_b32 v42, v83 offset:4864
    ds_write_b32 v42, v84 offset:8192
    ds_write_b32 v42, v85 offset:8448
    ds_write_b32 v42, v86 offset:8704
    ds_write_b32 v42, v87 offset:8960
    s_waitcnt lgkmcnt(0)
    s_barrier
    s_cmp_lg_u32 s43, 0
    s_cbranch_scc1 sk_3
    ds_read_b128 v[60:63], v45 offset:0
    ds_read_b128 v[64:67], v45 offset:256
    ds_read_b128 v[68:71], v45 offset:512
    ds_read_b128 v[72:75], v45 offset:768
    ds_read_b128 v[76:79], v45 offset:1024
    ds_read_b128 v[80:83], v45 offset:1280
    ds_read_b128 v[84:87], v45 offset:1536
    ds_read_b128 v[24:27], v45 offset:1792
    ds_read_b128 v[28:31], v45 offset:2048
    ds_read_b128 v[32:35], v45 offset:2304
    s_waitcnt lgkmcnt(9)
    v_add_f32 v60, v60, v61
    v_add_f32 v62, v62, v63
    v_add_f32 v8, v60, v62
    s_waitcnt lgkmcnt(8)
    v_add_f32 v64, v64, v65
    v_add_f32 v66, v66, v67
    v_add_f32 v9, v64, v66
    s_waitcnt lgkmcnt(7)
    v_add_f32 v68, v68, v69
    v_add_f32 v70, v70, v71
    v_add_f32 v10, v68, v70
    s_waitcnt lgkmcnt(6)
    v_add_f32 v72, v72, v73
    v_add_f32 v74, v74, v75
    v_add_f32 v11, v72, v74
    s_waitcnt lgkmcnt(5)
    v_add_f32 v76, v76, v77
    v_add_f32 v78, v78, v79
    v_add_f32 v12, v76, v78
    s_waitcnt lgkmcnt(4)
    v_add_f32 v80, v80, v81
    v_add_f32 v82, v82, v83
    v_add_f32 v13, v80, v82
    s_waitcnt lgkmcnt(3)
    v_add_f32 v84, v84, v85
    v_add_f32 v86, v86, v87
    v_add_f32 v14, v84, v86
    s_waitcnt lgkmcnt(2)
    v_add_f32 v24, v24, v25
    v_add_f32 v26, v26, v27
    v_add_f32 v15, v24, v26
    s_waitcnt lgkmcnt(1)
    v_add_f32 v28, v28, v29
    v_add_f32 v30, v30, v31
    v_add_f32 v16, v28, v30
    s_waitcnt lgkmcnt(0)
    v_add_f32 v32, v32, v33
    v_add_f32 v34, v34, v35
    v_add_f32 v17, v32, v34
    v_max_f32 v20, v8, v9
    v_max_f32 v20, v20, v10
    v_max_f32 v20, v20, v11
    v_max_f32 v20, v20, v12
    v_max_f32 v20, v20, v13
    v_max_f32 v20, v20, v14
    v_max_f32 v20, v20, v15
    v_max_f32 v20, v20, v16
    v_max_f32 v20, v20, v17
    v_xor_b32 v21, 8, v1
    v_lshlrev_b32 v21, 2, v21
    ds_bpermute_b32 v22, v21, v20
    s_waitcnt lgkmcnt(0)
    v_max_f32 v20, v20, v22
    v_xor_b32 v21, 16, v1
    v_lshlrev_b32 v21, 2, v21
    ds_bpermute_b32 v22, v21, v20
    s_waitcnt lgkmcnt(0)
    v_max_f32 v20, v20, v22
    v_sub_f32 v8, v8, v20
    v_mul_f32 v8, 0x3fb8aa3b, v8
    v_exp_f32 v8, v8
    v_sub_f32 v9, v9, v20
    v_mul_f32 v9, 0x3fb8aa3b, v9
    v_exp_f32 v9, v9
    v_sub_f32 v10, v10, v20
    v_mul_f32 v10, 0x3fb8aa3b, v10
    v_exp_f32 v10, v10
    v_sub_f32 v11, v11, v20
    v_mul_f32 v11, 0x3fb8aa3b, v11
    v_exp_f32 v11, v11
    v_sub_f32 v12, v12, v20
    v_mul_f32 v12, 0x3fb8aa3b, v12
    v_exp_f32 v12, v12
    v_sub_f32 v13, v13, v20
    v_mul_f32 v13, 0x3fb8aa3b, v13
    v_exp_f32 v13, v13
    v_sub_f32 v14, v14, v20
    v_mul_f32 v14, 0x3fb8aa3b, v14
    v_exp_f32 v14, v14
    v_sub_f32 v15, v15, v20
    v_mul_f32 v15, 0x3fb8aa3b, v15
    v_exp_f32 v15, v15
    v_sub_f32 v16, v16, v20
    v_mul_f32 v16, 0x3fb8aa3b, v16
    v_exp_f32 v16, v16
    v_sub_f32 v17, v17, v20
    v_mul_f32 v17, 0x3fb8aa3b, v17
    v_exp_f32 v17, v17
    s_nop 0
    v_add_f32 v20, v8, v9
    v_add_f32 v20, v20, v10
    v_add_f32 v20, v20, v11
    v_add_f32 v20, v20, v12
    v_add_f32 v20, v20, v13
    v_add_f32 v20, v20, v14
    v_add_f32 v20, v20, v15
    v_add_f32 v20, v20, v16
    v_add_f32 v20, v20, v17
    v_xor_b32 v21, 8, v1
    v_lshlrev_b32 v21, 2, v21
    ds_bpermute_b32 v22, v21, v20
    s_waitcnt lgkmcnt(0)
    v_add_f32 v20, v20, v22
    v_xor_b32 v21, 16, v1
    v_lshlrev_b32 v21, 2, v21
    ds_bpermute_b32 v22, v21, v20
    s_waitcnt lgkmcnt(0)
    v_add_f32 v20, v20, v22
    v_rcp_f32 v20, v20
    s_nop 0
    v_mul_f32 v8, v8, v20
    v_mul_f32 v9, v9, v20
    v_mul_f32 v10, v10, v20
    v_mul_f32 v11, v11, v20
    v_mul_f32 v12, v12, v20
    v_mul_f32 v13, v13, v20
    v_mul_f32 v14, v14, v20
    v_mul_f32 v15, v15, v20
    v_mul_f32 v16, v16, v20
    v_mul_f32 v17, v17, v20
    v_cvt_pk_bf16_f32 v24, v8, v9
    v_mov_b32 v25, 1
    v_cvt_pk_bf16_f32 v26, v10, v11
    v_mov_b32 v27, 1
    v_cvt_pk_bf16_f32 v28, v12, v13
    v_mov_b32 v29, 1
    v_cvt_pk_bf16_f32 v30, v14, v15
    v_mov_b32 v31, 1
    v_cvt_pk_bf16_f32 v32, v16, v17
    v_mov_b32 v33, 1
    s_lshl_b32 s42, s41, 15
    s_mov_b32 exec_lo, -1
    s_mov_b32 exec_hi, 0
    buffer_store_dwordx2 v[24:25], v46, s[16:19], s42 offen offset:0 sc1
    buffer_store_dwordx2 v[26:27], v46, s[16:19], s42 offen offset:8 sc1
    buffer_store_dwordx2 v[28:29], v46, s[16:19], s42 offen offset:16 sc1
    buffer_store_dwordx2 v[30:31], v46, s[16:19], s42 offen offset:24 sc1
    buffer_store_dwordx2 v[32:33], v46, s[16:19], s42 offen offset:32 sc1
    s_mov_b64 exec, -1
sk_3:
    s_waitcnt vmcnt(0)
    ds_write_b128 v36, v[88:91] offset:43776
    ds_write_b128 v37, v[92:95] offset:43776
    ds_write_b128 v38, v[96:99] offset:43776
    ds_write_b128 v39, v[100:103] offset:43776
    ds_write_b128 v47, v[104:107] offset:43776
    ds_write_b128 v48, v[108:111] offset:43776
    ds_write_b128 v59, v[112:115] offset:43776
    s_add_u32 s46, s46, 28672
    buffer_load_dwordx4 v[88:91], v49, s[20:23], s46 offen offset:0
    s_add_u32 s39, s46, 4096
    buffer_load_dwordx4 v[92:95], v49, s[20:23], s39 offen offset:0
    s_add_u32 s39, s46, 8192
    buffer_load_dwordx4 v[96:99], v49, s[20:23], s39 offen offset:0
    s_add_u32 s39, s46, 12288
    buffer_load_dwordx4 v[100:103], v49, s[20:23], s39 offen offset:0
    s_add_u32 s39, s46, 16384
    buffer_load_dwordx4 v[104:107], v49, s[20:23], s39 offen offset:0
    s_add_u32 s39, s46, 20480
    buffer_load_dwordx4 v[108:111], v49, s[20:23], s39 offen offset:0
    s_add_u32 s39, s46, 24576
    buffer_load_dwordx4 v[112:115], v49, s[20:23], s39 offen offset:0
    s_add_u32 s41, s41, 1
    s_cmp_lg_u32 s41, 0
    s_cbranch_scc1 gm_4_p
    buffer_load_dword v60, v51, s[24:27], 0 offen offset:0
    buffer_load_dword v62, v51, s[24:27], 0 offen offset:1024
    buffer_load_dword v64, v51, s[24:27], 0 offen offset:2048
    buffer_load_dword v66, v51, s[24:27], 0 offen offset:3072
    s_add_u32 s39, 0, 4096
    buffer_load_dword v68, v51, s[24:27], s39 offen offset:0
    s_add_u32 s39, 0, 4096
    buffer_load_dword v70, v51, s[24:27], s39 offen offset:1024
    s_add_u32 s39, 0, 4096
    buffer_load_dword v72, v51, s[24:27], s39 offen offset:2048
    s_waitcnt vmcnt(0)
    s_branch gm_4_w
gm_4_p:
    s_lshl_b32 s42, s41, 14
    s_mov_b32 s40, 0
poll_5:
    buffer_load_dwordx2 v[60:61], v50, s[12:15], s42 offen offset:0 sc1
    buffer_load_dwordx2 v[62:63], v50, s[12:15], s42 offen offset:2048 sc1
    s_add_u32 s39, s42, 4096
    buffer_load_dwordx2 v[64:65], v50, s[12:15], s39 offen offset:0 sc1
    s_add_u32 s39, s42, 4096
    buffer_load_dwordx2 v[66:67], v50, s[12:15], s39 offen offset:2048 sc1
    s_add_u32 s39, s42, 8192
    buffer_load_dwordx2 v[68:69], v50, s[12:15], s39 offen offset:0 sc1
    s_add_u32 s39, s42, 8192
    buffer_load_dwordx2 v[70:71], v50, s[12:15], s39 offen offset:2048 sc1
    s_add_u32 s39, s42, 12288
    buffer_load_dwordx2 v[72:73], v50, s[12:15], s39 offen offset:0 sc1
    s_waitcnt vmcnt(0)
    v_mov_b32 v119, v61
    v_and_b32 v119, v119, v63
    v_and_b32 v119, v119, v65
    v_and_b32 v119, v119, v67
    v_and_b32 v119, v119, v69
    v_and_b32 v119, v119, v71
    v_and_b32 v119, v119, v73
    v_cmp_ne_u32 vcc, 1, v119
    s_add_u32 s40, s40, 1
    s_cmp_gt_u32 s40, 0x100000
    s_cbranch_scc1 poll_5_x
    s_cbranch_vccnz poll_5
poll_5_x:
gm_4_w:
    ds_write_b32 v52, v60 offset:43776
    ds_write_b32 v53, v62 offset:43776
    ds_write_b32 v54, v64 offset:43776
    ds_write_b32 v55, v66 offset:43776
    ds_write_b32 v56, v68 offset:43776
    ds_write_b32 v57, v70 offset:43776
    ds_write_b32 v58, v72 offset:43776
    s_waitcnt lgkmcnt(0)
    s_barrier
    v_mov_b32 v8, 0
    v_mov_b32 v9, 0
    v_mov_b32 v10, 0
    v_mov_b32 v11, 0
    v_mov_b32 v12, 0
    v_mov_b32 v13, 0
    v_mov_b32 v14, 0
    v_mov_b32 v15, 0
    v_mov_b32 v16, 0
    v_mov_b32 v17, 0
    v_mov_b32 v18, 0
    v_mov_b32 v19, 0
    v_mov_b32 v20, 0
    v_mov_b32 v21, 0
    v_mov_b32 v22, 0
    v_mov_b32 v23, 0
    v_mov_b32 v24, 0
    v_mov_b32 v25, 0
    v_mov_b32 v26, 0
    v_mov_b32 v27, 0
    v_mov_b32 v28, 0
    v_mov_b32 v29, 0
    v_mov_b32 v30, 0
    v_mov_b32 v31, 0
    v_mov_b32 v32, 0
    v_mov_b32 v33, 0
    v_mov_b32 v34, 0
    v_mov_b32 v35, 0
    ds_read_b128 v[60:63], v40 offset:43776
    ds_read_b128 v[64:67], v40 offset:43840
    ds_read_b128 v[68:71], v40 offset:43904
    ds_read_b128 v[72:75], v40 offset:43968
    ds_read_b128 v[76:79], v40 offset:44032
    ds_read_b128 v[80:83], v40 offset:44096
    ds_read_b128 v[84:87], v40 offset:44160
    s_waitcnt lgkmcnt(6)
    v_mfma_f32_16x16x32_bf16 v[8:11], a[0:3], v[60:63], v[8:11]
    v_mfma_f32_16x16x32_bf16 v[12:15], a[56:59], v[60:63], v[12:15]
    v_mfma_f32_16x16x32_bf16 v[16:19], a[112:115], v[60:63], v[16:19]
    v_mfma_f32_16x16x32_bf16 v[20:23], a[168:171], v[60:63], v[20:23]
    v_mfma_f32_16x16x32_bf16 v[24:27], a[224:227], v[60:63], v[24:27]
    v_mfma_f32_16x16x32_bf16 v[28:31], v[144:147], v[60:63], v[28:31]
    v_mfma_f32_16x16x32_bf16 v[32:35], v[200:203], v[60:63], v[32:35]
    s_waitcnt lgkmcnt(5)
    v_mfma_f32_16x16x32_bf16 v[8:11], a[4:7], v[64:67], v[8:11]
    v_mfma_f32_16x16x32_bf16 v[12:15], a[60:63], v[64:67], v[12:15]
    v_mfma_f32_16x16x32_bf16 v[16:19], a[116:119], v[64:67], v[16:19]
    v_mfma_f32_16x16x32_bf16 v[20:23], a[172:175], v[64:67], v[20:23]
    v_mfma_f32_16x16x32_bf16 v[24:27], a[228:231], v[64:67], v[24:27]
    v_mfma_f32_16x16x32_bf16 v[28:31], v[148:151], v[64:67], v[28:31]
    v_mfma_f32_16x16x32_bf16 v[32:35], v[204:207], v[64:67], v[32:35]
    s_waitcnt lgkmcnt(4)
    v_mfma_f32_16x16x32_bf16 v[8:11], a[8:11], v[68:71], v[8:11]
    v_mfma_f32_16x16x32_bf16 v[12:15], a[64:67], v[68:71], v[12:15]
    v_mfma_f32_16x16x32_bf16 v[16:19], a[120:123], v[68:71], v[16:19]
    v_mfma_f32_16x16x32_bf16 v[20:23], a[176:179], v[68:71], v[20:23]
    v_mfma_f32_16x16x32_bf16 v[24:27], a[232:235], v[68:71], v[24:27]
    v_mfma_f32_16x16x32_bf16 v[28:31], v[152:155], v[68:71], v[28:31]
    v_mfma_f32_16x16x32_bf16 v[32:35], v[208:211], v[68:71], v[32:35]
    s_waitcnt lgkmcnt(3)
    v_mfma_f32_16x16x32_bf16 v[8:11], a[12:15], v[72:75], v[8:11]
    v_mfma_f32_16x16x32_bf16 v[12:15], a[68:71], v[72:75], v[12:15]
    v_mfma_f32_16x16x32_bf16 v[16:19], a[124:127], v[72:75], v[16:19]
    v_mfma_f32_16x16x32_bf16 v[20:23], a[180:183], v[72:75], v[20:23]
    v_mfma_f32_16x16x32_bf16 v[24:27], a[236:239], v[72:75], v[24:27]
    v_mfma_f32_16x16x32_bf16 v[28:31], v[156:159], v[72:75], v[28:31]
    v_mfma_f32_16x16x32_bf16 v[32:35], v[212:215], v[72:75], v[32:35]
    s_waitcnt lgkmcnt(2)
    v_mfma_f32_16x16x32_bf16 v[8:11], a[16:19], v[76:79], v[8:11]
    v_mfma_f32_16x16x32_bf16 v[12:15], a[72:75], v[76:79], v[12:15]
    v_mfma_f32_16x16x32_bf16 v[16:19], a[128:131], v[76:79], v[16:19]
    v_mfma_f32_16x16x32_bf16 v[20:23], a[184:187], v[76:79], v[20:23]
    v_mfma_f32_16x16x32_bf16 v[24:27], a[240:243], v[76:79], v[24:27]
    v_mfma_f32_16x16x32_bf16 v[28:31], v[160:163], v[76:79], v[28:31]
    v_mfma_f32_16x16x32_bf16 v[32:35], v[216:219], v[76:79], v[32:35]
    s_waitcnt lgkmcnt(1)
    v_mfma_f32_16x16x32_bf16 v[8:11], a[20:23], v[80:83], v[8:11]
    v_mfma_f32_16x16x32_bf16 v[12:15], a[76:79], v[80:83], v[12:15]
    v_mfma_f32_16x16x32_bf16 v[16:19], a[132:135], v[80:83], v[16:19]
    v_mfma_f32_16x16x32_bf16 v[20:23], a[188:191], v[80:83], v[20:23]
    v_mfma_f32_16x16x32_bf16 v[24:27], a[244:247], v[80:83], v[24:27]
    v_mfma_f32_16x16x32_bf16 v[28:31], v[164:167], v[80:83], v[28:31]
    v_mfma_f32_16x16x32_bf16 v[32:35], v[220:223], v[80:83], v[32:35]
    s_waitcnt lgkmcnt(0)
    v_mfma_f32_16x16x32_bf16 v[8:11], a[24:27], v[84:87], v[8:11]
    v_mfma_f32_16x16x32_bf16 v[12:15], a[80:83], v[84:87], v[12:15]
    v_mfma_f32_16x16x32_bf16 v[16:19], a[136:139], v[84:87], v[16:19]
    v_mfma_f32_16x16x32_bf16 v[20:23], a[192:195], v[84:87], v[20:23]
    v_mfma_f32_16x16x32_bf16 v[24:27], a[248:251], v[84:87], v[24:27]
    v_mfma_f32_16x16x32_bf16 v[28:31], v[168:171], v[84:87], v[28:31]
    v_mfma_f32_16x16x32_bf16 v[32:35], v[224:227], v[84:87], v[32:35]
    ds_read_b128 v[60:63], v40 offset:44224
    ds_read_b128 v[64:67], v40 offset:44288
    ds_read_b128 v[68:71], v40 offset:44352
    ds_read_b128 v[72:75], v40 offset:44416
    ds_read_b128 v[76:79], v40 offset:44480
    ds_read_b128 v[80:83], v40 offset:44544
    ds_read_b128 v[84:87], v40 offset:44608
    s_waitcnt lgkmcnt(6)
    v_mfma_f32_16x16x32_bf16 v[8:11], a[28:31], v[60:63], v[8:11]
    v_mfma_f32_16x16x32_bf16 v[12:15], a[84:87], v[60:63], v[12:15]
    v_mfma_f32_16x16x32_bf16 v[16:19], a[140:143], v[60:63], v[16:19]
    v_mfma_f32_16x16x32_bf16 v[20:23], a[196:199], v[60:63], v[20:23]
    v_mfma_f32_16x16x32_bf16 v[24:27], a[252:255], v[60:63], v[24:27]
    v_mfma_f32_16x16x32_bf16 v[28:31], v[172:175], v[60:63], v[28:31]
    v_mfma_f32_16x16x32_bf16 v[32:35], v[228:231], v[60:63], v[32:35]
    s_waitcnt lgkmcnt(5)
    v_mfma_f32_16x16x32_bf16 v[8:11], a[32:35], v[64:67], v[8:11]
    v_mfma_f32_16x16x32_bf16 v[12:15], a[88:91], v[64:67], v[12:15]
    v_mfma_f32_16x16x32_bf16 v[16:19], a[144:147], v[64:67], v[16:19]
    v_mfma_f32_16x16x32_bf16 v[20:23], a[200:203], v[64:67], v[20:23]
    v_mfma_f32_16x16x32_bf16 v[24:27], v[120:123], v[64:67], v[24:27]
    v_mfma_f32_16x16x32_bf16 v[28:31], v[176:179], v[64:67], v[28:31]
    v_mfma_f32_16x16x32_bf16 v[32:35], v[232:235], v[64:67], v[32:35]
    s_waitcnt lgkmcnt(4)
    v_mfma_f32_16x16x32_bf16 v[8:11], a[36:39], v[68:71], v[8:11]
    v_mfma_f32_16x16x32_bf16 v[12:15], a[92:95], v[68:71], v[12:15]
    v_mfma_f32_16x16x32_bf16 v[16:19], a[148:151], v[68:71], v[16:19]
    v_mfma_f32_16x16x32_bf16 v[20:23], a[204:207], v[68:71], v[20:23]
    v_mfma_f32_16x16x32_bf16 v[24:27], v[124:127], v[68:71], v[24:27]
    v_mfma_f32_16x16x32_bf16 v[28:31], v[180:183], v[68:71], v[28:31]
    v_mfma_f32_16x16x32_bf16 v[32:35], v[236:239], v[68:71], v[32:35]
    s_waitcnt lgkmcnt(3)
    v_mfma_f32_16x16x32_bf16 v[8:11], a[40:43], v[72:75], v[8:11]
    v_mfma_f32_16x16x32_bf16 v[12:15], a[96:99], v[72:75], v[12:15]
    v_mfma_f32_16x16x32_bf16 v[16:19], a[152:155], v[72:75], v[16:19]
    v_mfma_f32_16x16x32_bf16 v[20:23], a[208:211], v[72:75], v[20:23]
    v_mfma_f32_16x16x32_bf16 v[24:27], v[128:131], v[72:75], v[24:27]
    v_mfma_f32_16x16x32_bf16 v[28:31], v[184:187], v[72:75], v[28:31]
    v_mfma_f32_16x16x32_bf16 v[32:35], v[240:243], v[72:75], v[32:35]
    s_waitcnt lgkmcnt(2)
    v_mfma_f32_16x16x32_bf16 v[8:11], a[44:47], v[76:79], v[8:11]
    v_mfma_f32_16x16x32_bf16 v[12:15], a[100:103], v[76:79], v[12:15]
    v_mfma_f32_16x16x32_bf16 v[16:19], a[156:159], v[76:79], v[16:19]
    v_mfma_f32_16x16x32_bf16 v[20:23], a[212:215], v[76:79], v[20:23]
    v_mfma_f32_16x16x32_bf16 v[24:27], v[132:135], v[76:79], v[24:27]
    v_mfma_f32_16x16x32_bf16 v[28:31], v[188:191], v[76:79], v[28:31]
    v_mfma_f32_16x16x32_bf16 v[32:35], v[244:247], v[76:79], v[32:35]
    s_waitcnt lgkmcnt(1)
    v_mfma_f32_16x16x32_bf16 v[8:11], a[48:51], v[80:83], v[8:11]
    v_mfma_f32_16x16x32_bf16 v[12:15], a[104:107], v[80:83], v[12:15]
    v_mfma_f32_16x16x32_bf16 v[16:19], a[160:163], v[80:83], v[16:19]
    v_mfma_f32_16x16x32_bf16 v[20:23], a[216:219], v[80:83], v[20:23]
    v_mfma_f32_16x16x32_bf16 v[24:27], v[136:139], v[80:83], v[24:27]
    v_mfma_f32_16x16x32_bf16 v[28:31], v[192:195], v[80:83], v[28:31]
    v_mfma_f32_16x16x32_bf16 v[32:35], v[248:251], v[80:83], v[32:35]
    s_waitcnt lgkmcnt(0)
    v_mfma_f32_16x16x32_bf16 v[8:11], a[52:55], v[84:87], v[8:11]
    v_mfma_f32_16x16x32_bf16 v[12:15], a[108:111], v[84:87], v[12:15]
    v_mfma_f32_16x16x32_bf16 v[16:19], a[164:167], v[84:87], v[16:19]
    v_mfma_f32_16x16x32_bf16 v[20:23], a[220:223], v[84:87], v[20:23]
    v_mfma_f32_16x16x32_bf16 v[24:27], v[140:143], v[84:87], v[24:27]
    v_mfma_f32_16x16x32_bf16 v[28:31], v[196:199], v[84:87], v[28:31]
    v_mfma_f32_16x16x32_bf16 v[32:35], v[252:255], v[84:87], v[32:35]
    s_nop 7
    v_cvt_pk_bf16_f32 v8, v8, v9
    v_cvt_pk_bf16_f32 v9, v10, v11
    v_cvt_pk_bf16_f32 v12, v12, v13
    v_cvt_pk_bf16_f32 v13, v14, v15
    v_cvt_pk_bf16_f32 v16, v16, v17
    v_cvt_pk_bf16_f32 v17, v18, v19
    v_cvt_pk_bf16_f32 v20, v20, v21
    v_cvt_pk_bf16_f32 v21, v22, v23
    v_cvt_pk_bf16_f32 v24, v24, v25
    v_cvt_pk_bf16_f32 v25, v26, v27
    v_cvt_pk_bf16_f32 v28, v28, v29
    v_cvt_pk_bf16_f32 v29, v30, v31
    v_cvt_pk_bf16_f32 v32, v32, v33
    v_cvt_pk_bf16_f32 v33, v34, v35
    v_mov_b32 v10, v12
    v_mov_b32 v11, v13
    v_mov_b32 v18, v20
    v_mov_b32 v19, v21
    v_mov_b32 v26, v28
    v_mov_b32 v27, v29
    v_mov_b32 v34, 0
    v_mov_b32 v35, 0
    v_mov_b32 v76, 0
    v_mov_b32 v77, 0
    v_mov_b32 v78, 0
    v_mov_b32 v79, 0
    v_mov_b32 v80, 0
    v_mov_b32 v81, 0
    v_mov_b32 v82, 0
    v_mov_b32 v83, 0
    v_mov_b32 v84, 0
    v_mov_b32 v85, 0
    v_mov_b32 v86, 0
    v_mov_b32 v87, 0
    v_add_u32 v41, 43776, v41
    ds_read_b64 v[60:61], v41 offset:0
    ds_read_b64 v[62:63], v41 offset:32
    ds_read_b64 v[64:65], v41 offset:64
    ds_read_b64 v[66:67], v41 offset:96
    ds_read_b64 v[68:69], v41 offset:128
    ds_read_b64 v[70:71], v41 offset:160
    ds_read_b64 v[72:73], v41 offset:192
    ds_read_b64 v[74:75], v41 offset:224
    s_waitcnt lgkmcnt(0)
    v_mfma_f32_16x16x32_bf16 v[76:79], v[60:63], v[8:11], v[76:79]
    v_mfma_f32_16x16x32_bf16 v[76:79], v[64:67], v[16:19], v[76:79]
    v_mfma_f32_16x16x32_bf16 v[76:79], v[68:71], v[24:27], v[76:79]
    v_mfma_f32_16x16x32_bf16 v[76:79], v[72:75], v[32:35], v[76:79]
    ds_read_b64 v[60:61], v41 offset:14592
    ds_read_b64 v[62:63], v41 offset:14624
    ds_read_b64 v[64:65], v41 offset:14656
    ds_read_b64 v[66:67], v41 offset:14688
    ds_read_b64 v[68:69], v41 offset:14720
    ds_read_b64 v[70:71], v41 offset:14752
    ds_read_b64 v[72:73], v41 offset:14784
    ds_read_b64 v[74:75], v41 offset:14816
    s_waitcnt lgkmcnt(0)
    v_mfma_f32_16x16x32_bf16 v[80:83], v[60:63], v[8:11], v[80:83]
    v_mfma_f32_16x16x32_bf16 v[80:83], v[64:67], v[16:19], v[80:83]
    v_mfma_f32_16x16x32_bf16 v[80:83], v[68:71], v[24:27], v[80:83]
    v_mfma_f32_16x16x32_bf16 v[80:83], v[72:75], v[32:35], v[80:83]
    ds_read_b64 v[60:61], v41 offset:29184
    ds_read_b64 v[62:63], v41 offset:29216
    ds_read_b64 v[64:65], v41 offset:29248
    ds_read_b64 v[66:67], v41 offset:29280
    ds_read_b64 v[68:69], v41 offset:29312
    ds_read_b64 v[70:71], v41 offset:29344
    ds_read_b64 v[72:73], v41 offset:29376
    ds_read_b64 v[74:75], v41 offset:29408
    s_waitcnt lgkmcnt(0)
    v_mfma_f32_16x16x32_bf16 v[84:87], v[60:63], v[8:11], v[84:87]
    v_mfma_f32_16x16x32_bf16 v[84:87], v[64:67], v[16:19], v[84:87]
    v_mfma_f32_16x16x32_bf16 v[84:87], v[68:71], v[24:27], v[84:87]
    v_mfma_f32_16x16x32_bf16 v[84:87], v[72:75], v[32:35], v[84:87]
    v_subrev_u32 v41, 43776, v41
    s_nop 7
    s_nop 3
    ds_write_b32 v42, v76 offset:0
    ds_write_b32 v42, v77 offset:256
    ds_write_b32 v42, v78 offset:512
    ds_write_b32 v42, v79 offset:768
    ds_write_b32 v42, v80 offset:4096
    ds_write_b32 v42, v81 offset:4352
    ds_write_b32 v42, v82 offset:4608
    ds_write_b32 v42, v83 offset:4864
    ds_write_b32 v42, v84 offset:8192
    ds_write_b32 v42, v85 offset:8448
    ds_write_b32 v42, v86 offset:8704
    ds_write_b32 v42, v87 offset:8960
    s_waitcnt lgkmcnt(0)
    s_barrier
    s_cmp_lg_u32 s43, 0
    s_cbranch_scc1 sk_6
    ds_read_b128 v[60:63], v45 offset:0
    ds_read_b128 v[64:67], v45 offset:256
    ds_read_b128 v[68:71], v45 offset:512
    ds_read_b128 v[72:75], v45 offset:768
    ds_read_b128 v[76:79], v45 offset:1024
    ds_read_b128 v[80:83], v45 offset:1280
    ds_read_b128 v[84:87], v45 offset:1536
    ds_read_b128 v[24:27], v45 offset:1792
    ds_read_b128 v[28:31], v45 offset:2048
    ds_read_b128 v[32:35], v45 offset:2304
    s_waitcnt lgkmcnt(9)
    v_add_f32 v60, v60, v61
    v_add_f32 v62, v62, v63
    v_add_f32 v8, v60, v62
    s_waitcnt lgkmcnt(8)
    v_add_f32 v64, v64, v65
    v_add_f32 v66, v66, v67
    v_add_f32 v9, v64, v66
    s_waitcnt lgkmcnt(7)
    v_add_f32 v68, v68, v69
    v_add_f32 v70, v70, v71
    v_add_f32 v10, v68, v70
    s_waitcnt lgkmcnt(6)
    v_add_f32 v72, v72, v73
    v_add_f32 v74, v74, v75
    v_add_f32 v11, v72, v74
    s_waitcnt lgkmcnt(5)
    v_add_f32 v76, v76, v77
    v_add_f32 v78, v78, v79
    v_add_f32 v12, v76, v78
    s_waitcnt lgkmcnt(4)
    v_add_f32 v80, v80, v81
    v_add_f32 v82, v82, v83
    v_add_f32 v13, v80, v82
    s_waitcnt lgkmcnt(3)
    v_add_f32 v84, v84, v85
    v_add_f32 v86, v86, v87
    v_add_f32 v14, v84, v86
    s_waitcnt lgkmcnt(2)
    v_add_f32 v24, v24, v25
    v_add_f32 v26, v26, v27
    v_add_f32 v15, v24, v26
    s_waitcnt lgkmcnt(1)
    v_add_f32 v28, v28, v29
    v_add_f32 v30, v30, v31
    v_add_f32 v16, v28, v30
    s_waitcnt lgkmcnt(0)
    v_add_f32 v32, v32, v33
    v_add_f32 v34, v34, v35
    v_add_f32 v17, v32, v34
    v_max_f32 v20, v8, v9
    v_max_f32 v20, v20, v10
    v_max_f32 v20, v20, v11
    v_max_f32 v20, v20, v12
    v_max_f32 v20, v20, v13
    v_max_f32 v20, v20, v14
    v_max_f32 v20, v20, v15
    v_max_f32 v20, v20, v16
    v_max_f32 v20, v20, v17
    v_xor_b32 v21, 8, v1
    v_lshlrev_b32 v21, 2, v21
    ds_bpermute_b32 v22, v21, v20
    s_waitcnt lgkmcnt(0)
    v_max_f32 v20, v20, v22
    v_xor_b32 v21, 16, v1
    v_lshlrev_b32 v21, 2, v21
    ds_bpermute_b32 v22, v21, v20
    s_waitcnt lgkmcnt(0)
    v_max_f32 v20, v20, v22
    v_sub_f32 v8, v8, v20
    v_mul_f32 v8, 0x3fb8aa3b, v8
    v_exp_f32 v8, v8
    v_sub_f32 v9, v9, v20
    v_mul_f32 v9, 0x3fb8aa3b, v9
    v_exp_f32 v9, v9
    v_sub_f32 v10, v10, v20
    v_mul_f32 v10, 0x3fb8aa3b, v10
    v_exp_f32 v10, v10
    v_sub_f32 v11, v11, v20
    v_mul_f32 v11, 0x3fb8aa3b, v11
    v_exp_f32 v11, v11
    v_sub_f32 v12, v12, v20
    v_mul_f32 v12, 0x3fb8aa3b, v12
    v_exp_f32 v12, v12
    v_sub_f32 v13, v13, v20
    v_mul_f32 v13, 0x3fb8aa3b, v13
    v_exp_f32 v13, v13
    v_sub_f32 v14, v14, v20
    v_mul_f32 v14, 0x3fb8aa3b, v14
    v_exp_f32 v14, v14
    v_sub_f32 v15, v15, v20
    v_mul_f32 v15, 0x3fb8aa3b, v15
    v_exp_f32 v15, v15
    v_sub_f32 v16, v16, v20
    v_mul_f32 v16, 0x3fb8aa3b, v16
    v_exp_f32 v16, v16
    v_sub_f32 v17, v17, v20
    v_mul_f32 v17, 0x3fb8aa3b, v17
    v_exp_f32 v17, v17
    s_nop 0
    v_add_f32 v20, v8, v9
    v_add_f32 v20, v20, v10
    v_add_f32 v20, v20, v11
    v_add_f32 v20, v20, v12
    v_add_f32 v20, v20, v13
    v_add_f32 v20, v20, v14
    v_add_f32 v20, v20, v15
    v_add_f32 v20, v20, v16
    v_add_f32 v20, v20, v17
    v_xor_b32 v21, 8, v1
    v_lshlrev_b32 v21, 2, v21
    ds_bpermute_b32 v22, v21, v20
    s_waitcnt lgkmcnt(0)
    v_add_f32 v20, v20, v22
    v_xor_b32 v21, 16, v1
    v_lshlrev_b32 v21, 2, v21
    ds_bpermute_b32 v22, v21, v20
    s_waitcnt lgkmcnt(0)
    v_add_f32 v20, v20, v22
    v_rcp_f32 v20, v20
    s_nop 0
    v_mul_f32 v8, v8, v20
    v_mul_f32 v9, v9, v20
    v_mul_f32 v10, v10, v20
    v_mul_f32 v11, v11, v20
    v_mul_f32 v12, v12, v20
    v_mul_f32 v13, v13, v20
    v_mul_f32 v14, v14, v20
    v_mul_f32 v15, v15, v20
    v_mul_f32 v16, v16, v20
    v_mul_f32 v17, v17, v20
    v_cvt_pk_bf16_f32 v24, v8, v9
    v_mov_b32 v25, 1
    v_cvt_pk_bf16_f32 v26, v10, v11
    v_mov_b32 v27, 1
    v_cvt_pk_bf16_f32 v28, v12, v13
    v_mov_b32 v29, 1
    v_cvt_pk_bf16_f32 v30, v14, v15
    v_mov_b32 v31, 1
    v_cvt_pk_bf16_f32 v32, v16, v17
    v_mov_b32 v33, 1
    s_lshl_b32 s42, s41, 15
    s_mov_b32 exec_lo, -1
    s_mov_b32 exec_hi, 0
    buffer_store_dwordx2 v[24:25], v46, s[16:19], s42 offen offset:0 sc1
    buffer_store_dwordx2 v[26:27], v46, s[16:19], s42 offen offset:8 sc1
    buffer_store_dwordx2 v[28:29], v46, s[16:19], s42 offen offset:16 sc1
    buffer_store_dwordx2 v[30:31], v46, s[16:19], s42 offen offset:24 sc1
    buffer_store_dwordx2 v[32:33], v46, s[16:19], s42 offen offset:32 sc1
    s_mov_b64 exec, -1
sk_6:
    s_waitcnt vmcnt(0)
    ds_write_b128 v36, v[88:91] offset:0
    ds_write_b128 v37, v[92:95] offset:0
    ds_write_b128 v38, v[96:99] offset:0
    ds_write_b128 v39, v[100:103] offset:0
    ds_write_b128 v47, v[104:107] offset:0
    ds_write_b128 v48, v[108:111] offset:0
    ds_write_b128 v59, v[112:115] offset:0
    s_add_u32 s46, s46, 28672
    buffer_load_dwordx4 v[88:91], v49, s[20:23], s46 offen offset:0
    s_add_u32 s39, s46, 4096
    buffer_load_dwordx4 v[92:95], v49, s[20:23], s39 offen offset:0
    s_add_u32 s39, s46, 8192
    buffer_load_dwordx4 v[96:99], v49, s[20:23], s39 offen offset:0
    s_add_u32 s39, s46, 12288
    buffer_load_dwordx4 v[100:103], v49, s[20:23], s39 offen offset:0
    s_add_u32 s39, s46, 16384
    buffer_load_dwordx4 v[104:107], v49, s[20:23], s39 offen offset:0
    s_add_u32 s39, s46, 20480
    buffer_load_dwordx4 v[108:111], v49, s[20:23], s39 offen offset:0
    s_add_u32 s39, s46, 24576
    buffer_load_dwordx4 v[112:115], v49, s[20:23], s39 offen offset:0
    s_add_u32 s41, s41, 1
    s_cmp_lt_u32 s41, 64
    s_cbranch_scc1 chain_kernel_sloop
    s_branch chain_kernel_done
chain_kernel_val:
    s_load_dwordx2 s[8:9], s[0:1], 112
    s_waitcnt lgkmcnt(0)
    s_add_u32 s8, s8, 0x900000
    s_addc_u32 s9, s9, 0
    s_and_b32 s9, s9, 0xffff
    s_mov_b32 s10, 0x620000
    s_mov_b32 s11, 0x00020000
    s_load_dwordx2 s[20:21], s[0:1], 112
    s_waitcnt lgkmcnt(0)
    s_add_u32 s20, s20, 0x4000000
    s_addc_u32 s21, s21, 0
    s_and_b32 s21, s21, 0xffff
    s_mov_b32 s22, 0x1c00000
    s_mov_b32 s23, 0x00020000
    s_load_dwordx2 s[28:29], s[0:1], 112
    s_waitcnt lgkmcnt(0)
    s_add_u32 s28, s28, 0x6800000
    s_addc_u32 s29, s29, 0
    s_and_b32 s29, s29, 0xffff
    s_mov_b32 s30, 0x700000
    s_mov_b32 s31, 0x00020000
    s_sub_u32 s47, s2, 16
    s_mul_i32 s44, s43, 1605632
    s_mul_i32 s45, s47, 14336
    s_add_u32 s44, s44, s45
    v_mul_u32_u24 v6, 896, v3
    v_lshl_add_u32 v6, v4, 4, v6
    v_add_u32 v6, s44, v6
    buffer_load_dwordx4 a[0:3], v6, s[8:11], 0 offen offset:0
    buffer_load_dwordx4 a[4:7], v6, s[8:11], 0 offen offset:64
    buffer_load_dwordx4 a[8:11], v6, s[8:11], 0 offen offset:128
    buffer_load_dwordx4 a[12:15], v6, s[8:11], 0 offen offset:192
    buffer_load_dwordx4 a[16:19], v6, s[8:11], 0 offen offset:256
    buffer_load_dwordx4 a[20:23], v6, s[8:11], 0 offen offset:320
    buffer_load_dwordx4 a[24:27], v6, s[8:11], 0 offen offset:384
    buffer_load_dwordx4 a[28:31], v6, s[8:11], 0 offen offset:448
    buffer_load_dwordx4 a[32:35], v6, s[8:11], 0 offen offset:512
    buffer_load_dwordx4 a[36:39], v6, s[8:11], 0 offen offset:576
    buffer_load_dwordx4 a[40:43], v6, s[8:11], 0 offen offset:640
    buffer_load_dwordx4 a[44:47], v6, s[8:11], 0 offen offset:704
    buffer_load_dwordx4 a[48:51], v6, s[8:11], 0 offen offset:768
    buffer_load_dwordx4 a[52:55], v6, s[8:11], 0 offen offset:832
    v_add_u32 v6, 401408, v6
    buffer_load_dwordx4 a[56:59], v6, s[8:11], 0 offen offset:0
    buffer_load_dwordx4 a[60:63], v6, s[8:11], 0 offen offset:64
    buffer_load_dwordx4 a[64:67], v6, s[8:11], 0 offen offset:128
    buffer_load_dwordx4 a[68:71], v6, s[8:11], 0 offen offset:192
    buffer_load_dwordx4 a[72:75], v6, s[8:11], 0 offen offset:256
    buffer_load_dwordx4 a[76:79], v6, s[8:11], 0 offen offset:320
    buffer_load_dwordx4 a[80:83], v6, s[8:11], 0 offen offset:384
    buffer_load_dwordx4 a[84:87], v6, s[8:11], 0 offen offset:448
    buffer_load_dwordx4 a[88:91], v6, s[8:11], 0 offen offset:512
    buffer_load_dwordx4 a[92:95], v6, s[8:11], 0 offen offset:576
    buffer_load_dwordx4 a[96:99], v6, s[8:11], 0 offen offset:640
    buffer_load_dwordx4 a[100:103], v6, s[8:11], 0 offen offset:704
    buffer_load_dwordx4 a[104:107], v6, s[8:11], 0 offen offset:768
    buffer_load_dwordx4 a[108:111], v6, s[8:11], 0 offen offset:832
    v_add_u32 v6, 401408, v6
    buffer_load_dwordx4 a[112:115], v6, s[8:11], 0 offen offset:0
    buffer_load_dwordx4 a[116:119], v6, s[8:11], 0 offen offset:64
    buffer_load_dwordx4 a[120:123], v6, s[8:11], 0 offen offset:128
    buffer_load_dwordx4 a[124:127], v6, s[8:11], 0 offen offset:192
    buffer_load_dwordx4 a[128:131], v6, s[8:11], 0 offen offset:256
    buffer_load_dwordx4 a[132:135], v6, s[8:11], 0 offen offset:320
    buffer_load_dwordx4 a[136:139], v6, s[8:11], 0 offen offset:384
    buffer_load_dwordx4 a[140:143], v6, s[8:11], 0 offen offset:448
    buffer_load_dwordx4 a[144:147], v6, s[8:11], 0 offen offset:512
    buffer_load_dwordx4 a[148:151], v6, s[8:11], 0 offen offset:576
    buffer_load_dwordx4 a[152:155], v6, s[8:11], 0 offen offset:640
    buffer_load_dwordx4 a[156:159], v6, s[8:11], 0 offen offset:704
    buffer_load_dwordx4 a[160:163], v6, s[8:11], 0 offen offset:768
    buffer_load_dwordx4 a[164:167], v6, s[8:11], 0 offen offset:832
    v_add_u32 v6, 401408, v6
    buffer_load_dwordx4 a[168:171], v6, s[8:11], 0 offen offset:0
    buffer_load_dwordx4 a[172:175], v6, s[8:11], 0 offen offset:64
    buffer_load_dwordx4 a[176:179], v6, s[8:11], 0 offen offset:128
    buffer_load_dwordx4 a[180:183], v6, s[8:11], 0 offen offset:192
    buffer_load_dwordx4 a[184:187], v6, s[8:11], 0 offen offset:256
    buffer_load_dwordx4 a[188:191], v6, s[8:11], 0 offen offset:320
    buffer_load_dwordx4 a[192:195], v6, s[8:11], 0 offen offset:384
    buffer_load_dwordx4 a[196:199], v6, s[8:11], 0 offen offset:448
    buffer_load_dwordx4 a[200:203], v6, s[8:11], 0 offen offset:512
    buffer_load_dwordx4 a[204:207], v6, s[8:11], 0 offen offset:576
    buffer_load_dwordx4 a[208:211], v6, s[8:11], 0 offen offset:640
    buffer_load_dwordx4 a[212:215], v6, s[8:11], 0 offen offset:704
    buffer_load_dwordx4 a[216:219], v6, s[8:11], 0 offen offset:768
    buffer_load_dwordx4 a[220:223], v6, s[8:11], 0 offen offset:832
    v_add_u32 v6, 401408, v6
    v_add_u32 v6, 0, v0
    v_lshrrev_b32 v7, 6, v6
    v_bfe_u32 v8, v6, 2, 4
    v_and_b32 v9, 3, v6
    v_mul_u32_u24 v10, 448, v7
    v_add_u32 v10, v10, v8
    s_lshl_b32 s44, s47, 4
    v_add_u32 v10, s44, v10
    v_lshlrev_b32 v10, 12, v10
    v_lshl_add_u32 v36, v9, 4, v10
    v_mul_u32_u24 v10, 1296, v8
    v_mul_u32_u24 v11, 80, v7
    v_add_u32 v10, v10, v11
    v_lshl_add_u32 v10, v9, 4, v10
    v_add_u32 v40, 14592, v10
    v_add_u32 v6, 256, v0
    v_lshrrev_b32 v7, 6, v6
    v_bfe_u32 v8, v6, 2, 4
    v_and_b32 v9, 3, v6
    v_mul_u32_u24 v10, 448, v7
    v_add_u32 v10, v10, v8
    s_lshl_b32 s44, s47, 4
    v_add_u32 v10, s44, v10
    v_lshlrev_b32 v10, 12, v10
    v_lshl_add_u32 v37, v9, 4, v10
    v_mul_u32_u24 v10, 1296, v8
    v_mul_u32_u24 v11, 80, v7
    v_add_u32 v10, v10, v11
    v_lshl_add_u32 v10, v9, 4, v10
    v_add_u32 v41, 14592, v10
    v_add_u32 v6, 512, v0
    v_lshrrev_b32 v7, 6, v6
    v_bfe_u32 v8, v6, 2, 4
    v_and_b32 v9, 3, v6
    v_mul_u32_u24 v10, 448, v7
    v_add_u32 v10, v10, v8
    s_lshl_b32 s44, s47, 4
    v_add_u32 v10, s44, v10
    v_lshlrev_b32 v10, 12, v10
    v_lshl_add_u32 v38, v9, 4, v10
    v_mul_u32_u24 v10, 1296, v8
    v_mul_u32_u24 v11, 80, v7
    v_add_u32 v10, v10, v11
    v_lshl_add_u32 v10, v9, 4, v10
    v_add_u32 v42, 14592, v10
    v_add_u32 v6, 768, v0
    v_lshrrev_b32 v7, 6, v6
    v_bfe_u32 v8, v6, 2, 4
    v_and_b32 v9, 3, v6
    v_mul_u32_u24 v10, 448, v7
    v_add_u32 v10, v10, v8
    s_lshl_b32 s44, s47, 4
    v_add_u32 v10, s44, v10
    v_lshlrev_b32 v10, 12, v10
    v_lshl_add_u32 v39, v9, 4, v10
    v_mul_u32_u24 v10, 1296, v8
    v_mul_u32_u24 v11, 80, v7
    v_add_u32 v10, v10, v11
    v_lshl_add_u32 v10, v9, 4, v10
    v_add_u32 v43, 14592, v10
    s_load_dwordx2 s[32:33], s[0:1], 104
    s_waitcnt lgkmcnt(0)
    s_and_b32 s33, s33, 0xffff
    s_mov_b32 s34, 0x100
    s_mov_b32 s35, 0x00020000
    s_mov_b32 s46, 0
    s_and_b32 s44, s46, 255
    s_cmp_lg_u32 s44, 0
    s_cbranch_scc1 vw_7_go
    s_lshr_b32 s44, s46, 6
    v_mov_b32 v6, s44
    s_mov_b32 s40, 0
vw_7:
    buffer_load_dword v7, v6, s[32:35], 0 offen sc1
    s_waitcnt vmcnt(0)
    v_cmp_ne_u32 vcc, 56, v7
    s_add_u32 s40, s40, 1
    s_cmp_gt_u32 s40, 0x100000
    s_cbranch_scc1 vw_7_go
    s_cbranch_vccnz vw_7
vw_7_go:
    buffer_load_dwordx4 v[88:91], v36, s[20:23], s46 offen sc1
    buffer_load_dwordx4 v[92:95], v37, s[20:23], s46 offen sc1
    buffer_load_dwordx4 v[96:99], v38, s[20:23], s46 offen sc1
    buffer_load_dwordx4 v[100:103], v39, s[20:23], s46 offen sc1
    v_add_u32 v6, 0, v0
    v_lshlrev_b32 v6, 1, v6
    s_mov_b32 s44, 0xccccccd
    v_mul_hi_u32 v7, v6, s44
    v_mul_u32_u24 v8, 20, v7
    v_sub_u32 v8, v6, v8
    v_and_b32 v9, 7, v7
    v_lshrrev_b32 v7, 3, v7
    v_mul_u32_u24 v9, 1296, v9
    v_mul_u32_u24 v7, 80, v7
    v_add_u32 v9, v9, v7
    v_lshl_add_u32 v9, v8, 2, v9
    v_add_u32 v44, 35328, v9
    v_add_u32 v6, 256, v0
    v_lshlrev_b32 v6, 1, v6
    s_mov_b32 s44, 0xccccccd
    v_mul_hi_u32 v7, v6, s44
    v_mul_u32_u24 v8, 20, v7
    v_sub_u32 v8, v6, v8
    v_and_b32 v9, 7, v7
    v_lshrrev_b32 v7, 3, v7
    v_mul_u32_u24 v9, 1296, v9
    v_mul_u32_u24 v7, 80, v7
    v_add_u32 v9, v9, v7
    v_lshl_add_u32 v9, v8, 2, v9
    v_add_u32 v45, 35328, v9
    v_add_u32 v6, 512, v0
    v_lshlrev_b32 v6, 1, v6
    s_mov_b32 s44, 0xccccccd
    v_mul_hi_u32 v7, v6, s44
    v_mul_u32_u24 v8, 20, v7
    v_sub_u32 v8, v6, v8
    v_and_b32 v9, 7, v7
    v_lshrrev_b32 v7, 3, v7
    v_mul_u32_u24 v9, 1296, v9
    v_mul_u32_u24 v7, 80, v7
    v_add_u32 v9, v9, v7
    v_lshl_add_u32 v9, v8, 2, v9
    v_add_u32 v46, 35328, v9
    v_add_u32 v6, 768, v0
    v_lshlrev_b32 v6, 1, v6
    s_mov_b32 s44, 0xccccccd
    v_mul_hi_u32 v7, v6, s44
    v_mul_u32_u24 v8, 20, v7
    v_sub_u32 v8, v6, v8
    v_and_b32 v9, 7, v7
    v_lshrrev_b32 v7, 3, v7
    v_mul_u32_u24 v9, 1296, v9
    v_mul_u32_u24 v7, 80, v7
    v_add_u32 v9, v9, v7
    v_lshl_add_u32 v9, v8, 2, v9
    v_add_u32 v47, 35328, v9
    v_add_u32 v6, 1024, v0
    v_lshlrev_b32 v6, 1, v6
    s_mov_b32 s44, 0xccccccd
    v_mul_hi_u32 v7, v6, s44
    v_mul_u32_u24 v8, 20, v7
    v_sub_u32 v8, v6, v8
    v_and_b32 v9, 7, v7
    v_lshrrev_b32 v7, 3, v7
    v_mul_u32_u24 v9, 1296, v9
    v_mul_u32_u24 v7, 80, v7
    v_add_u32 v9, v9, v7
    v_lshl_add_u32 v9, v8, 2, v9
    v_add_u32 v48, 35328, v9
    v_lshlrev_b32 v49, 4, v0
    v_mul_u32_u24 v30, 912, v3
    v_lshl_add_u32 v30, v4, 4, v30
    v_mul_u32_u24 v31, 1296, v3
    v_lshl_add_u32 v31, v4, 4, v31
    v_mul_u32_u24 v32, 1296, v3
    v_lshl_add_u32 v32, v4, 3, v32
    v_mul_u32_u24 v6, 320, v2
    v_add_u32 v32, v32, v6
    v_add_u32 v32, 14656, v32
    v_mul_u32_u24 v33, 1792, v2
    v_add_u32 v33, v33, v3
    s_lshl_b32 s44, s47, 4
    v_add_u32 v33, s44, v33
    v_lshlrev_b32 v33, 4, v33
    v_lshl_add_u32 v33, v4, 3, v33
    v_mul_u32_u24 v34, 224, v3
    v_lshl_add_u32 v34, v4, 1, v34
    s_lshl_b32 s44, s47, 3
    v_add_u32 v34, s44, v34
    v_lshlrev_b32 v34, 3, v34
    s_mov_b32 s41, 0
chain_kernel_vloop:
    s_waitcnt vmcnt(0)
    ds_write_b128 v40, v[88:91]
    ds_write_b128 v41, v[92:95]
    ds_write_b128 v42, v[96:99]
    ds_write_b128 v43, v[100:103]
    s_add_u32 s46, s46, 64
    s_min_u32 s46, s46, 4032
    s_and_b32 s44, s46, 255
    s_cmp_lg_u32 s44, 0
    s_cbranch_scc1 vw_8_go
    s_lshr_b32 s44, s46, 6
    v_mov_b32 v6, s44
    s_mov_b32 s40, 0
vw_8:
    buffer_load_dword v7, v6, s[32:35], 0 offen sc1
    s_waitcnt vmcnt(0)
    v_cmp_ne_u32 vcc, 56, v7
    s_add_u32 s40, s40, 1
    s_cmp_gt_u32 s40, 0x100000
    s_cbranch_scc1 vw_8_go
    s_cbranch_vccnz vw_8
vw_8_go:
    buffer_load_dwordx4 v[88:91], v36, s[20:23], s46 offen sc1
    buffer_load_dwordx4 v[92:95], v37, s[20:23], s46 offen sc1
    buffer_load_dwordx4 v[96:99], v38, s[20:23], s46 offen sc1
    buffer_load_dwordx4 v[100:103], v39, s[20:23], s46 offen sc1
    s_cmp_lg_u32 s41, 0
    s_cbranch_scc1 gm_9_p
    buffer_load_dword v60, v51, s[24:27], 0 offen offset:0
    buffer_load_dword v62, v51, s[24:27], 0 offen offset:1024
    buffer_load_dword v64, v51, s[24:27], 0 offen offset:2048
    buffer_load_dword v66, v51, s[24:27], 0 offen offset:3072
    s_add_u32 s39, 0, 4096
    buffer_load_dword v68, v51, s[24:27], s39 offen offset:0
    s_add_u32 s39, 0, 4096
    buffer_load_dword v70, v51, s[24:27], s39 offen offset:1024
    s_add_u32 s39, 0, 4096
    buffer_load_dword v72, v51, s[24:27], s39 offen offset:2048
    s_waitcnt vmcnt(0)
    s_branch gm_9_w
gm_9_p:
    s_lshl_b32 s42, s41, 14
    s_mov_b32 s40, 0
poll_10:
    buffer_load_dwordx2 v[60:61], v50, s[12:15], s42 offen offset:0 sc1
    buffer_load_dwordx2 v[62:63], v50, s[12:15], s42 offen offset:2048 sc1
    s_add_u32 s39, s42, 4096
    buffer_load_dwordx2 v[64:65], v50, s[12:15], s39 offen offset:0 sc1
    s_add_u32 s39, s42, 4096
    buffer_load_dwordx2 v[66:67], v50, s[12:15], s39 offen offset:2048 sc1
    s_add_u32 s39, s42, 8192
    buffer_load_dwordx2 v[68:69], v50, s[12:15], s39 offen offset:0 sc1
    s_add_u32 s39, s42, 8192
    buffer_load_dwordx2 v[70:71], v50, s[12:15], s39 offen offset:2048 sc1
    s_add_u32 s39, s42, 12288
    buffer_load_dwordx2 v[72:73], v50, s[12:15], s39 offen offset:0 sc1
    s_waitcnt vmcnt(0)
    v_mov_b32 v119, v61
    v_and_b32 v119, v119, v63
    v_and_b32 v119, v119, v65
    v_and_b32 v119, v119, v67
    v_and_b32 v119, v119, v69
    v_and_b32 v119, v119, v71
    v_and_b32 v119, v119, v73
    v_cmp_ne_u32 vcc, 1, v119
    s_add_u32 s40, s40, 1
    s_cmp_gt_u32 s40, 0x100000
    s_cbranch_scc1 poll_10_x
    s_cbranch_vccnz poll_10
poll_10_x:
gm_9_w:
    ds_write_b32 v52, v60 offset:0
    ds_write_b32 v53, v62 offset:0
    ds_write_b32 v54, v64 offset:0
    ds_write_b32 v55, v66 offset:0
    ds_write_b32 v56, v68 offset:0
    ds_write_b32 v57, v70 offset:0
    ds_write_b32 v58, v72 offset:0
    s_waitcnt lgkmcnt(0)
    s_barrier
    v_mov_b32 v8, 0
    v_mov_b32 v9, 0
    v_mov_b32 v10, 0
    v_mov_b32 v11, 0
    v_mov_b32 v12, 0
    v_mov_b32 v13, 0
    v_mov_b32 v14, 0
    v_mov_b32 v15, 0
    v_mov_b32 v16, 0
    v_mov_b32 v17, 0
    v_mov_b32 v18, 0
    v_mov_b32 v19, 0
    v_mov_b32 v20, 0
    v_mov_b32 v21, 0
    v_mov_b32 v22, 0
    v_mov_b32 v23, 0
    ds_read_b128 v[60:63], v30 offset:0
    ds_read_b128 v[64:67], v30 offset:64
    ds_read_b128 v[68:71], v30 offset:128
    ds_read_b128 v[72:75], v30 offset:192
    ds_read_b128 v[76:79], v30 offset:256
    ds_read_b128 v[80:83], v30 offset:320
    ds_read_b128 v[84:87], v30 offset:384
    s_waitcnt lgkmcnt(6)
    v_mfma_f32_16x16x32_bf16 v[8:11], v[60:63], a[0:3], v[8:11]
    v_mfma_f32_16x16x32_bf16 v[12:15], v[60:63], a[56:59], v[12:15]
    v_mfma_f32_16x16x32_bf16 v[16:19], v[60:63], a[112:115], v[16:19]
    v_mfma_f32_16x16x32_bf16 v[20:23], v[60:63], a[168:171], v[20:23]
    s_waitcnt lgkmcnt(5)
    v_mfma_f32_16x16x32_bf16 v[8:11], v[64:67], a[4:7], v[8:11]
    v_mfma_f32_16x16x32_bf16 v[12:15], v[64:67], a[60:63], v[12:15]
    v_mfma_f32_16x16x32_bf16 v[16:19], v[64:67], a[116:119], v[16:19]
    v_mfma_f32_16x16x32_bf16 v[20:23], v[64:67], a[172:175], v[20:23]
    s_waitcnt lgkmcnt(4)
    v_mfma_f32_16x16x32_bf16 v[8:11], v[68:71], a[8:11], v[8:11]
    v_mfma_f32_16x16x32_bf16 v[12:15], v[68:71], a[64:67], v[12:15]
    v_mfma_f32_16x16x32_bf16 v[16:19], v[68:71], a[120:123], v[16:19]
    v_mfma_f32_16x16x32_bf16 v[20:23], v[68:71], a[176:179], v[20:23]
    s_waitcnt lgkmcnt(3)
    v_mfma_f32_16x16x32_bf16 v[8:11], v[72:75], a[12:15], v[8:11]
    v_mfma_f32_16x16x32_bf16 v[12:15], v[72:75], a[68:71], v[12:15]
    v_mfma_f32_16x16x32_bf16 v[16:19], v[72:75], a[124:127], v[16:19]
    v_mfma_f32_16x16x32_bf16 v[20:23], v[72:75], a[180:183], v[20:23]
    s_waitcnt lgkmcnt(2)
    v_mfma_f32_16x16x32_bf16 v[8:11], v[76:79], a[16:19], v[8:11]
    v_mfma_f32_16x16x32_bf16 v[12:15], v[76:79], a[72:75], v[12:15]
    v_mfma_f32_16x16x32_bf16 v[16:19], v[76:79], a[128:131], v[16:19]
    v_mfma_f32_16x16x32_bf16 v[20:23], v[76:79], a[184:187], v[20:23]
    s_waitcnt lgkmcnt(1)
    v_mfma_f32_16x16x32_bf16 v[8:11], v[80:83], a[20:23], v[8:11]
    v_mfma_f32_16x16x32_bf16 v[12:15], v[80:83], a[76:79], v[12:15]
    v_mfma_f32_16x16x32_bf16 v[16:19], v[80:83], a[132:135], v[16:19]
    v_mfma_f32_16x16x32_bf16 v[20:23], v[80:83], a[188:191], v[20:23]
    s_waitcnt lgkmcnt(0)
    v_mfma_f32_16x16x32_bf16 v[8:11], v[84:87], a[24:27], v[8:11]
    v_mfma_f32_16x16x32_bf16 v[12:15], v[84:87], a[80:83], v[12:15]
    v_mfma_f32_16x16x32_bf16 v[16:19], v[84:87], a[136:139], v[16:19]
    v_mfma_f32_16x16x32_bf16 v[20:23], v[84:87], a[192:195], v[20:23]
    ds_read_b128 v[60:63], v30 offset:448
    ds_read_b128 v[64:67], v30 offset:512
    ds_read_b128 v[68:71], v30 offset:576
    ds_read_b128 v[72:75], v30 offset:640
    ds_read_b128 v[76:79], v30 offset:704
    ds_read_b128 v[80:83], v30 offset:768
    ds_read_b128 v[84:87], v30 offset:832
    s_waitcnt lgkmcnt(6)
    v_mfma_f32_16x16x32_bf16 v[8:11], v[60:63], a[28:31], v[8:11]
    v_mfma_f32_16x16x32_bf16 v[12:15], v[60:63], a[84:87], v[12:15]
    v_mfma_f32_16x16x32_bf16 v[16:19], v[60:63], a[140:143], v[16:19]
    v_mfma_f32_16x16x32_bf16 v[20:23], v[60:63], a[196:199], v[20:23]
    s_waitcnt lgkmcnt(5)
    v_mfma_f32_16x16x32_bf16 v[8:11], v[64:67], a[32:35], v[8:11]
    v_mfma_f32_16x16x32_bf16 v[12:15], v[64:67], a[88:91], v[12:15]
    v_mfma_f32_16x16x32_bf16 v[16:19], v[64:67], a[144:147], v[16:19]
    v_mfma_f32_16x16x32_bf16 v[20:23], v[64:67], a[200:203], v[20:23]
    s_waitcnt lgkmcnt(4)
    v_mfma_f32_16x16x32_bf16 v[8:11], v[68:71], a[36:39], v[8:11]
    v_mfma_f32_16x16x32_bf16 v[12:15], v[68:71], a[92:95], v[12:15]
    v_mfma_f32_16x16x32_bf16 v[16:19], v[68:71], a[148:151], v[16:19]
    v_mfma_f32_16x16x32_bf16 v[20:23], v[68:71], a[204:207], v[20:23]
    s_waitcnt lgkmcnt(3)
    v_mfma_f32_16x16x32_bf16 v[8:11], v[72:75], a[40:43], v[8:11]
    v_mfma_f32_16x16x32_bf16 v[12:15], v[72:75], a[96:99], v[12:15]
    v_mfma_f32_16x16x32_bf16 v[16:19], v[72:75], a[152:155], v[16:19]
    v_mfma_f32_16x16x32_bf16 v[20:23], v[72:75], a[208:211], v[20:23]
    s_waitcnt lgkmcnt(2)
    v_mfma_f32_16x16x32_bf16 v[8:11], v[76:79], a[44:47], v[8:11]
    v_mfma_f32_16x16x32_bf16 v[12:15], v[76:79], a[100:103], v[12:15]
    v_mfma_f32_16x16x32_bf16 v[16:19], v[76:79], a[156:159], v[16:19]
    v_mfma_f32_16x16x32_bf16 v[20:23], v[76:79], a[212:215], v[20:23]
    s_waitcnt lgkmcnt(1)
    v_mfma_f32_16x16x32_bf16 v[8:11], v[80:83], a[48:51], v[8:11]
    v_mfma_f32_16x16x32_bf16 v[12:15], v[80:83], a[104:107], v[12:15]
    v_mfma_f32_16x16x32_bf16 v[16:19], v[80:83], a[160:163], v[16:19]
    v_mfma_f32_16x16x32_bf16 v[20:23], v[80:83], a[216:219], v[20:23]
    s_waitcnt lgkmcnt(0)
    v_mfma_f32_16x16x32_bf16 v[8:11], v[84:87], a[52:55], v[8:11]
    v_mfma_f32_16x16x32_bf16 v[12:15], v[84:87], a[108:111], v[12:15]
    v_mfma_f32_16x16x32_bf16 v[16:19], v[84:87], a[164:167], v[16:19]
    v_mfma_f32_16x16x32_bf16 v[20:23], v[84:87], a[220:223], v[20:23]
    s_nop 7
    v_cvt_pk_bf16_f32 v8, v8, v9
    v_cvt_pk_bf16_f32 v9, v10, v11
    v_cvt_pk_bf16_f32 v12, v12, v13
    v_cvt_pk_bf16_f32 v13, v14, v15
    v_cvt_pk_bf16_f32 v16, v16, v17
    v_cvt_pk_bf16_f32 v17, v18, v19
    v_cvt_pk_bf16_f32 v20, v20, v21
    v_cvt_pk_bf16_f32 v21, v22, v23
    s_mul_i32 s44, s41, 114688
    s_mov_b32 exec_lo, -1
    s_mov_b32 exec_hi, 0
    ds_write_b64 v32, v[8:9] offset:0
    buffer_store_dwordx2 v[8:9], v33, s[28:31], s44 offen offset:0
    ds_write_b64 v32, v[12:13] offset:80
    v_add_u32 v35, 7168, v33
    buffer_store_dwordx2 v[12:13], v35, s[28:31], s44 offen
    ds_write_b64 v32, v[16:17] offset:160
    v_add_u32 v35, 14336, v33
    buffer_store_dwordx2 v[16:17], v35, s[28:31], s44 offen
    ds_write_b64 v32, v[20:21] offset:240
    v_add_u32 v35, 21504, v33
    buffer_store_dwordx2 v[20:21], v35, s[28:31], s44 offen
    s_mov_b64 exec, -1
    s_lshl_b32 s42, s41, 15
    s_mov_b32 s40, 0
poll_11:
    buffer_load_dwordx4 v[60:63], v49, s[16:19], s42 offen offset:0 sc1
    s_add_u32 s39, s42, 4096
    buffer_load_dwordx4 v[64:67], v49, s[16:19], s39 offen offset:0 sc1
    s_add_u32 s39, s42, 8192
    buffer_load_dwordx4 v[68:71], v49, s[16:19], s39 offen offset:0 sc1
    s_add_u32 s39, s42, 12288
    buffer_load_dwordx4 v[72:75], v49, s[16:19], s39 offen offset:0 sc1
    s_add_u32 s39, s42, 16384
    buffer_load_dwordx4 v[76:79], v49, s[16:19], s39 offen offset:0 sc1
    s_waitcnt vmcnt(0)
    v_mov_b32 v119, v61
    v_and_b32 v119, v119, v63
    v_and_b32 v119, v119, v65
    v_and_b32 v119, v119, v67
    v_and_b32 v119, v119, v69
    v_and_b32 v119, v119, v71
    v_and_b32 v119, v119, v73
    v_and_b32 v119, v119, v75
    v_and_b32 v119, v119, v77
    v_and_b32 v119, v119, v79
    v_cmp_ne_u32 vcc, 1, v119
    s_add_u32 s40, s40, 1
    s_cmp_gt_u32 s40, 0x100000
    s_cbranch_scc1 poll_11_x
    s_cbranch_vccnz poll_11
poll_11_x:
    ds_write_b32 v44, v60
    ds_write_b32 v44, v62 offset:4
    ds_write_b32 v45, v64
    ds_write_b32 v45, v66 offset:4
    ds_write_b32 v46, v68
    ds_write_b32 v46, v70 offset:4
    ds_write_b32 v47, v72
    ds_write_b32 v47, v74 offset:4
    ds_write_b32 v48, v76
    ds_write_b32 v48, v78 offset:4
    s_waitcnt lgkmcnt(0)
    s_barrier
    v_mul_u32_u24 v24, 320, v2
    v_add_u32 v24, v24, v31
    v_mov_b32 v8, 0
    v_mov_b32 v9, 0
    v_mov_b32 v10, 0
    v_mov_b32 v11, 0
    ds_read_b128 v[60:63], v24 offset:14592
    ds_read_b128 v[64:67], v24 offset:35328
    ds_read_b128 v[68:71], v24 offset:14656
    ds_read_b128 v[72:75], v24 offset:35392
    ds_read_b128 v[76:79], v24 offset:14720
    ds_read_b128 v[80:83], v24 offset:35456
    s_waitcnt lgkmcnt(0)
    v_mfma_f32_16x16x32_bf16 v[8:11], v[60:63], v[64:67], v[8:11]
    v_mfma_f32_16x16x32_bf16 v[8:11], v[68:71], v[72:75], v[8:11]
    v_mfma_f32_16x16x32_bf16 v[8:11], v[76:79], v[80:83], v[8:11]
    ds_read_b128 v[60:63], v24 offset:14784
    ds_read_b128 v[64:67], v24 offset:35520
    ds_read_b128 v[68:71], v24 offset:14848
    ds_read_b128 v[72:75], v24 offset:35584
    s_waitcnt lgkmcnt(0)
    v_mfma_f32_16x16x32_bf16 v[8:11], v[60:63], v[64:67], v[8:11]
    v_mfma_f32_16x16x32_bf16 v[8:11], v[68:71], v[72:75], v[8:11]
    s_nop 7
    s_nop 3
    ds_write_b128 v49, v[8:11] offset:56064
    s_waitcnt lgkmcnt(0)
    s_barrier
    s_cmp_lg_u32 s43, 0
    s_cbranch_scc1 vs_12
    ds_read_b128 v[12:15], v49 offset:57088
    ds_read_b128 v[16:19], v49 offset:58112
    ds_read_b128 v[20:23], v49 offset:59136
    s_waitcnt lgkmcnt(0)
    v_add_f32 v8, v8, v12
    v_add_f32 v16, v16, v20
    v_add_f32 v8, v8, v16
    v_add_f32 v9, v9, v13
    v_add_f32 v17, v17, v21
    v_add_f32 v9, v9, v17
    v_add_f32 v10, v10, v14
    v_add_f32 v18, v18, v22
    v_add_f32 v10, v10, v18
    v_add_f32 v11, v11, v15
    v_add_f32 v19, v19, v23
    v_add_f32 v11, v11, v19
    v_cvt_pk_bf16_f32 v12, v8, v9
    v_mov_b32 v13, 1
    v_cvt_pk_bf16_f32 v14, v10, v11
    v_mov_b32 v15, 1
    s_add_u32 s42, s41, 1
    s_lshl_b32 s42, s42, 14
    v_cmp_gt_u32 vcc, 8, v3
    s_and_b64 exec, exec, vcc
    buffer_store_dwordx4 v[12:15], v34, s[12:15], s42 offen sc1
    s_mov_b64 exec, -1
vs_12:
    s_barrier
    s_add_u32 s41, s41, 1
    s_cmp_lt_u32 s41, 64
    s_cbranch_scc1 chain_kernel_vloop
chain_kernel_done:
    s_endpgm
x_gvo:
    s_sub_u32 s2, s2, 44
    s_cmp_ge_u32 s2, 896
    s_cbranch_scc1 x_gf2
    s_mul_hi_u32 s20, s2, 0x492493
    s_mul_i32 s24, s20, 896
    s_sub_u32 s23, s2, s24
    s_mul_hi_u32 s21, s23, 0x4924925
    s_mul_i32 s24, s21, 56
    s_sub_u32 s22, s23, s24
    s_load_dwordx2 s[8:9], s[0:1], 112
    s_waitcnt lgkmcnt(0)
    s_and_b32 s9, s9, 0xffff
    s_mov_b32 s10, 0x10000000
    s_mov_b32 s11, 0x00020000
    s_load_dwordx2 s[12:13], s[0:1], 112
    s_waitcnt lgkmcnt(0)
    s_add_u32 s12, s12, 0x900000
    s_addc_u32 s13, s13, 0
    s_and_b32 s13, s13, 0xffff
    s_mov_b32 s14, 0xf700000
    s_mov_b32 s15, 0x00020000
    s_load_dwordx2 s[16:17], s[0:1], 112
    s_waitcnt lgkmcnt(0)
    s_add_u32 s16, s16, 0x4000000
    s_addc_u32 s17, s17, 0
    s_and_b32 s17, s17, 0xffff
    s_mov_b32 s18, 0xc000000
    s_mov_b32 s19, 0x00020000
    v_lshrrev_b32 v4, 3, v0
    v_and_b32 v5, 7, v0
    v_lshlrev_b32 v5, 4, v5
    s_mul_i32 s24, s21, 114688
    s_mul_i32 s25, s20, 0
    s_add_u32 s24, s24, s25
    s_mov_b32 s26, 896
    v_mul_lo_u32 v1, v4, s26
    v_add_u32 v1, v1, v5
    v_add_u32 v1, s24, v1
    s_mul_i32 s24, s22, 114688
    s_mul_i32 s25, s20, 0
    s_add_u32 s24, s24, s25
    s_mov_b32 s26, 896
    v_mul_lo_u32 v2, v4, s26
    v_add_u32 v2, v2, v5
    v_add_u32 v2, s24, v2
    v_mul_u32_u24 v3, 144, v4
    v_add_u32 v3, v3, v5
    v_lshrrev_b32 v6, 6, v0
    v_and_b32 v7, 1, v6
    v_lshrrev_b32 v6, 1, v6
    v_and_b32 v8, 31, v0
    v_bfe_u32 v9, v0, 5, 1
    v_lshlrev_b32 v10, 4, v9
    v_mul_u32_u24 v11, 64, v7
    v_add_u32 v11, v11, v8
    v_mul_u32_u24 v11, 144, v11
    v_add_u32 v11, v11, v10
    v_mul_u32_u24 v12, 64, v6
    v_add_u32 v12, v12, v8
    v_mul_u32_u24 v12, 144, v12
    v_add_u32 v12, v12, v10
    v_add_u32 v12, 18432, v12
    v_add_u32 v15, 36864, v3
    v_add_u32 v16, 36864, v11
    v_add_u32 v17, 36864, v12
    v_mov_b32 v20, 0
    v_mov_b32 v21, 0
    v_mov_b32 v22, 0
    v_mov_b32 v23, 0
    v_mov_b32 v24, 0
    v_mov_b32 v25, 0
    v_mov_b32 v26, 0
    v_mov_b32 v27, 0
    v_mov_b32 v28, 0
    v_mov_b32 v29, 0
    v_mov_b32 v30, 0
    v_mov_b32 v31, 0
    v_mov_b32 v32, 0
    v_mov_b32 v33, 0
    v_mov_b32 v34, 0
    v_mov_b32 v35, 0
    v_mov_b32 v36, 0
    v_mov_b32 v37, 0
    v_mov_b32 v38, 0
    v_mov_b32 v39, 0
    v_mov_b32 v40, 0
    v_mov_b32 v41, 0
    v_mov_b32 v42, 0
    v_mov_b32 v43, 0
    v_mov_b32 v44, 0
    v_mov_b32 v45, 0
    v_mov_b32 v46, 0
    v_mov_b32 v47, 0
    v_mov_b32 v48, 0
    v_mov_b32 v49, 0
    v_mov_b32 v50, 0
    v_mov_b32 v51, 0
    v_mov_b32 v52, 0
    v_mov_b32 v53, 0
    v_mov_b32 v54, 0
    v_mov_b32 v55, 0
    v_mov_b32 v56, 0
    v_mov_b32 v57, 0
    v_mov_b32 v58, 0
    v_mov_b32 v59, 0
    v_mov_b32 v60, 0
    v_mov_b32 v61, 0
    v_mov_b32 v62, 0
    v_mov_b32 v63, 0
    v_mov_b32 v64, 0
    v_mov_b32 v65, 0
    v_mov_b32 v66, 0
    v_mov_b32 v67, 0
    v_mov_b32 v68, 0
    v_mov_b32 v69, 0
    v_mov_b32 v70, 0
    v_mov_b32 v71, 0
    v_mov_b32 v72, 0
    v_mov_b32 v73, 0
    v_mov_b32 v74, 0
    v_mov_b32 v75, 0
    v_mov_b32 v76, 0
    v_mov_b32 v77, 0
    v_mov_b32 v78, 0
    v_mov_b32 v79, 0
    v_mov_b32 v80, 0
    v_mov_b32 v81, 0
    v_mov_b32 v82, 0
    v_mov_b32 v83, 0
    s_mov_b32 s27, 0
    buffer_load_dwordx4 v[100:103], v1, s[8:11], s27 offen
    v_add_u32 v13, 28672, v1
    buffer_load_dwordx4 v[104:107], v13, s[8:11], s27 offen
    v_add_u32 v13, 57344, v1
    buffer_load_dwordx4 v[108:111], v13, s[8:11], s27 offen
    v_add_u32 v13, 86016, v1
    buffer_load_dwordx4 v[112:115], v13, s[8:11], s27 offen
    buffer_load_dwordx4 v[116:119], v2, s[12:15], s27 offen
    v_add_u32 v14, 28672, v2
    buffer_load_dwordx4 v[120:123], v14, s[12:15], s27 offen
    v_add_u32 v14, 57344, v2
    buffer_load_dwordx4 v[124:127], v14, s[12:15], s27 offen
    v_add_u32 v14, 86016, v2
    buffer_load_dwordx4 v[128:131], v14, s[12:15], s27 offen
    s_waitcnt vmcnt(0)
    ds_write_b128 v3, v[100:103] offset:0
    ds_write_b128 v3, v[104:107] offset:4608
    ds_write_b128 v3, v[108:111] offset:9216
    ds_write_b128 v3, v[112:115] offset:13824
    ds_write_b128 v3, v[116:119] offset:18432
    ds_write_b128 v3, v[120:123] offset:23040
    ds_write_b128 v3, v[124:127] offset:27648
    ds_write_b128 v3, v[128:131] offset:32256
    s_waitcnt lgkmcnt(0)
    s_barrier
    s_mov_b32 s27, 128
    buffer_load_dwordx4 v[100:103], v1, s[8:11], s27 offen
    v_add_u32 v13, 28672, v1
    buffer_load_dwordx4 v[104:107], v13, s[8:11], s27 offen
    v_add_u32 v13, 57344, v1
    buffer_load_dwordx4 v[108:111], v13, s[8:11], s27 offen
    v_add_u32 v13, 86016, v1
    buffer_load_dwordx4 v[112:115], v13, s[8:11], s27 offen
    buffer_load_dwordx4 v[116:119], v2, s[12:15], s27 offen
    v_add_u32 v14, 28672, v2
    buffer_load_dwordx4 v[120:123], v14, s[12:15], s27 offen
    v_add_u32 v14, 57344, v2
    buffer_load_dwordx4 v[124:127], v14, s[12:15], s27 offen
    v_add_u32 v14, 86016, v2
    buffer_load_dwordx4 v[128:131], v14, s[12:15], s27 offen
    ds_read_b128 v[84:87], v11 offset:0
    ds_read_b128 v[88:91], v11 offset:4608
    ds_read_b128 v[92:95], v12 offset:0
    ds_read_b128 v[96:99], v12 offset:4608
    s_waitcnt lgkmcnt(0)
    v_mfma_f32_32x32x16_bf16 v[20:35], v[84:87], v[92:95], v[20:35]
    v_mfma_f32_32x32x16_bf16 v[36:51], v[84:87], v[96:99], v[36:51]
    v_mfma_f32_32x32x16_bf16 v[52:67], v[88:91], v[92:95], v[52:67]
    v_mfma_f32_32x32x16_bf16 v[68:83], v[88:91], v[96:99], v[68:83]
    ds_read_b128 v[84:87], v11 offset:32
    ds_read_b128 v[88:91], v11 offset:4640
    ds_read_b128 v[92:95], v12 offset:32
    ds_read_b128 v[96:99], v12 offset:4640
    s_waitcnt lgkmcnt(0)
    v_mfma_f32_32x32x16_bf16 v[20:35], v[84:87], v[92:95], v[20:35]
    v_mfma_f32_32x32x16_bf16 v[36:51], v[84:87], v[96:99], v[36:51]
    v_mfma_f32_32x32x16_bf16 v[52:67], v[88:91], v[92:95], v[52:67]
    v_mfma_f32_32x32x16_bf16 v[68:83], v[88:91], v[96:99], v[68:83]
    ds_read_b128 v[84:87], v11 offset:64
    ds_read_b128 v[88:91], v11 offset:4672
    ds_read_b128 v[92:95], v12 offset:64
    ds_read_b128 v[96:99], v12 offset:4672
    s_waitcnt lgkmcnt(0)
    v_mfma_f32_32x32x16_bf16 v[20:35], v[84:87], v[92:95], v[20:35]
    v_mfma_f32_32x32x16_bf16 v[36:51], v[84:87], v[96:99], v[36:51]
    v_mfma_f32_32x32x16_bf16 v[52:67], v[88:91], v[92:95], v[52:67]
    v_mfma_f32_32x32x16_bf16 v[68:83], v[88:91], v[96:99], v[68:83]
    ds_read_b128 v[84:87], v11 offset:96
    ds_read_b128 v[88:91], v11 offset:4704
    ds_read_b128 v[92:95], v12 offset:96
    ds_read_b128 v[96:99], v12 offset:4704
    s_waitcnt lgkmcnt(0)
    v_mfma_f32_32x32x16_bf16 v[20:35], v[84:87], v[92:95], v[20:35]
    v_mfma_f32_32x32x16_bf16 v[36:51], v[84:87], v[96:99], v[36:51]
    v_mfma_f32_32x32x16_bf16 v[52:67], v[88:91], v[92:95], v[52:67]
    v_mfma_f32_32x32x16_bf16 v[68:83], v[88:91], v[96:99], v[68:83]
    s_waitcnt vmcnt(0)
    ds_write_b128 v15, v[100:103] offset:0
    ds_write_b128 v15, v[104:107] offset:4608
    ds_write_b128 v15, v[108:111] offset:9216
    ds_write_b128 v15, v[112:115] offset:13824
    ds_write_b128 v15, v[116:119] offset:18432
    ds_write_b128 v15, v[120:123] offset:23040
    ds_write_b128 v15, v[124:127] offset:27648
    ds_write_b128 v15, v[128:131] offset:32256
    s_waitcnt lgkmcnt(0)
    s_barrier
    s_mov_b32 s27, 256
    buffer_load_dwordx4 v[100:103], v1, s[8:11], s27 offen
    v_add_u32 v13, 28672, v1
    buffer_load_dwordx4 v[104:107], v13, s[8:11], s27 offen
    v_add_u32 v13, 57344, v1
    buffer_load_dwordx4 v[108:111], v13, s[8:11], s27 offen
    v_add_u32 v13, 86016, v1
    buffer_load_dwordx4 v[112:115], v13, s[8:11], s27 offen
    buffer_load_dwordx4 v[116:119], v2, s[12:15], s27 offen
    v_add_u32 v14, 28672, v2
    buffer_load_dwordx4 v[120:123], v14, s[12:15], s27 offen
    v_add_u32 v14, 57344, v2
    buffer_load_dwordx4 v[124:127], v14, s[12:15], s27 offen
    v_add_u32 v14, 86016, v2
    buffer_load_dwordx4 v[128:131], v14, s[12:15], s27 offen
    ds_read_b128 v[84:87], v16 offset:0
    ds_read_b128 v[88:91], v16 offset:4608
    ds_read_b128 v[92:95], v17 offset:0
    ds_read_b128 v[96:99], v17 offset:4608
    s_waitcnt lgkmcnt(0)
    v_mfma_f32_32x32x16_bf16 v[20:35], v[84:87], v[92:95], v[20:35]
    v_mfma_f32_32x32x16_bf16 v[36:51], v[84:87], v[96:99], v[36:51]
    v_mfma_f32_32x32x16_bf16 v[52:67], v[88:91], v[92:95], v[52:67]
    v_mfma_f32_32x32x16_bf16 v[68:83], v[88:91], v[96:99], v[68:83]
    ds_read_b128 v[84:87], v16 offset:32
    ds_read_b128 v[88:91], v16 offset:4640
    ds_read_b128 v[92:95], v17 offset:32
    ds_read_b128 v[96:99], v17 offset:4640
    s_waitcnt lgkmcnt(0)
    v_mfma_f32_32x32x16_bf16 v[20:35], v[84:87], v[92:95], v[20:35]
    v_mfma_f32_32x32x16_bf16 v[36:51], v[84:87], v[96:99], v[36:51]
    v_mfma_f32_32x32x16_bf16 v[52:67], v[88:91], v[92:95], v[52:67]
    v_mfma_f32_32x32x16_bf16 v[68:83], v[88:91], v[96:99], v[68:83]
    ds_read_b128 v[84:87], v16 offset:64
    ds_read_b128 v[88:91], v16 offset:4672
    ds_read_b128 v[92:95], v17 offset:64
    ds_read_b128 v[96:99], v17 offset:4672
    s_waitcnt lgkmcnt(0)
    v_mfma_f32_32x32x16_bf16 v[20:35], v[84:87], v[92:95], v[20:35]
    v_mfma_f32_32x32x16_bf16 v[36:51], v[84:87], v[96:99], v[36:51]
    v_mfma_f32_32x32x16_bf16 v[52:67], v[88:91], v[92:95], v[52:67]
    v_mfma_f32_32x32x16_bf16 v[68:83], v[88:91], v[96:99], v[68:83]
    ds_read_b128 v[84:87], v16 offset:96
    ds_read_b128 v[88:91], v16 offset:4704
    ds_read_b128 v[92:95], v17 offset:96
    ds_read_b128 v[96:99], v17 offset:4704
    s_waitcnt lgkmcnt(0)
    v_mfma_f32_32x32x16_bf16 v[20:35], v[84:87], v[92:95], v[20:35]
    v_mfma_f32_32x32x16_bf16 v[36:51], v[84:87], v[96:99], v[36:51]
    v_mfma_f32_32x32x16_bf16 v[52:67], v[88:91], v[92:95], v[52:67]
    v_mfma_f32_32x32x16_bf16 v[68:83], v[88:91], v[96:99], v[68:83]
    s_waitcnt vmcnt(0)
    ds_write_b128 v3, v[100:103] offset:0
    ds_write_b128 v3, v[104:107] offset:4608
    ds_write_b128 v3, v[108:111] offset:9216
    ds_write_b128 v3, v[112:115] offset:13824
    ds_write_b128 v3, v[116:119] offset:18432
    ds_write_b128 v3, v[120:123] offset:23040
    ds_write_b128 v3, v[124:127] offset:27648
    ds_write_b128 v3, v[128:131] offset:32256
    s_waitcnt lgkmcnt(0)
    s_barrier
    s_mov_b32 s27, 384
    buffer_load_dwordx4 v[100:103], v1, s[8:11], s27 offen
    v_add_u32 v13, 28672, v1
    buffer_load_dwordx4 v[104:107], v13, s[8:11], s27 offen
    v_add_u32 v13, 57344, v1
    buffer_load_dwordx4 v[108:111], v13, s[8:11], s27 offen
    v_add_u32 v13, 86016, v1
    buffer_load_dwordx4 v[112:115], v13, s[8:11], s27 offen
    buffer_load_dwordx4 v[116:119], v2, s[12:15], s27 offen
    v_add_u32 v14, 28672, v2
    buffer_load_dwordx4 v[120:123], v14, s[12:15], s27 offen
    v_add_u32 v14, 57344, v2
    buffer_load_dwordx4 v[124:127], v14, s[12:15], s27 offen
    v_add_u32 v14, 86016, v2
    buffer_load_dwordx4 v[128:131], v14, s[12:15], s27 offen
    ds_read_b128 v[84:87], v11 offset:0
    ds_read_b128 v[88:91], v11 offset:4608
    ds_read_b128 v[92:95], v12 offset:0
    ds_read_b128 v[96:99], v12 offset:4608
    s_waitcnt lgkmcnt(0)
    v_mfma_f32_32x32x16_bf16 v[20:35], v[84:87], v[92:95], v[20:35]
    v_mfma_f32_32x32x16_bf16 v[36:51], v[84:87], v[96:99], v[36:51]
    v_mfma_f32_32x32x16_bf16 v[52:67], v[88:91], v[92:95], v[52:67]
    v_mfma_f32_32x32x16_bf16 v[68:83], v[88:91], v[96:99], v[68:83]
    ds_read_b128 v[84:87], v11 offset:32
    ds_read_b128 v[88:91], v11 offset:4640
    ds_read_b128 v[92:95], v12 offset:32
    ds_read_b128 v[96:99], v12 offset:4640
    s_waitcnt lgkmcnt(0)
    v_mfma_f32_32x32x16_bf16 v[20:35], v[84:87], v[92:95], v[20:35]
    v_mfma_f32_32x32x16_bf16 v[36:51], v[84:87], v[96:99], v[36:51]
    v_mfma_f32_32x32x16_bf16 v[52:67], v[88:91], v[92:95], v[52:67]
    v_mfma_f32_32x32x16_bf16 v[68:83], v[88:91], v[96:99], v[68:83]
    ds_read_b128 v[84:87], v11 offset:64
    ds_read_b128 v[88:91], v11 offset:4672
    ds_read_b128 v[92:95], v12 offset:64
    ds_read_b128 v[96:99], v12 offset:4672
    s_waitcnt lgkmcnt(0)
    v_mfma_f32_32x32x16_bf16 v[20:35], v[84:87], v[92:95], v[20:35]
    v_mfma_f32_32x32x16_bf16 v[36:51], v[84:87], v[96:99], v[36:51]
    v_mfma_f32_32x32x16_bf16 v[52:67], v[88:91], v[92:95], v[52:67]
    v_mfma_f32_32x32x16_bf16 v[68:83], v[88:91], v[96:99], v[68:83]
    ds_read_b128 v[84:87], v11 offset:96
    ds_read_b128 v[88:91], v11 offset:4704
    ds_read_b128 v[92:95], v12 offset:96
    ds_read_b128 v[96:99], v12 offset:4704
    s_waitcnt lgkmcnt(0)
    v_mfma_f32_32x32x16_bf16 v[20:35], v[84:87], v[92:95], v[20:35]
    v_mfma_f32_32x32x16_bf16 v[36:51], v[84:87], v[96:99], v[36:51]
    v_mfma_f32_32x32x16_bf16 v[52:67], v[88:91], v[92:95], v[52:67]
    v_mfma_f32_32x32x16_bf16 v[68:83], v[88:91], v[96:99], v[68:83]
    s_waitcnt vmcnt(0)
    ds_write_b128 v15, v[100:103] offset:0
    ds_write_b128 v15, v[104:107] offset:4608
    ds_write_b128 v15, v[108:111] offset:9216
    ds_write_b128 v15, v[112:115] offset:13824
    ds_write_b128 v15, v[116:119] offset:18432
    ds_write_b128 v15, v[120:123] offset:23040
    ds_write_b128 v15, v[124:127] offset:27648
    ds_write_b128 v15, v[128:131] offset:32256
    s_waitcnt lgkmcnt(0)
    s_barrier
    s_mov_b32 s27, 512
    buffer_load_dwordx4 v[100:103], v1, s[8:11], s27 offen
    v_add_u32 v13, 28672, v1
    buffer_load_dwordx4 v[104:107], v13, s[8:11], s27 offen
    v_add_u32 v13, 57344, v1
    buffer_load_dwordx4 v[108:111], v13, s[8:11], s27 offen
    v_add_u32 v13, 86016, v1
    buffer_load_dwordx4 v[112:115], v13, s[8:11], s27 offen
    buffer_load_dwordx4 v[116:119], v2, s[12:15], s27 offen
    v_add_u32 v14, 28672, v2
    buffer_load_dwordx4 v[120:123], v14, s[12:15], s27 offen
    v_add_u32 v14, 57344, v2
    buffer_load_dwordx4 v[124:127], v14, s[12:15], s27 offen
    v_add_u32 v14, 86016, v2
    buffer_load_dwordx4 v[128:131], v14, s[12:15], s27 offen
    ds_read_b128 v[84:87], v16 offset:0
    ds_read_b128 v[88:91], v16 offset:4608
    ds_read_b128 v[92:95], v17 offset:0
    ds_read_b128 v[96:99], v17 offset:4608
    s_waitcnt lgkmcnt(0)
    v_mfma_f32_32x32x16_bf16 v[20:35], v[84:87], v[92:95], v[20:35]
    v_mfma_f32_32x32x16_bf16 v[36:51], v[84:87], v[96:99], v[36:51]
    v_mfma_f32_32x32x16_bf16 v[52:67], v[88:91], v[92:95], v[52:67]
    v_mfma_f32_32x32x16_bf16 v[68:83], v[88:91], v[96:99], v[68:83]
    ds_read_b128 v[84:87], v16 offset:32
    ds_read_b128 v[88:91], v16 offset:4640
    ds_read_b128 v[92:95], v17 offset:32
    ds_read_b128 v[96:99], v17 offset:4640
    s_waitcnt lgkmcnt(0)
    v_mfma_f32_32x32x16_bf16 v[20:35], v[84:87], v[92:95], v[20:35]
    v_mfma_f32_32x32x16_bf16 v[36:51], v[84:87], v[96:99], v[36:51]
    v_mfma_f32_32x32x16_bf16 v[52:67], v[88:91], v[92:95], v[52:67]
    v_mfma_f32_32x32x16_bf16 v[68:83], v[88:91], v[96:99], v[68:83]
    ds_read_b128 v[84:87], v16 offset:64
    ds_read_b128 v[88:91], v16 offset:4672
    ds_read_b128 v[92:95], v17 offset:64
    ds_read_b128 v[96:99], v17 offset:4672
    s_waitcnt lgkmcnt(0)
    v_mfma_f32_32x32x16_bf16 v[20:35], v[84:87], v[92:95], v[20:35]
    v_mfma_f32_32x32x16_bf16 v[36:51], v[84:87], v[96:99], v[36:51]
    v_mfma_f32_32x32x16_bf16 v[52:67], v[88:91], v[92:95], v[52:67]
    v_mfma_f32_32x32x16_bf16 v[68:83], v[88:91], v[96:99], v[68:83]
    ds_read_b128 v[84:87], v16 offset:96
    ds_read_b128 v[88:91], v16 offset:4704
    ds_read_b128 v[92:95], v17 offset:96
    ds_read_b128 v[96:99], v17 offset:4704
    s_waitcnt lgkmcnt(0)
    v_mfma_f32_32x32x16_bf16 v[20:35], v[84:87], v[92:95], v[20:35]
    v_mfma_f32_32x32x16_bf16 v[36:51], v[84:87], v[96:99], v[36:51]
    v_mfma_f32_32x32x16_bf16 v[52:67], v[88:91], v[92:95], v[52:67]
    v_mfma_f32_32x32x16_bf16 v[68:83], v[88:91], v[96:99], v[68:83]
    s_waitcnt vmcnt(0)
    ds_write_b128 v3, v[100:103] offset:0
    ds_write_b128 v3, v[104:107] offset:4608
    ds_write_b128 v3, v[108:111] offset:9216
    ds_write_b128 v3, v[112:115] offset:13824
    ds_write_b128 v3, v[116:119] offset:18432
    ds_write_b128 v3, v[120:123] offset:23040
    ds_write_b128 v3, v[124:127] offset:27648
    ds_write_b128 v3, v[128:131] offset:32256
    s_waitcnt lgkmcnt(0)
    s_barrier
    s_mov_b32 s27, 640
    buffer_load_dwordx4 v[100:103], v1, s[8:11], s27 offen
    v_add_u32 v13, 28672, v1
    buffer_load_dwordx4 v[104:107], v13, s[8:11], s27 offen
    v_add_u32 v13, 57344, v1
    buffer_load_dwordx4 v[108:111], v13, s[8:11], s27 offen
    v_add_u32 v13, 86016, v1
    buffer_load_dwordx4 v[112:115], v13, s[8:11], s27 offen
    buffer_load_dwordx4 v[116:119], v2, s[12:15], s27 offen
    v_add_u32 v14, 28672, v2
    buffer_load_dwordx4 v[120:123], v14, s[12:15], s27 offen
    v_add_u32 v14, 57344, v2
    buffer_load_dwordx4 v[124:127], v14, s[12:15], s27 offen
    v_add_u32 v14, 86016, v2
    buffer_load_dwordx4 v[128:131], v14, s[12:15], s27 offen
    ds_read_b128 v[84:87], v11 offset:0
    ds_read_b128 v[88:91], v11 offset:4608
    ds_read_b128 v[92:95], v12 offset:0
    ds_read_b128 v[96:99], v12 offset:4608
    s_waitcnt lgkmcnt(0)
    v_mfma_f32_32x32x16_bf16 v[20:35], v[84:87], v[92:95], v[20:35]
    v_mfma_f32_32x32x16_bf16 v[36:51], v[84:87], v[96:99], v[36:51]
    v_mfma_f32_32x32x16_bf16 v[52:67], v[88:91], v[92:95], v[52:67]
    v_mfma_f32_32x32x16_bf16 v[68:83], v[88:91], v[96:99], v[68:83]
    ds_read_b128 v[84:87], v11 offset:32
    ds_read_b128 v[88:91], v11 offset:4640
    ds_read_b128 v[92:95], v12 offset:32
    ds_read_b128 v[96:99], v12 offset:4640
    s_waitcnt lgkmcnt(0)
    v_mfma_f32_32x32x16_bf16 v[20:35], v[84:87], v[92:95], v[20:35]
    v_mfma_f32_32x32x16_bf16 v[36:51], v[84:87], v[96:99], v[36:51]
    v_mfma_f32_32x32x16_bf16 v[52:67], v[88:91], v[92:95], v[52:67]
    v_mfma_f32_32x32x16_bf16 v[68:83], v[88:91], v[96:99], v[68:83]
    ds_read_b128 v[84:87], v11 offset:64
    ds_read_b128 v[88:91], v11 offset:4672
    ds_read_b128 v[92:95], v12 offset:64
    ds_read_b128 v[96:99], v12 offset:4672
    s_waitcnt lgkmcnt(0)
    v_mfma_f32_32x32x16_bf16 v[20:35], v[84:87], v[92:95], v[20:35]
    v_mfma_f32_32x32x16_bf16 v[36:51], v[84:87], v[96:99], v[36:51]
    v_mfma_f32_32x32x16_bf16 v[52:67], v[88:91], v[92:95], v[52:67]
    v_mfma_f32_32x32x16_bf16 v[68:83], v[88:91], v[96:99], v[68:83]
    ds_read_b128 v[84:87], v11 offset:96
    ds_read_b128 v[88:91], v11 offset:4704
    ds_read_b128 v[92:95], v12 offset:96
    ds_read_b128 v[96:99], v12 offset:4704
    s_waitcnt lgkmcnt(0)
    v_mfma_f32_32x32x16_bf16 v[20:35], v[84:87], v[92:95], v[20:35]
    v_mfma_f32_32x32x16_bf16 v[36:51], v[84:87], v[96:99], v[36:51]
    v_mfma_f32_32x32x16_bf16 v[52:67], v[88:91], v[92:95], v[52:67]
    v_mfma_f32_32x32x16_bf16 v[68:83], v[88:91], v[96:99], v[68:83]
    s_waitcnt vmcnt(0)
    ds_write_b128 v15, v[100:103] offset:0
    ds_write_b128 v15, v[104:107] offset:4608
    ds_write_b128 v15, v[108:111] offset:9216
    ds_write_b128 v15, v[112:115] offset:13824
    ds_write_b128 v15, v[116:119] offset:18432
    ds_write_b128 v15, v[120:123] offset:23040
    ds_write_b128 v15, v[124:127] offset:27648
    ds_write_b128 v15, v[128:131] offset:32256
    s_waitcnt lgkmcnt(0)
    s_barrier
    s_mov_b32 s27, 768
    buffer_load_dwordx4 v[100:103], v1, s[8:11], s27 offen
    v_add_u32 v13, 28672, v1
    buffer_load_dwordx4 v[104:107], v13, s[8:11], s27 offen
    v_add_u32 v13, 57344, v1
    buffer_load_dwordx4 v[108:111], v13, s[8:11], s27 offen
    v_add_u32 v13, 86016, v1
    buffer_load_dwordx4 v[112:115], v13, s[8:11], s27 offen
    buffer_load_dwordx4 v[116:119], v2, s[12:15], s27 offen
    v_add_u32 v14, 28672, v2
    buffer_load_dwordx4 v[120:123], v14, s[12:15], s27 offen
    v_add_u32 v14, 57344, v2
    buffer_load_dwordx4 v[124:127], v14, s[12:15], s27 offen
    v_add_u32 v14, 86016, v2
    buffer_load_dwordx4 v[128:131], v14, s[12:15], s27 offen
    ds_read_b128 v[84:87], v16 offset:0
    ds_read_b128 v[88:91], v16 offset:4608
    ds_read_b128 v[92:95], v17 offset:0
    ds_read_b128 v[96:99], v17 offset:4608
    s_waitcnt lgkmcnt(0)
    v_mfma_f32_32x32x16_bf16 v[20:35], v[84:87], v[92:95], v[20:35]
    v_mfma_f32_32x32x16_bf16 v[36:51], v[84:87], v[96:99], v[36:51]
    v_mfma_f32_32x32x16_bf16 v[52:67], v[88:91], v[92:95], v[52:67]
    v_mfma_f32_32x32x16_bf16 v[68:83], v[88:91], v[96:99], v[68:83]
    ds_read_b128 v[84:87], v16 offset:32
    ds_read_b128 v[88:91], v16 offset:4640
    ds_read_b128 v[92:95], v17 offset:32
    ds_read_b128 v[96:99], v17 offset:4640
    s_waitcnt lgkmcnt(0)
    v_mfma_f32_32x32x16_bf16 v[20:35], v[84:87], v[92:95], v[20:35]
    v_mfma_f32_32x32x16_bf16 v[36:51], v[84:87], v[96:99], v[36:51]
    v_mfma_f32_32x32x16_bf16 v[52:67], v[88:91], v[92:95], v[52:67]
    v_mfma_f32_32x32x16_bf16 v[68:83], v[88:91], v[96:99], v[68:83]
    ds_read_b128 v[84:87], v16 offset:64
    ds_read_b128 v[88:91], v16 offset:4672
    ds_read_b128 v[92:95], v17 offset:64
    ds_read_b128 v[96:99], v17 offset:4672
    s_waitcnt lgkmcnt(0)
    v_mfma_f32_32x32x16_bf16 v[20:35], v[84:87], v[92:95], v[20:35]
    v_mfma_f32_32x32x16_bf16 v[36:51], v[84:87], v[96:99], v[36:51]
    v_mfma_f32_32x32x16_bf16 v[52:67], v[88:91], v[92:95], v[52:67]
    v_mfma_f32_32x32x16_bf16 v[68:83], v[88:91], v[96:99], v[68:83]
    ds_read_b128 v[84:87], v16 offset:96
    ds_read_b128 v[88:91], v16 offset:4704
    ds_read_b128 v[92:95], v17 offset:96
    ds_read_b128 v[96:99], v17 offset:4704
    s_waitcnt lgkmcnt(0)
    v_mfma_f32_32x32x16_bf16 v[20:35], v[84:87], v[92:95], v[20:35]
    v_mfma_f32_32x32x16_bf16 v[36:51], v[84:87], v[96:99], v[36:51]
    v_mfma_f32_32x32x16_bf16 v[52:67], v[88:91], v[92:95], v[52:67]
    v_mfma_f32_32x32x16_bf16 v[68:83], v[88:91], v[96:99], v[68:83]
    s_waitcnt vmcnt(0)
    ds_write_b128 v3, v[100:103] offset:0
    ds_write_b128 v3, v[104:107] offset:4608
    ds_write_b128 v3, v[108:111] offset:9216
    ds_write_b128 v3, v[112:115] offset:13824
    ds_write_b128 v3, v[116:119] offset:18432
    ds_write_b128 v3, v[120:123] offset:23040
    ds_write_b128 v3, v[124:127] offset:27648
    ds_write_b128 v3, v[128:131] offset:32256
    s_waitcnt lgkmcnt(0)
    s_barrier
    ds_read_b128 v[84:87], v11 offset:0
    ds_read_b128 v[88:91], v11 offset:4608
    ds_read_b128 v[92:95], v12 offset:0
    ds_read_b128 v[96:99], v12 offset:4608
    s_waitcnt lgkmcnt(0)
    v_mfma_f32_32x32x16_bf16 v[20:35], v[84:87], v[92:95], v[20:35]
    v_mfma_f32_32x32x16_bf16 v[36:51], v[84:87], v[96:99], v[36:51]
    v_mfma_f32_32x32x16_bf16 v[52:67], v[88:91], v[92:95], v[52:67]
    v_mfma_f32_32x32x16_bf16 v[68:83], v[88:91], v[96:99], v[68:83]
    ds_read_b128 v[84:87], v11 offset:32
    ds_read_b128 v[88:91], v11 offset:4640
    ds_read_b128 v[92:95], v12 offset:32
    ds_read_b128 v[96:99], v12 offset:4640
    s_waitcnt lgkmcnt(0)
    v_mfma_f32_32x32x16_bf16 v[20:35], v[84:87], v[92:95], v[20:35]
    v_mfma_f32_32x32x16_bf16 v[36:51], v[84:87], v[96:99], v[36:51]
    v_mfma_f32_32x32x16_bf16 v[52:67], v[88:91], v[92:95], v[52:67]
    v_mfma_f32_32x32x16_bf16 v[68:83], v[88:91], v[96:99], v[68:83]
    ds_read_b128 v[84:87], v11 offset:64
    ds_read_b128 v[88:91], v11 offset:4672
    ds_read_b128 v[92:95], v12 offset:64
    ds_read_b128 v[96:99], v12 offset:4672
    s_waitcnt lgkmcnt(0)
    v_mfma_f32_32x32x16_bf16 v[20:35], v[84:87], v[92:95], v[20:35]
    v_mfma_f32_32x32x16_bf16 v[36:51], v[84:87], v[96:99], v[36:51]
    v_mfma_f32_32x32x16_bf16 v[52:67], v[88:91], v[92:95], v[52:67]
    v_mfma_f32_32x32x16_bf16 v[68:83], v[88:91], v[96:99], v[68:83]
    ds_read_b128 v[84:87], v11 offset:96
    ds_read_b128 v[88:91], v11 offset:4704
    ds_read_b128 v[92:95], v12 offset:96
    ds_read_b128 v[96:99], v12 offset:4704
    s_waitcnt lgkmcnt(0)
    v_mfma_f32_32x32x16_bf16 v[20:35], v[84:87], v[92:95], v[20:35]
    v_mfma_f32_32x32x16_bf16 v[36:51], v[84:87], v[96:99], v[36:51]
    v_mfma_f32_32x32x16_bf16 v[52:67], v[88:91], v[92:95], v[52:67]
    v_mfma_f32_32x32x16_bf16 v[68:83], v[88:91], v[96:99], v[68:83]
    s_nop 15
    s_nop 7
    s_mul_i32 s24, s22, 128
    v_mul_u32_u24 v1, 64, v6
    v_add_u32 v1, v1, v8
    v_add_u32 v1, s24, v1
    s_mov_b32 s26, 4096
    v_mul_lo_u32 v1, v1, s26
    s_mul_i32 s24, s21, 128
    v_mul_u32_u24 v2, 64, v7
    v_lshl_add_u32 v2, v9, 2, v2
    v_add_u32 v2, s24, v2
    v_lshlrev_b32 v2, 1, v2
    s_mul_i32 s25, s20, 0
    v_add_u32 v1, v1, v2
    v_add_u32 v1, s25, v1
    v_cvt_pk_bf16_f32 v86, v20, v21
    v_cvt_pk_bf16_f32 v87, v22, v23
    buffer_store_dwordx2 v[86:87], v1, s[16:19], 0 offen offset:0 sc1
    s_waitcnt vmcnt(0)
    v_cvt_pk_bf16_f32 v86, v24, v25
    v_cvt_pk_bf16_f32 v87, v26, v27
    buffer_store_dwordx2 v[86:87], v1, s[16:19], 0 offen offset:16 sc1
    s_waitcnt vmcnt(0)
    v_cvt_pk_bf16_f32 v86, v28, v29
    v_cvt_pk_bf16_f32 v87, v30, v31
    buffer_store_dwordx2 v[86:87], v1, s[16:19], 0 offen offset:32 sc1
    s_waitcnt vmcnt(0)
    v_cvt_pk_bf16_f32 v86, v32, v33
    v_cvt_pk_bf16_f32 v87, v34, v35
    buffer_store_dwordx2 v[86:87], v1, s[16:19], 0 offen offset:48 sc1
    s_waitcnt vmcnt(0)
    v_cvt_pk_bf16_f32 v86, v36, v37
    v_cvt_pk_bf16_f32 v87, v38, v39
    s_mov_b32 s26, 131072
    buffer_store_dwordx2 v[86:87], v1, s[16:19], s26 offen offset:0 sc1
    s_waitcnt vmcnt(0)
    v_cvt_pk_bf16_f32 v86, v40, v41
    v_cvt_pk_bf16_f32 v87, v42, v43
    s_mov_b32 s26, 131072
    buffer_store_dwordx2 v[86:87], v1, s[16:19], s26 offen offset:16 sc1
    s_waitcnt vmcnt(0)
    v_cvt_pk_bf16_f32 v86, v44, v45
    v_cvt_pk_bf16_f32 v87, v46, v47
    s_mov_b32 s26, 131072
    buffer_store_dwordx2 v[86:87], v1, s[16:19], s26 offen offset:32 sc1
    s_waitcnt vmcnt(0)
    v_cvt_pk_bf16_f32 v86, v48, v49
    v_cvt_pk_bf16_f32 v87, v50, v51
    s_mov_b32 s26, 131072
    buffer_store_dwordx2 v[86:87], v1, s[16:19], s26 offen offset:48 sc1
    s_waitcnt vmcnt(0)
    v_cvt_pk_bf16_f32 v86, v52, v53
    v_cvt_pk_bf16_f32 v87, v54, v55
    buffer_store_dwordx2 v[86:87], v1, s[16:19], 0 offen offset:64 sc1
    s_waitcnt vmcnt(0)
    v_cvt_pk_bf16_f32 v86, v56, v57
    v_cvt_pk_bf16_f32 v87, v58, v59
    buffer_store_dwordx2 v[86:87], v1, s[16:19], 0 offen offset:80 sc1
    s_waitcnt vmcnt(0)
    v_cvt_pk_bf16_f32 v86, v60, v61
    v_cvt_pk_bf16_f32 v87, v62, v63
    buffer_store_dwordx2 v[86:87], v1, s[16:19], 0 offen offset:96 sc1
    s_waitcnt vmcnt(0)
    v_cvt_pk_bf16_f32 v86, v64, v65
    v_cvt_pk_bf16_f32 v87, v66, v67
    buffer_store_dwordx2 v[86:87], v1, s[16:19], 0 offen offset:112 sc1
    s_waitcnt vmcnt(0)
    v_cvt_pk_bf16_f32 v86, v68, v69
    v_cvt_pk_bf16_f32 v87, v70, v71
    s_mov_b32 s26, 131072
    buffer_store_dwordx2 v[86:87], v1, s[16:19], s26 offen offset:64 sc1
    s_waitcnt vmcnt(0)
    v_cvt_pk_bf16_f32 v86, v72, v73
    v_cvt_pk_bf16_f32 v87, v74, v75
    s_mov_b32 s26, 131072
    buffer_store_dwordx2 v[86:87], v1, s[16:19], s26 offen offset:80 sc1
    s_waitcnt vmcnt(0)
    v_cvt_pk_bf16_f32 v86, v76, v77
    v_cvt_pk_bf16_f32 v87, v78, v79
    s_mov_b32 s26, 131072
    buffer_store_dwordx2 v[86:87], v1, s[16:19], s26 offen offset:96 sc1
    s_waitcnt vmcnt(0)
    v_cvt_pk_bf16_f32 v86, v80, v81
    v_cvt_pk_bf16_f32 v87, v82, v83
    s_mov_b32 s26, 131072
    buffer_store_dwordx2 v[86:87], v1, s[16:19], s26 offen offset:112 sc1
    s_waitcnt vmcnt(0)
    s_barrier
    s_load_dwordx2 s[32:33], s[0:1], 104
    s_waitcnt lgkmcnt(0)
    s_and_b32 s33, s33, 0xffff
    s_mov_b32 s34, 0x100
    s_mov_b32 s35, 0x00020000
    v_cmp_eq_u32 vcc, 0, v0
    s_and_b64 exec, exec, vcc
    s_lshl_b32 s24, s21, 2
    v_mov_b32 v8, 1
    v_mov_b32 v9, s24
    buffer_atomic_add v8, v9, s[32:35], 0 offen sc1
x_gvo_done:
    s_endpgm
x_gf2:
    s_sub_u32 s2, s2, 896
    s_cmp_ge_u32 s2, 224
    s_cbranch_scc1 x_gu
    s_mul_hi_u32 s20, s2, 0x124924a
    s_mul_i32 s24, s20, 224
    s_sub_u32 s23, s2, s24
    s_mul_hi_u32 s22, s23, 0x24924925
    s_mul_i32 s24, s22, 7
    s_sub_u32 s21, s23, s24
    s_load_dwordx2 s[8:9], s[0:1], 112
    s_waitcnt lgkmcnt(0)
    s_add_u32 s8, s8, 0x1600000
    s_addc_u32 s9, s9, 0
    s_and_b32 s9, s9, 0xffff
    s_mov_b32 s10, 0xea00000
    s_mov_b32 s11, 0x00020000
    s_load_dwordx2 s[12:13], s[0:1], 112
    s_waitcnt lgkmcnt(0)
    s_add_u32 s12, s12, 0x1800000
    s_addc_u32 s13, s13, 0
    s_and_b32 s13, s13, 0xffff
    s_mov_b32 s14, 0xe800000
    s_mov_b32 s15, 0x00020000
    s_load_dwordx2 s[16:17], s[0:1], 112
    s_waitcnt lgkmcnt(0)
    s_add_u32 s16, s16, 0x2000000
    s_addc_u32 s17, s17, 0
    s_and_b32 s17, s17, 0xffff
    s_mov_b32 s18, 0xe000000
    s_mov_b32 s19, 0x00020000
    s_load_dwordx2 s[28:29], s[0:1], 88
    s_waitcnt lgkmcnt(0)
    s_and_b32 s29, s29, 0xffff
    s_mov_b32 s30, 0x380
    s_mov_b32 s31, 0x00020000
    v_lshrrev_b32 v4, 3, v0
    v_and_b32 v5, 7, v0
    v_lshlrev_b32 v5, 4, v5
    s_mul_i32 s24, s21, 229376
    s_mul_i32 s25, s20, 0
    s_add_u32 s24, s24, s25
    s_mov_b32 s26, 3584
    v_mul_lo_u32 v1, v4, s26
    v_add_u32 v1, v1, v5
    v_add_u32 v1, s24, v1
    s_mul_i32 s24, s22, 229376
    s_mul_i32 s25, s20, 0
    s_add_u32 s24, s24, s25
    s_mov_b32 s26, 3584
    v_mul_lo_u32 v2, v4, s26
    v_add_u32 v2, v2, v5
    v_add_u32 v2, s24, v2
    v_mul_u32_u24 v3, 144, v4
    v_add_u32 v3, v3, v5
    v_lshrrev_b32 v6, 6, v0
    v_and_b32 v7, 1, v6
    v_lshrrev_b32 v6, 1, v6
    v_and_b32 v8, 31, v0
    v_bfe_u32 v9, v0, 5, 1
    v_lshlrev_b32 v10, 4, v9
    v_mul_u32_u24 v11, 32, v7
    v_add_u32 v11, v11, v8
    v_mul_u32_u24 v11, 144, v11
    v_add_u32 v11, v11, v10
    v_mul_u32_u24 v12, 32, v6
    v_add_u32 v12, v12, v8
    v_mul_u32_u24 v12, 144, v12
    v_add_u32 v12, v12, v10
    v_add_u32 v12, 9216, v12
    v_add_u32 v15, 18432, v3
    v_add_u32 v16, 18432, v11
    v_add_u32 v17, 18432, v12
    v_mov_b32 v20, 0
    v_mov_b32 v21, 0
    v_mov_b32 v22, 0
    v_mov_b32 v23, 0
    v_mov_b32 v24, 0
    v_mov_b32 v25, 0
    v_mov_b32 v26, 0
    v_mov_b32 v27, 0
    v_mov_b32 v28, 0
    v_mov_b32 v29, 0
    v_mov_b32 v30, 0
    v_mov_b32 v31, 0
    v_mov_b32 v32, 0
    v_mov_b32 v33, 0
    v_mov_b32 v34, 0
    v_mov_b32 v35, 0
    s_mov_b32 s27, 0
    buffer_load_dwordx4 v[44:47], v1, s[8:11], s27 offen
    v_add_u32 v13, 114688, v1
    buffer_load_dwordx4 v[48:51], v13, s[8:11], s27 offen
    buffer_load_dwordx4 v[52:55], v2, s[12:15], s27 offen
    v_add_u32 v14, 114688, v2
    buffer_load_dwordx4 v[56:59], v14, s[12:15], s27 offen
    s_waitcnt vmcnt(0)
    ds_write_b128 v3, v[44:47] offset:0
    ds_write_b128 v3, v[48:51] offset:4608
    ds_write_b128 v3, v[52:55] offset:9216
    ds_write_b128 v3, v[56:59] offset:13824
    s_waitcnt lgkmcnt(0)
    s_barrier
    s_mov_b32 s27, 128
    buffer_load_dwordx4 v[44:47], v1, s[8:11], s27 offen
    v_add_u32 v13, 114688, v1
    buffer_load_dwordx4 v[48:51], v13, s[8:11], s27 offen
    buffer_load_dwordx4 v[52:55], v2, s[12:15], s27 offen
    v_add_u32 v14, 114688, v2
    buffer_load_dwordx4 v[56:59], v14, s[12:15], s27 offen
    ds_read_b128 v[36:39], v11 offset:0
    ds_read_b128 v[40:43], v12 offset:0
    s_waitcnt lgkmcnt(0)
    v_mfma_f32_32x32x16_bf16 v[20:35], v[36:39], v[40:43], v[20:35]
    ds_read_b128 v[36:39], v11 offset:32
    ds_read_b128 v[40:43], v12 offset:32
    s_waitcnt lgkmcnt(0)
    v_mfma_f32_32x32x16_bf16 v[20:35], v[36:39], v[40:43], v[20:35]
    ds_read_b128 v[36:39], v11 offset:64
    ds_read_b128 v[40:43], v12 offset:64
    s_waitcnt lgkmcnt(0)
    v_mfma_f32_32x32x16_bf16 v[20:35], v[36:39], v[40:43], v[20:35]
    ds_read_b128 v[36:39], v11 offset:96
    ds_read_b128 v[40:43], v12 offset:96
    s_waitcnt lgkmcnt(0)
    v_mfma_f32_32x32x16_bf16 v[20:35], v[36:39], v[40:43], v[20:35]
    s_waitcnt vmcnt(0)
    ds_write_b128 v15, v[44:47] offset:0
    ds_write_b128 v15, v[48:51] offset:4608
    ds_write_b128 v15, v[52:55] offset:9216
    ds_write_b128 v15, v[56:59] offset:13824
    s_waitcnt lgkmcnt(0)
    s_barrier
    s_mov_b32 s27, 256
    buffer_load_dwordx4 v[44:47], v1, s[8:11], s27 offen
    v_add_u32 v13, 114688, v1
    buffer_load_dwordx4 v[48:51], v13, s[8:11], s27 offen
    buffer_load_dwordx4 v[52:55], v2, s[12:15], s27 offen
    v_add_u32 v14, 114688, v2
    buffer_load_dwordx4 v[56:59], v14, s[12:15], s27 offen
    ds_read_b128 v[36:39], v16 offset:0
    ds_read_b128 v[40:43], v17 offset:0
    s_waitcnt lgkmcnt(0)
    v_mfma_f32_32x32x16_bf16 v[20:35], v[36:39], v[40:43], v[20:35]
    ds_read_b128 v[36:39], v16 offset:32
    ds_read_b128 v[40:43], v17 offset:32
    s_waitcnt lgkmcnt(0)
    v_mfma_f32_32x32x16_bf16 v[20:35], v[36:39], v[40:43], v[20:35]
    ds_read_b128 v[36:39], v16 offset:64
    ds_read_b128 v[40:43], v17 offset:64
    s_waitcnt lgkmcnt(0)
    v_mfma_f32_32x32x16_bf16 v[20:35], v[36:39], v[40:43], v[20:35]
    ds_read_b128 v[36:39], v16 offset:96
    ds_read_b128 v[40:43], v17 offset:96
    s_waitcnt lgkmcnt(0)
    v_mfma_f32_32x32x16_bf16 v[20:35], v[36:39], v[40:43], v[20:35]
    s_waitcnt vmcnt(0)
    ds_write_b128 v3, v[44:47] offset:0
    ds_write_b128 v3, v[48:51] offset:4608
    ds_write_b128 v3, v[52:55] offset:9216
    ds_write_b128 v3, v[56:59] offset:13824
    s_waitcnt lgkmcnt(0)
    s_barrier
    s_mov_b32 s27, 384
    buffer_load_dwordx4 v[44:47], v1, s[8:11], s27 offen
    v_add_u32 v13, 114688, v1
    buffer_load_dwordx4 v[48:51], v13, s[8:11], s27 offen
    buffer_load_dwordx4 v[52:55], v2, s[12:15], s27 offen
    v_add_u32 v14, 114688, v2
    buffer_load_dwordx4 v[56:59], v14, s[12:15], s27 offen
    ds_read_b128 v[36:39], v11 offset:0
    ds_read_b128 v[40:43], v12 offset:0
    s_waitcnt lgkmcnt(0)
    v_mfma_f32_32x32x16_bf16 v[20:35], v[36:39], v[40:43], v[20:35]
    ds_read_b128 v[36:39], v11 offset:32
    ds_read_b128 v[40:43], v12 offset:32
    s_waitcnt lgkmcnt(0)
    v_mfma_f32_32x32x16_bf16 v[20:35], v[36:39], v[40:43], v[20:35]
    ds_read_b128 v[36:39], v11 offset:64
    ds_read_b128 v[40:43], v12 offset:64
    s_waitcnt lgkmcnt(0)
    v_mfma_f32_32x32x16_bf16 v[20:35], v[36:39], v[40:43], v[20:35]
    ds_read_b128 v[36:39], v11 offset:96
    ds_read_b128 v[40:43], v12 offset:96
    s_waitcnt lgkmcnt(0)
    v_mfma_f32_32x32x16_bf16 v[20:35], v[36:39], v[40:43], v[20:35]
    s_waitcnt vmcnt(0)
    ds_write_b128 v15, v[44:47] offset:0
    ds_write_b128 v15, v[48:51] offset:4608
    ds_write_b128 v15, v[52:55] offset:9216
    ds_write_b128 v15, v[56:59] offset:13824
    s_waitcnt lgkmcnt(0)
    s_barrier
    s_mov_b32 s27, 512
    buffer_load_dwordx4 v[44:47], v1, s[8:11], s27 offen
    v_add_u32 v13, 114688, v1
    buffer_load_dwordx4 v[48:51], v13, s[8:11], s27 offen
    buffer_load_dwordx4 v[52:55], v2, s[12:15], s27 offen
    v_add_u32 v14, 114688, v2
    buffer_load_dwordx4 v[56:59], v14, s[12:15], s27 offen
    ds_read_b128 v[36:39], v16 offset:0
    ds_read_b128 v[40:43], v17 offset:0
    s_waitcnt lgkmcnt(0)
    v_mfma_f32_32x32x16_bf16 v[20:35], v[36:39], v[40:43], v[20:35]
    ds_read_b128 v[36:39], v16 offset:32
    ds_read_b128 v[40:43], v17 offset:32
    s_waitcnt lgkmcnt(0)
    v_mfma_f32_32x32x16_bf16 v[20:35], v[36:39], v[40:43], v[20:35]
    ds_read_b128 v[36:39], v16 offset:64
    ds_read_b128 v[40:43], v17 offset:64
    s_waitcnt lgkmcnt(0)
    v_mfma_f32_32x32x16_bf16 v[20:35], v[36:39], v[40:43], v[20:35]
    ds_read_b128 v[36:39], v16 offset:96
    ds_read_b128 v[40:43], v17 offset:96
    s_waitcnt lgkmcnt(0)
    v_mfma_f32_32x32x16_bf16 v[20:35], v[36:39], v[40:43], v[20:35]
    s_waitcnt vmcnt(0)
    ds_write_b128 v3, v[44:47] offset:0
    ds_write_b128 v3, v[48:51] offset:4608
    ds_write_b128 v3, v[52:55] offset:9216
    ds_write_b128 v3, v[56:59] offset:13824
    s_waitcnt lgkmcnt(0)
    s_barrier
    s_mov_b32 s27, 640
    buffer_load_dwordx4 v[44:47], v1, s[8:11], s27 offen
    v_add_u32 v13, 114688, v1
    buffer_load_dwordx4 v[48:51], v13, s[8:11], s27 offen
    buffer_load_dwordx4 v[52:55], v2, s[12:15], s27 offen
    v_add_u32 v14, 114688, v2
    buffer_load_dwordx4 v[56:59], v14, s[12:15], s27 offen
    ds_read_b128 v[36:39], v11 offset:0
    ds_read_b128 v[40:43], v12 offset:0
    s_waitcnt lgkmcnt(0)
    v_mfma_f32_32x32x16_bf16 v[20:35], v[36:39], v[40:43], v[20:35]
    ds_read_b128 v[36:39], v11 offset:32
    ds_read_b128 v[40:43], v12 offset:32
    s_waitcnt lgkmcnt(0)
    v_mfma_f32_32x32x16_bf16 v[20:35], v[36:39], v[40:43], v[20:35]
    ds_read_b128 v[36:39], v11 offset:64
    ds_read_b128 v[40:43], v12 offset:64
    s_waitcnt lgkmcnt(0)
    v_mfma_f32_32x32x16_bf16 v[20:35], v[36:39], v[40:43], v[20:35]
    ds_read_b128 v[36:39], v11 offset:96
    ds_read_b128 v[40:43], v12 offset:96
    s_waitcnt lgkmcnt(0)
    v_mfma_f32_32x32x16_bf16 v[20:35], v[36:39], v[40:43], v[20:35]
    s_waitcnt vmcnt(0)
    ds_write_b128 v15, v[44:47] offset:0
    ds_write_b128 v15, v[48:51] offset:4608
    ds_write_b128 v15, v[52:55] offset:9216
    ds_write_b128 v15, v[56:59] offset:13824
    s_waitcnt lgkmcnt(0)
    s_barrier
    s_mov_b32 s27, 768
    buffer_load_dwordx4 v[44:47], v1, s[8:11], s27 offen
    v_add_u32 v13, 114688, v1
    buffer_load_dwordx4 v[48:51], v13, s[8:11], s27 offen
    buffer_load_dwordx4 v[52:55], v2, s[12:15], s27 offen
    v_add_u32 v14, 114688, v2
    buffer_load_dwordx4 v[56:59], v14, s[12:15], s27 offen
    ds_read_b128 v[36:39], v16 offset:0
    ds_read_b128 v[40:43], v17 offset:0
    s_waitcnt lgkmcnt(0)
    v_mfma_f32_32x32x16_bf16 v[20:35], v[36:39], v[40:43], v[20:35]
    ds_read_b128 v[36:39], v16 offset:32
    ds_read_b128 v[40:43], v17 offset:32
    s_waitcnt lgkmcnt(0)
    v_mfma_f32_32x32x16_bf16 v[20:35], v[36:39], v[40:43], v[20:35]
    ds_read_b128 v[36:39], v16 offset:64
    ds_read_b128 v[40:43], v17 offset:64
    s_waitcnt lgkmcnt(0)
    v_mfma_f32_32x32x16_bf16 v[20:35], v[36:39], v[40:43], v[20:35]
    ds_read_b128 v[36:39], v16 offset:96
    ds_read_b128 v[40:43], v17 offset:96
    s_waitcnt lgkmcnt(0)
    v_mfma_f32_32x32x16_bf16 v[20:35], v[36:39], v[40:43], v[20:35]
    s_waitcnt vmcnt(0)
    ds_write_b128 v3, v[44:47] offset:0
    ds_write_b128 v3, v[48:51] offset:4608
    ds_write_b128 v3, v[52:55] offset:9216
    ds_write_b128 v3, v[56:59] offset:13824
    s_waitcnt lgkmcnt(0)
    s_barrier
    s_mov_b32 s27, 896
    buffer_load_dwordx4 v[44:47], v1, s[8:11], s27 offen
    v_add_u32 v13, 114688, v1
    buffer_load_dwordx4 v[48:51], v13, s[8:11], s27 offen
    buffer_load_dwordx4 v[52:55], v2, s[12:15], s27 offen
    v_add_u32 v14, 114688, v2
    buffer_load_dwordx4 v[56:59], v14, s[12:15], s27 offen
    ds_read_b128 v[36:39], v11 offset:0
    ds_read_b128 v[40:43], v12 offset:0
    s_waitcnt lgkmcnt(0)
    v_mfma_f32_32x32x16_bf16 v[20:35], v[36:39], v[40:43], v[20:35]
    ds_read_b128 v[36:39], v11 offset:32
    ds_read_b128 v[40:43], v12 offset:32
    s_waitcnt lgkmcnt(0)
    v_mfma_f32_32x32x16_bf16 v[20:35], v[36:39], v[40:43], v[20:35]
    ds_read_b128 v[36:39], v11 offset:64
    ds_read_b128 v[40:43], v12 offset:64
    s_waitcnt lgkmcnt(0)
    v_mfma_f32_32x32x16_bf16 v[20:35], v[36:39], v[40:43], v[20:35]
    ds_read_b128 v[36:39], v11 offset:96
    ds_read_b128 v[40:43], v12 offset:96
    s_waitcnt lgkmcnt(0)
    v_mfma_f32_32x32x16_bf16 v[20:35], v[36:39], v[40:43], v[20:35]
    s_waitcnt vmcnt(0)
    ds_write_b128 v15, v[44:47] offset:0
    ds_write_b128 v15, v[48:51] offset:4608
    ds_write_b128 v15, v[52:55] offset:9216
    ds_write_b128 v15, v[56:59] offset:13824
    s_waitcnt lgkmcnt(0)
    s_barrier
    s_mov_b32 s27, 1024
    buffer_load_dwordx4 v[44:47], v1, s[8:11], s27 offen
    v_add_u32 v13, 114688, v1
    buffer_load_dwordx4 v[48:51], v13, s[8:11], s27 offen
    buffer_load_dwordx4 v[52:55], v2, s[12:15], s27 offen
    v_add_u32 v14, 114688, v2
    buffer_load_dwordx4 v[56:59], v14, s[12:15], s27 offen
    ds_read_b128 v[36:39], v16 offset:0
    ds_read_b128 v[40:43], v17 offset:0
    s_waitcnt lgkmcnt(0)
    v_mfma_f32_32x32x16_bf16 v[20:35], v[36:39], v[40:43], v[20:35]
    ds_read_b128 v[36:39], v16 offset:32
    ds_read_b128 v[40:43], v17 offset:32
    s_waitcnt lgkmcnt(0)
    v_mfma_f32_32x32x16_bf16 v[20:35], v[36:39], v[40:43], v[20:35]
    ds_read_b128 v[36:39], v16 offset:64
    ds_read_b128 v[40:43], v17 offset:64
    s_waitcnt lgkmcnt(0)
    v_mfma_f32_32x32x16_bf16 v[20:35], v[36:39], v[40:43], v[20:35]
    ds_read_b128 v[36:39], v16 offset:96
    ds_read_b128 v[40:43], v17 offset:96
    s_waitcnt lgkmcnt(0)
    v_mfma_f32_32x32x16_bf16 v[20:35], v[36:39], v[40:43], v[20:35]
    s_waitcnt vmcnt(0)
    ds_write_b128 v3, v[44:47] offset:0
    ds_write_b128 v3, v[48:51] offset:4608
    ds_write_b128 v3, v[52:55] offset:9216
    ds_write_b128 v3, v[56:59] offset:13824
    s_waitcnt lgkmcnt(0)
    s_barrier
    s_mov_b32 s27, 1152
    buffer_load_dwordx4 v[44:47], v1, s[8:11], s27 offen
    v_add_u32 v13, 114688, v1
    buffer_load_dwordx4 v[48:51], v13, s[8:11], s27 offen
    buffer_load_dwordx4 v[52:55], v2, s[12:15], s27 offen
    v_add_u32 v14, 114688, v2
    buffer_load_dwordx4 v[56:59], v14, s[12:15], s27 offen
    ds_read_b128 v[36:39], v11 offset:0
    ds_read_b128 v[40:43], v12 offset:0
    s_waitcnt lgkmcnt(0)
    v_mfma_f32_32x32x16_bf16 v[20:35], v[36:39], v[40:43], v[20:35]
    ds_read_b128 v[36:39], v11 offset:32
    ds_read_b128 v[40:43], v12 offset:32
    s_waitcnt lgkmcnt(0)
    v_mfma_f32_32x32x16_bf16 v[20:35], v[36:39], v[40:43], v[20:35]
    ds_read_b128 v[36:39], v11 offset:64
    ds_read_b128 v[40:43], v12 offset:64
    s_waitcnt lgkmcnt(0)
    v_mfma_f32_32x32x16_bf16 v[20:35], v[36:39], v[40:43], v[20:35]
    ds_read_b128 v[36:39], v11 offset:96
    ds_read_b128 v[40:43], v12 offset:96
    s_waitcnt lgkmcnt(0)
    v_mfma_f32_32x32x16_bf16 v[20:35], v[36:39], v[40:43], v[20:35]
    s_waitcnt vmcnt(0)
    ds_write_b128 v15, v[44:47] offset:0
    ds_write_b128 v15, v[48:51] offset:4608
    ds_write_b128 v15, v[52:55] offset:9216
    ds_write_b128 v15, v[56:59] offset:13824
    s_waitcnt lgkmcnt(0)
    s_barrier
    s_mov_b32 s27, 1280
    buffer_load_dwordx4 v[44:47], v1, s[8:11], s27 offen
    v_add_u32 v13, 114688, v1
    buffer_load_dwordx4 v[48:51], v13, s[8:11], s27 offen
    buffer_load_dwordx4 v[52:55], v2, s[12:15], s27 offen
    v_add_u32 v14, 114688, v2
    buffer_load_dwordx4 v[56:59], v14, s[12:15], s27 offen
    ds_read_b128 v[36:39], v16 offset:0
    ds_read_b128 v[40:43], v17 offset:0
    s_waitcnt lgkmcnt(0)
    v_mfma_f32_32x32x16_bf16 v[20:35], v[36:39], v[40:43], v[20:35]
    ds_read_b128 v[36:39], v16 offset:32
    ds_read_b128 v[40:43], v17 offset:32
    s_waitcnt lgkmcnt(0)
    v_mfma_f32_32x32x16_bf16 v[20:35], v[36:39], v[40:43], v[20:35]
    ds_read_b128 v[36:39], v16 offset:64
    ds_read_b128 v[40:43], v17 offset:64
    s_waitcnt lgkmcnt(0)
    v_mfma_f32_32x32x16_bf16 v[20:35], v[36:39], v[40:43], v[20:35]
    ds_read_b128 v[36:39], v16 offset:96
    ds_read_b128 v[40:43], v17 offset:96
    s_waitcnt lgkmcnt(0)
    v_mfma_f32_32x32x16_bf16 v[20:35], v[36:39], v[40:43], v[20:35]
    s_waitcnt vmcnt(0)
    ds_write_b128 v3, v[44:47] offset:0
    ds_write_b128 v3, v[48:51] offset:4608
    ds_write_b128 v3, v[52:55] offset:9216
    ds_write_b128 v3, v[56:59] offset:13824
    s_waitcnt lgkmcnt(0)
    s_barrier
    s_mov_b32 s27, 1408
    buffer_load_dwordx4 v[44:47], v1, s[8:11], s27 offen
    v_add_u32 v13, 114688, v1
    buffer_load_dwordx4 v[48:51], v13, s[8:11], s27 offen
    buffer_load_dwordx4 v[52:55], v2, s[12:15], s27 offen
    v_add_u32 v14, 114688, v2
    buffer_load_dwordx4 v[56:59], v14, s[12:15], s27 offen
    ds_read_b128 v[36:39], v11 offset:0
    ds_read_b128 v[40:43], v12 offset:0
    s_waitcnt lgkmcnt(0)
    v_mfma_f32_32x32x16_bf16 v[20:35], v[36:39], v[40:43], v[20:35]
    ds_read_b128 v[36:39], v11 offset:32
    ds_read_b128 v[40:43], v12 offset:32
    s_waitcnt lgkmcnt(0)
    v_mfma_f32_32x32x16_bf16 v[20:35], v[36:39], v[40:43], v[20:35]
    ds_read_b128 v[36:39], v11 offset:64
    ds_read_b128 v[40:43], v12 offset:64
    s_waitcnt lgkmcnt(0)
    v_mfma_f32_32x32x16_bf16 v[20:35], v[36:39], v[40:43], v[20:35]
    ds_read_b128 v[36:39], v11 offset:96
    ds_read_b128 v[40:43], v12 offset:96
    s_waitcnt lgkmcnt(0)
    v_mfma_f32_32x32x16_bf16 v[20:35], v[36:39], v[40:43], v[20:35]
    s_waitcnt vmcnt(0)
    ds_write_b128 v15, v[44:47] offset:0
    ds_write_b128 v15, v[48:51] offset:4608
    ds_write_b128 v15, v[52:55] offset:9216
    ds_write_b128 v15, v[56:59] offset:13824
    s_waitcnt lgkmcnt(0)
    s_barrier
    s_mov_b32 s27, 1536
    buffer_load_dwordx4 v[44:47], v1, s[8:11], s27 offen
    v_add_u32 v13, 114688, v1
    buffer_load_dwordx4 v[48:51], v13, s[8:11], s27 offen
    buffer_load_dwordx4 v[52:55], v2, s[12:15], s27 offen
    v_add_u32 v14, 114688, v2
    buffer_load_dwordx4 v[56:59], v14, s[12:15], s27 offen
    ds_read_b128 v[36:39], v16 offset:0
    ds_read_b128 v[40:43], v17 offset:0
    s_waitcnt lgkmcnt(0)
    v_mfma_f32_32x32x16_bf16 v[20:35], v[36:39], v[40:43], v[20:35]
    ds_read_b128 v[36:39], v16 offset:32
    ds_read_b128 v[40:43], v17 offset:32
    s_waitcnt lgkmcnt(0)
    v_mfma_f32_32x32x16_bf16 v[20:35], v[36:39], v[40:43], v[20:35]
    ds_read_b128 v[36:39], v16 offset:64
    ds_read_b128 v[40:43], v17 offset:64
    s_waitcnt lgkmcnt(0)
    v_mfma_f32_32x32x16_bf16 v[20:35], v[36:39], v[40:43], v[20:35]
    ds_read_b128 v[36:39], v16 offset:96
    ds_read_b128 v[40:43], v17 offset:96
    s_waitcnt lgkmcnt(0)
    v_mfma_f32_32x32x16_bf16 v[20:35], v[36:39], v[40:43], v[20:35]
    s_waitcnt vmcnt(0)
    ds_write_b128 v3, v[44:47] offset:0
    ds_write_b128 v3, v[48:51] offset:4608
    ds_write_b128 v3, v[52:55] offset:9216
    ds_write_b128 v3, v[56:59] offset:13824
    s_waitcnt lgkmcnt(0)
    s_barrier
    s_mov_b32 s27, 1664
    buffer_load_dwordx4 v[44:47], v1, s[8:11], s27 offen
    v_add_u32 v13, 114688, v1
    buffer_load_dwordx4 v[48:51], v13, s[8:11], s27 offen
    buffer_load_dwordx4 v[52:55], v2, s[12:15], s27 offen
    v_add_u32 v14, 114688, v2
    buffer_load_dwordx4 v[56:59], v14, s[12:15], s27 offen
    ds_read_b128 v[36:39], v11 offset:0
    ds_read_b128 v[40:43], v12 offset:0
    s_waitcnt lgkmcnt(0)
    v_mfma_f32_32x32x16_bf16 v[20:35], v[36:39], v[40:43], v[20:35]
    ds_read_b128 v[36:39], v11 offset:32
    ds_read_b128 v[40:43], v12 offset:32
    s_waitcnt lgkmcnt(0)
    v_mfma_f32_32x32x16_bf16 v[20:35], v[36:39], v[40:43], v[20:35]
    ds_read_b128 v[36:39], v11 offset:64
    ds_read_b128 v[40:43], v12 offset:64
    s_waitcnt lgkmcnt(0)
    v_mfma_f32_32x32x16_bf16 v[20:35], v[36:39], v[40:43], v[20:35]
    ds_read_b128 v[36:39], v11 offset:96
    ds_read_b128 v[40:43], v12 offset:96
    s_waitcnt lgkmcnt(0)
    v_mfma_f32_32x32x16_bf16 v[20:35], v[36:39], v[40:43], v[20:35]
    s_waitcnt vmcnt(0)
    ds_write_b128 v15, v[44:47] offset:0
    ds_write_b128 v15, v[48:51] offset:4608
    ds_write_b128 v15, v[52:55] offset:9216
    ds_write_b128 v15, v[56:59] offset:13824
    s_waitcnt lgkmcnt(0)
    s_barrier
    s_mov_b32 s27, 1792
    buffer_load_dwordx4 v[44:47], v1, s[8:11], s27 offen
    v_add_u32 v13, 114688, v1
    buffer_load_dwordx4 v[48:51], v13, s[8:11], s27 offen
    buffer_load_dwordx4 v[52:55], v2, s[12:15], s27 offen
    v_add_u32 v14, 114688, v2
    buffer_load_dwordx4 v[56:59], v14, s[12:15], s27 offen
    ds_read_b128 v[36:39], v16 offset:0
    ds_read_b128 v[40:43], v17 offset:0
    s_waitcnt lgkmcnt(0)
    v_mfma_f32_32x32x16_bf16 v[20:35], v[36:39], v[40:43], v[20:35]
    ds_read_b128 v[36:39], v16 offset:32
    ds_read_b128 v[40:43], v17 offset:32
    s_waitcnt lgkmcnt(0)
    v_mfma_f32_32x32x16_bf16 v[20:35], v[36:39], v[40:43], v[20:35]
    ds_read_b128 v[36:39], v16 offset:64
    ds_read_b128 v[40:43], v17 offset:64
    s_waitcnt lgkmcnt(0)
    v_mfma_f32_32x32x16_bf16 v[20:35], v[36:39], v[40:43], v[20:35]
    ds_read_b128 v[36:39], v16 offset:96
    ds_read_b128 v[40:43], v17 offset:96
    s_waitcnt lgkmcnt(0)
    v_mfma_f32_32x32x16_bf16 v[20:35], v[36:39], v[40:43], v[20:35]
    s_waitcnt vmcnt(0)
    ds_write_b128 v3, v[44:47] offset:0
    ds_write_b128 v3, v[48:51] offset:4608
    ds_write_b128 v3, v[52:55] offset:9216
    ds_write_b128 v3, v[56:59] offset:13824
    s_waitcnt lgkmcnt(0)
    s_barrier
    s_mov_b32 s27, 1920
    buffer_load_dwordx4 v[44:47], v1, s[8:11], s27 offen
    v_add_u32 v13, 114688, v1
    buffer_load_dwordx4 v[48:51], v13, s[8:11], s27 offen
    buffer_load_dwordx4 v[52:55], v2, s[12:15], s27 offen
    v_add_u32 v14, 114688, v2
    buffer_load_dwordx4 v[56:59], v14, s[12:15], s27 offen
    ds_read_b128 v[36:39], v11 offset:0
    ds_read_b128 v[40:43], v12 offset:0
    s_waitcnt lgkmcnt(0)
    v_mfma_f32_32x32x16_bf16 v[20:35], v[36:39], v[40:43], v[20:35]
    ds_read_b128 v[36:39], v11 offset:32
    ds_read_b128 v[40:43], v12 offset:32
    s_waitcnt lgkmcnt(0)
    v_mfma_f32_32x32x16_bf16 v[20:35], v[36:39], v[40:43], v[20:35]
    ds_read_b128 v[36:39], v11 offset:64
    ds_read_b128 v[40:43], v12 offset:64
    s_waitcnt lgkmcnt(0)
    v_mfma_f32_32x32x16_bf16 v[20:35], v[36:39], v[40:43], v[20:35]
    ds_read_b128 v[36:39], v11 offset:96
    ds_read_b128 v[40:43], v12 offset:96
    s_waitcnt lgkmcnt(0)
    v_mfma_f32_32x32x16_bf16 v[20:35], v[36:39], v[40:43], v[20:35]
    s_waitcnt vmcnt(0)
    ds_write_b128 v15, v[44:47] offset:0
    ds_write_b128 v15, v[48:51] offset:4608
    ds_write_b128 v15, v[52:55] offset:9216
    ds_write_b128 v15, v[56:59] offset:13824
    s_waitcnt lgkmcnt(0)
    s_barrier
    s_mov_b32 s27, 2048
    buffer_load_dwordx4 v[44:47], v1, s[8:11], s27 offen
    v_add_u32 v13, 114688, v1
    buffer_load_dwordx4 v[48:51], v13, s[8:11], s27 offen
    buffer_load_dwordx4 v[52:55], v2, s[12:15], s27 offen
    v_add_u32 v14, 114688, v2
    buffer_load_dwordx4 v[56:59], v14, s[12:15], s27 offen
    ds_read_b128 v[36:39], v16 offset:0
    ds_read_b128 v[40:43], v17 offset:0
    s_waitcnt lgkmcnt(0)
    v_mfma_f32_32x32x16_bf16 v[20:35], v[36:39], v[40:43], v[20:35]
    ds_read_b128 v[36:39], v16 offset:32
    ds_read_b128 v[40:43], v17 offset:32
    s_waitcnt lgkmcnt(0)
    v_mfma_f32_32x32x16_bf16 v[20:35], v[36:39], v[40:43], v[20:35]
    ds_read_b128 v[36:39], v16 offset:64
    ds_read_b128 v[40:43], v17 offset:64
    s_waitcnt lgkmcnt(0)
    v_mfma_f32_32x32x16_bf16 v[20:35], v[36:39], v[40:43], v[20:35]
    ds_read_b128 v[36:39], v16 offset:96
    ds_read_b128 v[40:43], v17 offset:96
    s_waitcnt lgkmcnt(0)
    v_mfma_f32_32x32x16_bf16 v[20:35], v[36:39], v[40:43], v[20:35]
    s_waitcnt vmcnt(0)
    ds_write_b128 v3, v[44:47] offset:0
    ds_write_b128 v3, v[48:51] offset:4608
    ds_write_b128 v3, v[52:55] offset:9216
    ds_write_b128 v3, v[56:59] offset:13824
    s_waitcnt lgkmcnt(0)
    s_barrier
    s_mov_b32 s27, 2176
    buffer_load_dwordx4 v[44:47], v1, s[8:11], s27 offen
    v_add_u32 v13, 114688, v1
    buffer_load_dwordx4 v[48:51], v13, s[8:11], s27 offen
    buffer_load_dwordx4 v[52:55], v2, s[12:15], s27 offen
    v_add_u32 v14, 114688, v2
    buffer_load_dwordx4 v[56:59], v14, s[12:15], s27 offen
    ds_read_b128 v[36:39], v11 offset:0
    ds_read_b128 v[40:43], v12 offset:0
    s_waitcnt lgkmcnt(0)
    v_mfma_f32_32x32x16_bf16 v[20:35], v[36:39], v[40:43], v[20:35]
    ds_read_b128 v[36:39], v11 offset:32
    ds_read_b128 v[40:43], v12 offset:32
    s_waitcnt lgkmcnt(0)
    v_mfma_f32_32x32x16_bf16 v[20:35], v[36:39], v[40:43], v[20:35]
    ds_read_b128 v[36:39], v11 offset:64
    ds_read_b128 v[40:43], v12 offset:64
    s_waitcnt lgkmcnt(0)
    v_mfma_f32_32x32x16_bf16 v[20:35], v[36:39], v[40:43], v[20:35]
    ds_read_b128 v[36:39], v11 offset:96
    ds_read_b128 v[40:43], v12 offset:96
    s_waitcnt lgkmcnt(0)
    v_mfma_f32_32x32x16_bf16 v[20:35], v[36:39], v[40:43], v[20:35]
    s_waitcnt vmcnt(0)
    ds_write_b128 v15, v[44:47] offset:0
    ds_write_b128 v15, v[48:51] offset:4608
    ds_write_b128 v15, v[52:55] offset:9216
    ds_write_b128 v15, v[56:59] offset:13824
    s_waitcnt lgkmcnt(0)
    s_barrier
    s_mov_b32 s27, 2304
    buffer_load_dwordx4 v[44:47], v1, s[8:11], s27 offen
    v_add_u32 v13, 114688, v1
    buffer_load_dwordx4 v[48:51], v13, s[8:11], s27 offen
    buffer_load_dwordx4 v[52:55], v2, s[12:15], s27 offen
    v_add_u32 v14, 114688, v2
    buffer_load_dwordx4 v[56:59], v14, s[12:15], s27 offen
    ds_read_b128 v[36:39], v16 offset:0
    ds_read_b128 v[40:43], v17 offset:0
    s_waitcnt lgkmcnt(0)
    v_mfma_f32_32x32x16_bf16 v[20:35], v[36:39], v[40:43], v[20:35]
    ds_read_b128 v[36:39], v16 offset:32
    ds_read_b128 v[40:43], v17 offset:32
    s_waitcnt lgkmcnt(0)
    v_mfma_f32_32x32x16_bf16 v[20:35], v[36:39], v[40:43], v[20:35]
    ds_read_b128 v[36:39], v16 offset:64
    ds_read_b128 v[40:43], v17 offset:64
    s_waitcnt lgkmcnt(0)
    v_mfma_f32_32x32x16_bf16 v[20:35], v[36:39], v[40:43], v[20:35]
    ds_read_b128 v[36:39], v16 offset:96
    ds_read_b128 v[40:43], v17 offset:96
    s_waitcnt lgkmcnt(0)
    v_mfma_f32_32x32x16_bf16 v[20:35], v[36:39], v[40:43], v[20:35]
    s_waitcnt vmcnt(0)
    ds_write_b128 v3, v[44:47] offset:0
    ds_write_b128 v3, v[48:51] offset:4608
    ds_write_b128 v3, v[52:55] offset:9216
    ds_write_b128 v3, v[56:59] offset:13824
    s_waitcnt lgkmcnt(0)
    s_barrier
    s_mov_b32 s27, 2432
    buffer_load_dwordx4 v[44:47], v1, s[8:11], s27 offen
    v_add_u32 v13, 114688, v1
    buffer_load_dwordx4 v[48:51], v13, s[8:11], s27 offen
    buffer_load_dwordx4 v[52:55], v2, s[12:15], s27 offen
    v_add_u32 v14, 114688, v2
    buffer_load_dwordx4 v[56:59], v14, s[12:15], s27 offen
    ds_read_b128 v[36:39], v11 offset:0
    ds_read_b128 v[40:43], v12 offset:0
    s_waitcnt lgkmcnt(0)
    v_mfma_f32_32x32x16_bf16 v[20:35], v[36:39], v[40:43], v[20:35]
    ds_read_b128 v[36:39], v11 offset:32
    ds_read_b128 v[40:43], v12 offset:32
    s_waitcnt lgkmcnt(0)
    v_mfma_f32_32x32x16_bf16 v[20:35], v[36:39], v[40:43], v[20:35]
    ds_read_b128 v[36:39], v11 offset:64
    ds_read_b128 v[40:43], v12 offset:64
    s_waitcnt lgkmcnt(0)
    v_mfma_f32_32x32x16_bf16 v[20:35], v[36:39], v[40:43], v[20:35]
    ds_read_b128 v[36:39], v11 offset:96
    ds_read_b128 v[40:43], v12 offset:96
    s_waitcnt lgkmcnt(0)
    v_mfma_f32_32x32x16_bf16 v[20:35], v[36:39], v[40:43], v[20:35]
    s_waitcnt vmcnt(0)
    ds_write_b128 v15, v[44:47] offset:0
    ds_write_b128 v15, v[48:51] offset:4608
    ds_write_b128 v15, v[52:55] offset:9216
    ds_write_b128 v15, v[56:59] offset:13824
    s_waitcnt lgkmcnt(0)
    s_barrier
    s_mov_b32 s27, 2560
    buffer_load_dwordx4 v[44:47], v1, s[8:11], s27 offen
    v_add_u32 v13, 114688, v1
    buffer_load_dwordx4 v[48:51], v13, s[8:11], s27 offen
    buffer_load_dwordx4 v[52:55], v2, s[12:15], s27 offen
    v_add_u32 v14, 114688, v2
    buffer_load_dwordx4 v[56:59], v14, s[12:15], s27 offen
    ds_read_b128 v[36:39], v16 offset:0
    ds_read_b128 v[40:43], v17 offset:0
    s_waitcnt lgkmcnt(0)
    v_mfma_f32_32x32x16_bf16 v[20:35], v[36:39], v[40:43], v[20:35]
    ds_read_b128 v[36:39], v16 offset:32
    ds_read_b128 v[40:43], v17 offset:32
    s_waitcnt lgkmcnt(0)
    v_mfma_f32_32x32x16_bf16 v[20:35], v[36:39], v[40:43], v[20:35]
    ds_read_b128 v[36:39], v16 offset:64
    ds_read_b128 v[40:43], v17 offset:64
    s_waitcnt lgkmcnt(0)
    v_mfma_f32_32x32x16_bf16 v[20:35], v[36:39], v[40:43], v[20:35]
    ds_read_b128 v[36:39], v16 offset:96
    ds_read_b128 v[40:43], v17 offset:96
    s_waitcnt lgkmcnt(0)
    v_mfma_f32_32x32x16_bf16 v[20:35], v[36:39], v[40:43], v[20:35]
    s_waitcnt vmcnt(0)
    ds_write_b128 v3, v[44:47] offset:0
    ds_write_b128 v3, v[48:51] offset:4608
    ds_write_b128 v3, v[52:55] offset:9216
    ds_write_b128 v3, v[56:59] offset:13824
    s_waitcnt lgkmcnt(0)
    s_barrier
    s_mov_b32 s27, 2688
    buffer_load_dwordx4 v[44:47], v1, s[8:11], s27 offen
    v_add_u32 v13, 114688, v1
    buffer_load_dwordx4 v[48:51], v13, s[8:11], s27 offen
    buffer_load_dwordx4 v[52:55], v2, s[12:15], s27 offen
    v_add_u32 v14, 114688, v2
    buffer_load_dwordx4 v[56:59], v14, s[12:15], s27 offen
    ds_read_b128 v[36:39], v11 offset:0
    ds_read_b128 v[40:43], v12 offset:0
    s_waitcnt lgkmcnt(0)
    v_mfma_f32_32x32x16_bf16 v[20:35], v[36:39], v[40:43], v[20:35]
    ds_read_b128 v[36:39], v11 offset:32
    ds_read_b128 v[40:43], v12 offset:32
    s_waitcnt lgkmcnt(0)
    v_mfma_f32_32x32x16_bf16 v[20:35], v[36:39], v[40:43], v[20:35]
    ds_read_b128 v[36:39], v11 offset:64
    ds_read_b128 v[40:43], v12 offset:64
    s_waitcnt lgkmcnt(0)
    v_mfma_f32_32x32x16_bf16 v[20:35], v[36:39], v[40:43], v[20:35]
    ds_read_b128 v[36:39], v11 offset:96
    ds_read_b128 v[40:43], v12 offset:96
    s_waitcnt lgkmcnt(0)
    v_mfma_f32_32x32x16_bf16 v[20:35], v[36:39], v[40:43], v[20:35]
    s_waitcnt vmcnt(0)
    ds_write_b128 v15, v[44:47] offset:0
    ds_write_b128 v15, v[48:51] offset:4608
    ds_write_b128 v15, v[52:55] offset:9216
    ds_write_b128 v15, v[56:59] offset:13824
    s_waitcnt lgkmcnt(0)
    s_barrier
    s_mov_b32 s27, 2816
    buffer_load_dwordx4 v[44:47], v1, s[8:11], s27 offen
    v_add_u32 v13, 114688, v1
    buffer_load_dwordx4 v[48:51], v13, s[8:11], s27 offen
    buffer_load_dwordx4 v[52:55], v2, s[12:15], s27 offen
    v_add_u32 v14, 114688, v2
    buffer_load_dwordx4 v[56:59], v14, s[12:15], s27 offen
    ds_read_b128 v[36:39], v16 offset:0
    ds_read_b128 v[40:43], v17 offset:0
    s_waitcnt lgkmcnt(0)
    v_mfma_f32_32x32x16_bf16 v[20:35], v[36:39], v[40:43], v[20:35]
    ds_read_b128 v[36:39], v16 offset:32
    ds_read_b128 v[40:43], v17 offset:32
    s_waitcnt lgkmcnt(0)
    v_mfma_f32_32x32x16_bf16 v[20:35], v[36:39], v[40:43], v[20:35]
    ds_read_b128 v[36:39], v16 offset:64
    ds_read_b128 v[40:43], v17 offset:64
    s_waitcnt lgkmcnt(0)
    v_mfma_f32_32x32x16_bf16 v[20:35], v[36:39], v[40:43], v[20:35]
    ds_read_b128 v[36:39], v16 offset:96
    ds_read_b128 v[40:43], v17 offset:96
    s_waitcnt lgkmcnt(0)
    v_mfma_f32_32x32x16_bf16 v[20:35], v[36:39], v[40:43], v[20:35]
    s_waitcnt vmcnt(0)
    ds_write_b128 v3, v[44:47] offset:0
    ds_write_b128 v3, v[48:51] offset:4608
    ds_write_b128 v3, v[52:55] offset:9216
    ds_write_b128 v3, v[56:59] offset:13824
    s_waitcnt lgkmcnt(0)
    s_barrier
    s_mov_b32 s27, 2944
    buffer_load_dwordx4 v[44:47], v1, s[8:11], s27 offen
    v_add_u32 v13, 114688, v1
    buffer_load_dwordx4 v[48:51], v13, s[8:11], s27 offen
    buffer_load_dwordx4 v[52:55], v2, s[12:15], s27 offen
    v_add_u32 v14, 114688, v2
    buffer_load_dwordx4 v[56:59], v14, s[12:15], s27 offen
    ds_read_b128 v[36:39], v11 offset:0
    ds_read_b128 v[40:43], v12 offset:0
    s_waitcnt lgkmcnt(0)
    v_mfma_f32_32x32x16_bf16 v[20:35], v[36:39], v[40:43], v[20:35]
    ds_read_b128 v[36:39], v11 offset:32
    ds_read_b128 v[40:43], v12 offset:32
    s_waitcnt lgkmcnt(0)
    v_mfma_f32_32x32x16_bf16 v[20:35], v[36:39], v[40:43], v[20:35]
    ds_read_b128 v[36:39], v11 offset:64
    ds_read_b128 v[40:43], v12 offset:64
    s_waitcnt lgkmcnt(0)
    v_mfma_f32_32x32x16_bf16 v[20:35], v[36:39], v[40:43], v[20:35]
    ds_read_b128 v[36:39], v11 offset:96
    ds_read_b128 v[40:43], v12 offset:96
    s_waitcnt lgkmcnt(0)
    v_mfma_f32_32x32x16_bf16 v[20:35], v[36:39], v[40:43], v[20:35]
    s_waitcnt vmcnt(0)
    ds_write_b128 v15, v[44:47] offset:0
    ds_write_b128 v15, v[48:51] offset:4608
    ds_write_b128 v15, v[52:55] offset:9216
    ds_write_b128 v15, v[56:59] offset:13824
    s_waitcnt lgkmcnt(0)
    s_barrier
    s_mov_b32 s27, 3072
    buffer_load_dwordx4 v[44:47], v1, s[8:11], s27 offen
    v_add_u32 v13, 114688, v1
    buffer_load_dwordx4 v[48:51], v13, s[8:11], s27 offen
    buffer_load_dwordx4 v[52:55], v2, s[12:15], s27 offen
    v_add_u32 v14, 114688, v2
    buffer_load_dwordx4 v[56:59], v14, s[12:15], s27 offen
    ds_read_b128 v[36:39], v16 offset:0
    ds_read_b128 v[40:43], v17 offset:0
    s_waitcnt lgkmcnt(0)
    v_mfma_f32_32x32x16_bf16 v[20:35], v[36:39], v[40:43], v[20:35]
    ds_read_b128 v[36:39], v16 offset:32
    ds_read_b128 v[40:43], v17 offset:32
    s_waitcnt lgkmcnt(0)
    v_mfma_f32_32x32x16_bf16 v[20:35], v[36:39], v[40:43], v[20:35]
    ds_read_b128 v[36:39], v16 offset:64
    ds_read_b128 v[40:43], v17 offset:64
    s_waitcnt lgkmcnt(0)
    v_mfma_f32_32x32x16_bf16 v[20:35], v[36:39], v[40:43], v[20:35]
    ds_read_b128 v[36:39], v16 offset:96
    ds_read_b128 v[40:43], v17 offset:96
    s_waitcnt lgkmcnt(0)
    v_mfma_f32_32x32x16_bf16 v[20:35], v[36:39], v[40:43], v[20:35]
    s_waitcnt vmcnt(0)
    ds_write_b128 v3, v[44:47] offset:0
    ds_write_b128 v3, v[48:51] offset:4608
    ds_write_b128 v3, v[52:55] offset:9216
    ds_write_b128 v3, v[56:59] offset:13824
    s_waitcnt lgkmcnt(0)
    s_barrier
    s_mov_b32 s27, 3200
    buffer_load_dwordx4 v[44:47], v1, s[8:11], s27 offen
    v_add_u32 v13, 114688, v1
    buffer_load_dwordx4 v[48:51], v13, s[8:11], s27 offen
    buffer_load_dwordx4 v[52:55], v2, s[12:15], s27 offen
    v_add_u32 v14, 114688, v2
    buffer_load_dwordx4 v[56:59], v14, s[12:15], s27 offen
    ds_read_b128 v[36:39], v11 offset:0
    ds_read_b128 v[40:43], v12 offset:0
    s_waitcnt lgkmcnt(0)
    v_mfma_f32_32x32x16_bf16 v[20:35], v[36:39], v[40:43], v[20:35]
    ds_read_b128 v[36:39], v11 offset:32
    ds_read_b128 v[40:43], v12 offset:32
    s_waitcnt lgkmcnt(0)
    v_mfma_f32_32x32x16_bf16 v[20:35], v[36:39], v[40:43], v[20:35]
    ds_read_b128 v[36:39], v11 offset:64
    ds_read_b128 v[40:43], v12 offset:64
    s_waitcnt lgkmcnt(0)
    v_mfma_f32_32x32x16_bf16 v[20:35], v[36:39], v[40:43], v[20:35]
    ds_read_b128 v[36:39], v11 offset:96
    ds_read_b128 v[40:43], v12 offset:96
    s_waitcnt lgkmcnt(0)
    v_mfma_f32_32x32x16_bf16 v[20:35], v[36:39], v[40:43], v[20:35]
    s_waitcnt vmcnt(0)
    ds_write_b128 v15, v[44:47] offset:0
    ds_write_b128 v15, v[48:51] offset:4608
    ds_write_b128 v15, v[52:55] offset:9216
    ds_write_b128 v15, v[56:59] offset:13824
    s_waitcnt lgkmcnt(0)
    s_barrier
    s_mov_b32 s27, 3328
    buffer_load_dwordx4 v[44:47], v1, s[8:11], s27 offen
    v_add_u32 v13, 114688, v1
    buffer_load_dwordx4 v[48:51], v13, s[8:11], s27 offen
    buffer_load_dwordx4 v[52:55], v2, s[12:15], s27 offen
    v_add_u32 v14, 114688, v2
    buffer_load_dwordx4 v[56:59], v14, s[12:15], s27 offen
    ds_read_b128 v[36:39], v16 offset:0
    ds_read_b128 v[40:43], v17 offset:0
    s_waitcnt lgkmcnt(0)
    v_mfma_f32_32x32x16_bf16 v[20:35], v[36:39], v[40:43], v[20:35]
    ds_read_b128 v[36:39], v16 offset:32
    ds_read_b128 v[40:43], v17 offset:32
    s_waitcnt lgkmcnt(0)
    v_mfma_f32_32x32x16_bf16 v[20:35], v[36:39], v[40:43], v[20:35]
    ds_read_b128 v[36:39], v16 offset:64
    ds_read_b128 v[40:43], v17 offset:64
    s_waitcnt lgkmcnt(0)
    v_mfma_f32_32x32x16_bf16 v[20:35], v[36:39], v[40:43], v[20:35]
    ds_read_b128 v[36:39], v16 offset:96
    ds_read_b128 v[40:43], v17 offset:96
    s_waitcnt lgkmcnt(0)
    v_mfma_f32_32x32x16_bf16 v[20:35], v[36:39], v[40:43], v[20:35]
    s_waitcnt vmcnt(0)
    ds_write_b128 v3, v[44:47] offset:0
    ds_write_b128 v3, v[48:51] offset:4608
    ds_write_b128 v3, v[52:55] offset:9216
    ds_write_b128 v3, v[56:59] offset:13824
    s_waitcnt lgkmcnt(0)
    s_barrier
    s_mov_b32 s27, 3456
    buffer_load_dwordx4 v[44:47], v1, s[8:11], s27 offen
    v_add_u32 v13, 114688, v1
    buffer_load_dwordx4 v[48:51], v13, s[8:11], s27 offen
    buffer_load_dwordx4 v[52:55], v2, s[12:15], s27 offen
    v_add_u32 v14, 114688, v2
    buffer_load_dwordx4 v[56:59], v14, s[12:15], s27 offen
    ds_read_b128 v[36:39], v11 offset:0
    ds_read_b128 v[40:43], v12 offset:0
    s_waitcnt lgkmcnt(0)
    v_mfma_f32_32x32x16_bf16 v[20:35], v[36:39], v[40:43], v[20:35]
    ds_read_b128 v[36:39], v11 offset:32
    ds_read_b128 v[40:43], v12 offset:32
    s_waitcnt lgkmcnt(0)
    v_mfma_f32_32x32x16_bf16 v[20:35], v[36:39], v[40:43], v[20:35]
    ds_read_b128 v[36:39], v11 offset:64
    ds_read_b128 v[40:43], v12 offset:64
    s_waitcnt lgkmcnt(0)
    v_mfma_f32_32x32x16_bf16 v[20:35], v[36:39], v[40:43], v[20:35]
    ds_read_b128 v[36:39], v11 offset:96
    ds_read_b128 v[40:43], v12 offset:96
    s_waitcnt lgkmcnt(0)
    v_mfma_f32_32x32x16_bf16 v[20:35], v[36:39], v[40:43], v[20:35]
    s_waitcnt vmcnt(0)
    ds_write_b128 v15, v[44:47] offset:0
    ds_write_b128 v15, v[48:51] offset:4608
    ds_write_b128 v15, v[52:55] offset:9216
    ds_write_b128 v15, v[56:59] offset:13824
    s_waitcnt lgkmcnt(0)
    s_barrier
    ds_read_b128 v[36:39], v16 offset:0
    ds_read_b128 v[40:43], v17 offset:0
    s_waitcnt lgkmcnt(0)
    v_mfma_f32_32x32x16_bf16 v[20:35], v[36:39], v[40:43], v[20:35]
    ds_read_b128 v[36:39], v16 offset:32
    ds_read_b128 v[40:43], v17 offset:32
    s_waitcnt lgkmcnt(0)
    v_mfma_f32_32x32x16_bf16 v[20:35], v[36:39], v[40:43], v[20:35]
    ds_read_b128 v[36:39], v16 offset:64
    ds_read_b128 v[40:43], v17 offset:64
    s_waitcnt lgkmcnt(0)
    v_mfma_f32_32x32x16_bf16 v[20:35], v[36:39], v[40:43], v[20:35]
    ds_read_b128 v[36:39], v16 offset:96
    ds_read_b128 v[40:43], v17 offset:96
    s_waitcnt lgkmcnt(0)
    v_mfma_f32_32x32x16_bf16 v[20:35], v[36:39], v[40:43], v[20:35]
    s_nop 15
    s_nop 7
    s_mul_i32 s24, s22, 64
    v_mul_u32_u24 v1, 32, v6
    v_add_u32 v1, v1, v8
    v_add_u32 v1, s24, v1
    s_mov_b32 s26, 896
    v_mul_lo_u32 v1, v1, s26
    s_mul_i32 s24, s21, 64
    v_mul_u32_u24 v2, 32, v7
    v_lshl_add_u32 v2, v9, 2, v2
    v_add_u32 v2, s24, v2
    v_lshlrev_b32 v2, 1, v2
    s_mul_i32 s25, s20, 0
    v_add_u32 v1, v1, v2
    v_add_u32 v1, s25, v1
    buffer_load_dwordx2 v[36:37], v2, s[28:31], 0 offen offset:0
    v_cvt_pk_bf16_f32 v38, v20, v21
    v_cvt_pk_bf16_f32 v39, v22, v23
    s_waitcnt vmcnt(0)
    v_lshlrev_b32 v20, 16, v38
    v_lshlrev_b32 v40, 16, v36
    v_add_f32 v20, v20, v40
    v_and_b32 v21, 0xffff0000, v38
    v_and_b32 v40, 0xffff0000, v36
    v_add_f32 v21, v21, v40
    v_lshlrev_b32 v22, 16, v39
    v_lshlrev_b32 v40, 16, v37
    v_add_f32 v22, v22, v40
    v_and_b32 v23, 0xffff0000, v39
    v_and_b32 v40, 0xffff0000, v37
    v_add_f32 v23, v23, v40
    v_cvt_pk_bf16_f32 v38, v20, v21
    v_cvt_pk_bf16_f32 v39, v22, v23
    buffer_store_dwordx2 v[38:39], v1, s[16:19], 0 offen offset:0
    s_waitcnt vmcnt(0)
    buffer_load_dwordx2 v[36:37], v2, s[28:31], 0 offen offset:16
    v_cvt_pk_bf16_f32 v38, v24, v25
    v_cvt_pk_bf16_f32 v39, v26, v27
    s_waitcnt vmcnt(0)
    v_lshlrev_b32 v24, 16, v38
    v_lshlrev_b32 v40, 16, v36
    v_add_f32 v24, v24, v40
    v_and_b32 v25, 0xffff0000, v38
    v_and_b32 v40, 0xffff0000, v36
    v_add_f32 v25, v25, v40
    v_lshlrev_b32 v26, 16, v39
    v_lshlrev_b32 v40, 16, v37
    v_add_f32 v26, v26, v40
    v_and_b32 v27, 0xffff0000, v39
    v_and_b32 v40, 0xffff0000, v37
    v_add_f32 v27, v27, v40
    v_cvt_pk_bf16_f32 v38, v24, v25
    v_cvt_pk_bf16_f32 v39, v26, v27
    buffer_store_dwordx2 v[38:39], v1, s[16:19], 0 offen offset:16
    s_waitcnt vmcnt(0)
    buffer_load_dwordx2 v[36:37], v2, s[28:31], 0 offen offset:32
    v_cvt_pk_bf16_f32 v38, v28, v29
    v_cvt_pk_bf16_f32 v39, v30, v31
    s_waitcnt vmcnt(0)
    v_lshlrev_b32 v28, 16, v38
    v_lshlrev_b32 v40, 16, v36
    v_add_f32 v28, v28, v40
    v_and_b32 v29, 0xffff0000, v38
    v_and_b32 v40, 0xffff0000, v36
    v_add_f32 v29, v29, v40
    v_lshlrev_b32 v30, 16, v39
    v_lshlrev_b32 v40, 16, v37
    v_add_f32 v30, v30, v40
    v_and_b32 v31, 0xffff0000, v39
    v_and_b32 v40, 0xffff0000, v37
    v_add_f32 v31, v31, v40
    v_cvt_pk_bf16_f32 v38, v28, v29
    v_cvt_pk_bf16_f32 v39, v30, v31
    buffer_store_dwordx2 v[38:39], v1, s[16:19], 0 offen offset:32
    s_waitcnt vmcnt(0)
    buffer_load_dwordx2 v[36:37], v2, s[28:31], 0 offen offset:48
    v_cvt_pk_bf16_f32 v38, v32, v33
    v_cvt_pk_bf16_f32 v39, v34, v35
    s_waitcnt vmcnt(0)
    v_lshlrev_b32 v32, 16, v38
    v_lshlrev_b32 v40, 16, v36
    v_add_f32 v32, v32, v40
    v_and_b32 v33, 0xffff0000, v38
    v_and_b32 v40, 0xffff0000, v36
    v_add_f32 v33, v33, v40
    v_lshlrev_b32 v34, 16, v39
    v_lshlrev_b32 v40, 16, v37
    v_add_f32 v34, v34, v40
    v_and_b32 v35, 0xffff0000, v39
    v_and_b32 v40, 0xffff0000, v37
    v_add_f32 v35, v35, v40
    v_cvt_pk_bf16_f32 v38, v32, v33
    v_cvt_pk_bf16_f32 v39, v34, v35
    buffer_store_dwordx2 v[38:39], v1, s[16:19], 0 offen offset:48
    s_waitcnt vmcnt(0)
x_gf2_done:
    s_endpgm
x_gu:
    s_sub_u32 s2, s2, 224
    s_cmp_ge_u32 s2, 896
    s_cbranch_scc1 chain_kernel_done2
    s_mul_hi_u32 s20, s2, 0x492493
    s_mul_i32 s24, s20, 896
    s_sub_u32 s23, s2, s24
    s_mul_hi_u32 s22, s23, 0x4924925
    s_mul_i32 s24, s22, 56
    s_sub_u32 s21, s23, s24
    s_load_dwordx2 s[8:9], s[0:1], 112
    s_waitcnt lgkmcnt(0)
    s_add_u32 s8, s8, 0x200000
    s_addc_u32 s9, s9, 0
    s_and_b32 s9, s9, 0xffff
    s_mov_b32 s10, 0xfe00000
    s_mov_b32 s11, 0x00020000
    s_load_dwordx2 s[12:13], s[0:1], 112
    s_waitcnt lgkmcnt(0)
    s_and_b32 s13, s13, 0xffff
    s_mov_b32 s14, 0x10000000
    s_mov_b32 s15, 0x00020000
    s_load_dwordx2 s[16:17], s[0:1], 112
    s_waitcnt lgkmcnt(0)
    s_add_u32 s16, s16, 0x2200000
    s_addc_u32 s17, s17, 0
    s_and_b32 s17, s17, 0xffff
    s_mov_b32 s18, 0xde00000
    s_mov_b32 s19, 0x00020000
    v_lshrrev_b32 v4, 3, v0
    v_and_b32 v5, 7, v0
    v_lshlrev_b32 v5, 4, v5
    s_mul_i32 s24, s21, 114688
    s_mul_i32 s25, s20, 0
    s_add_u32 s24, s24, s25
    s_mov_b32 s26, 896
    v_mul_lo_u32 v1, v4, s26
    v_add_u32 v1, v1, v5
    v_add_u32 v1, s24, v1
    s_mul_i32 s24, s22, 114688
    s_mul_i32 s25, s20, 0
    s_add_u32 s24, s24, s25
    s_mov_b32 s26, 896
    v_mul_lo_u32 v2, v4, s26
    v_add_u32 v2, v2, v5
    v_add_u32 v2, s24, v2
    v_mul_u32_u24 v3, 144, v4
    v_add_u32 v3, v3, v5
    v_lshrrev_b32 v6, 6, v0
    v_and_b32 v7, 1, v6
    v_lshrrev_b32 v6, 1, v6
    v_and_b32 v8, 31, v0
    v_bfe_u32 v9, v0, 5, 1
    v_lshlrev_b32 v10, 4, v9
    v_mul_u32_u24 v11, 64, v7
    v_add_u32 v11, v11, v8
    v_mul_u32_u24 v11, 144, v11
    v_add_u32 v11, v11, v10
    v_mul_u32_u24 v12, 64, v6
    v_add_u32 v12, v12, v8
    v_mul_u32_u24 v12, 144, v12
    v_add_u32 v12, v12, v10
    v_add_u32 v12, 18432, v12
    v_add_u32 v15, 36864, v3
    v_add_u32 v16, 36864, v11
    v_add_u32 v17, 36864, v12
    v_mov_b32 v20, 0
    v_mov_b32 v21, 0
    v_mov_b32 v22, 0
    v_mov_b32 v23, 0
    v_mov_b32 v24, 0
    v_mov_b32 v25, 0
    v_mov_b32 v26, 0
    v_mov_b32 v27, 0
    v_mov_b32 v28, 0
    v_mov_b32 v29, 0
    v_mov_b32 v30, 0
    v_mov_b32 v31, 0
    v_mov_b32 v32, 0
    v_mov_b32 v33, 0
    v_mov_b32 v34, 0
    v_mov_b32 v35, 0
    v_mov_b32 v36, 0
    v_mov_b32 v37, 0
    v_mov_b32 v38, 0
    v_mov_b32 v39, 0
    v_mov_b32 v40, 0
    v_mov_b32 v41, 0
    v_mov_b32 v42, 0
    v_mov_b32 v43, 0
    v_mov_b32 v44, 0
    v_mov_b32 v45, 0
    v_mov_b32 v46, 0
    v_mov_b32 v47, 0
    v_mov_b32 v48, 0
    v_mov_b32 v49, 0
    v_mov_b32 v50, 0
    v_mov_b32 v51, 0
    v_mov_b32 v52, 0
    v_mov_b32 v53, 0
    v_mov_b32 v54, 0
    v_mov_b32 v55, 0
    v_mov_b32 v56, 0
    v_mov_b32 v57, 0
    v_mov_b32 v58, 0
    v_mov_b32 v59, 0
    v_mov_b32 v60, 0
    v_mov_b32 v61, 0
    v_mov_b32 v62, 0
    v_mov_b32 v63, 0
    v_mov_b32 v64, 0
    v_mov_b32 v65, 0
    v_mov_b32 v66, 0
    v_mov_b32 v67, 0
    v_mov_b32 v68, 0
    v_mov_b32 v69, 0
    v_mov_b32 v70, 0
    v_mov_b32 v71, 0
    v_mov_b32 v72, 0
    v_mov_b32 v73, 0
    v_mov_b32 v74, 0
    v_mov_b32 v75, 0
    v_mov_b32 v76, 0
    v_mov_b32 v77, 0
    v_mov_b32 v78, 0
    v_mov_b32 v79, 0
    v_mov_b32 v80, 0
    v_mov_b32 v81, 0
    v_mov_b32 v82, 0
    v_mov_b32 v83, 0
    s_mov_b32 s27, 0
    buffer_load_dwordx4 v[100:103], v1, s[8:11], s27 offen
    v_add_u32 v13, 28672, v1
    buffer_load_dwordx4 v[104:107], v13, s[8:11], s27 offen
    v_add_u32 v13, 57344, v1
    buffer_load_dwordx4 v[108:111], v13, s[8:11], s27 offen
    v_add_u32 v13, 86016, v1
    buffer_load_dwordx4 v[112:115], v13, s[8:11], s27 offen
    buffer_load_dwordx4 v[116:119], v2, s[12:15], s27 offen
    v_add_u32 v14, 28672, v2
    buffer_load_dwordx4 v[120:123], v14, s[12:15], s27 offen
    v_add_u32 v14, 57344, v2
    buffer_load_dwordx4 v[124:127], v14, s[12:15], s27 offen
    v_add_u32 v14, 86016, v2
    buffer_load_dwordx4 v[128:131], v14, s[12:15], s27 offen
    s_waitcnt vmcnt(0)
    ds_write_b128 v3, v[100:103] offset:0
    ds_write_b128 v3, v[104:107] offset:4608
    ds_write_b128 v3, v[108:111] offset:9216
    ds_write_b128 v3, v[112:115] offset:13824
    ds_write_b128 v3, v[116:119] offset:18432
    ds_write_b128 v3, v[120:123] offset:23040
    ds_write_b128 v3, v[124:127] offset:27648
    ds_write_b128 v3, v[128:131] offset:32256
    s_waitcnt lgkmcnt(0)
    s_barrier
    s_mov_b32 s27, 128
    buffer_load_dwordx4 v[100:103], v1, s[8:11], s27 offen
    v_add_u32 v13, 28672, v1
    buffer_load_dwordx4 v[104:107], v13, s[8:11], s27 offen
    v_add_u32 v13, 57344, v1
    buffer_load_dwordx4 v[108:111], v13, s[8:11], s27 offen
    v_add_u32 v13, 86016, v1
    buffer_load_dwordx4 v[112:115], v13, s[8:11], s27 offen
    buffer_load_dwordx4 v[116:119], v2, s[12:15], s27 offen
    v_add_u32 v14, 28672, v2
    buffer_load_dwordx4 v[120:123], v14, s[12:15], s27 offen
    v_add_u32 v14, 57344, v2
    buffer_load_dwordx4 v[124:127], v14, s[12:15], s27 offen
    v_add_u32 v14, 86016, v2
    buffer_load_dwordx4 v[128:131], v14, s[12:15], s27 offen
    ds_read_b128 v[84:87], v11 offset:0
    ds_read_b128 v[88:91], v11 offset:4608
    ds_read_b128 v[92:95], v12 offset:0
    ds_read_b128 v[96:99], v12 offset:4608
    s_waitcnt lgkmcnt(0)
    v_mfma_f32_32x32x16_bf16 v[20:35], v[84:87], v[92:95], v[20:35]
    v_mfma_f32_32x32x16_bf16 v[36:51], v[84:87], v[96:99], v[36:51]
    v_mfma_f32_32x32x16_bf16 v[52:67], v[88:91], v[92:95], v[52:67]
    v_mfma_f32_32x32x16_bf16 v[68:83], v[88:91], v[96:99], v[68:83]
    ds_read_b128 v[84:87], v11 offset:32
    ds_read_b128 v[88:91], v11 offset:4640
    ds_read_b128 v[92:95], v12 offset:32
    ds_read_b128 v[96:99], v12 offset:4640
    s_waitcnt lgkmcnt(0)
    v_mfma_f32_32x32x16_bf16 v[20:35], v[84:87], v[92:95], v[20:35]
    v_mfma_f32_32x32x16_bf16 v[36:51], v[84:87], v[96:99], v[36:51]
    v_mfma_f32_32x32x16_bf16 v[52:67], v[88:91], v[92:95], v[52:67]
    v_mfma_f32_32x32x16_bf16 v[68:83], v[88:91], v[96:99], v[68:83]
    ds_read_b128 v[84:87], v11 offset:64
    ds_read_b128 v[88:91], v11 offset:4672
    ds_read_b128 v[92:95], v12 offset:64
    ds_read_b128 v[96:99], v12 offset:4672
    s_waitcnt lgkmcnt(0)
    v_mfma_f32_32x32x16_bf16 v[20:35], v[84:87], v[92:95], v[20:35]
    v_mfma_f32_32x32x16_bf16 v[36:51], v[84:87], v[96:99], v[36:51]
    v_mfma_f32_32x32x16_bf16 v[52:67], v[88:91], v[92:95], v[52:67]
    v_mfma_f32_32x32x16_bf16 v[68:83], v[88:91], v[96:99], v[68:83]
    ds_read_b128 v[84:87], v11 offset:96
    ds_read_b128 v[88:91], v11 offset:4704
    ds_read_b128 v[92:95], v12 offset:96
    ds_read_b128 v[96:99], v12 offset:4704
    s_waitcnt lgkmcnt(0)
    v_mfma_f32_32x32x16_bf16 v[20:35], v[84:87], v[92:95], v[20:35]
    v_mfma_f32_32x32x16_bf16 v[36:51], v[84:87], v[96:99], v[36:51]
    v_mfma_f32_32x32x16_bf16 v[52:67], v[88:91], v[92:95], v[52:67]
    v_mfma_f32_32x32x16_bf16 v[68:83], v[88:91], v[96:99], v[68:83]
    s_waitcnt vmcnt(0)
    ds_write_b128 v15, v[100:103] offset:0
    ds_write_b128 v15, v[104:107] offset:4608
    ds_write_b128 v15, v[108:111] offset:9216
    ds_write_b128 v15, v[112:115] offset:13824
    ds_write_b128 v15, v[116:119] offset:18432
    ds_write_b128 v15, v[120:123] offset:23040
    ds_write_b128 v15, v[124:127] offset:27648
    ds_write_b128 v15, v[128:131] offset:32256
    s_waitcnt lgkmcnt(0)
    s_barrier
    s_mov_b32 s27, 256
    buffer_load_dwordx4 v[100:103], v1, s[8:11], s27 offen
    v_add_u32 v13, 28672, v1
    buffer_load_dwordx4 v[104:107], v13, s[8:11], s27 offen
    v_add_u32 v13, 57344, v1
    buffer_load_dwordx4 v[108:111], v13, s[8:11], s27 offen
    v_add_u32 v13, 86016, v1
    buffer_load_dwordx4 v[112:115], v13, s[8:11], s27 offen
    buffer_load_dwordx4 v[116:119], v2, s[12:15], s27 offen
    v_add_u32 v14, 28672, v2
    buffer_load_dwordx4 v[120:123], v14, s[12:15], s27 offen
    v_add_u32 v14, 57344, v2
    buffer_load_dwordx4 v[124:127], v14, s[12:15], s27 offen
    v_add_u32 v14, 86016, v2
    buffer_load_dwordx4 v[128:131], v14, s[12:15], s27 offen
    ds_read_b128 v[84:87], v16 offset:0
    ds_read_b128 v[88:91], v16 offset:4608
    ds_read_b128 v[92:95], v17 offset:0
    ds_read_b128 v[96:99], v17 offset:4608
    s_waitcnt lgkmcnt(0)
    v_mfma_f32_32x32x16_bf16 v[20:35], v[84:87], v[92:95], v[20:35]
    v_mfma_f32_32x32x16_bf16 v[36:51], v[84:87], v[96:99], v[36:51]
    v_mfma_f32_32x32x16_bf16 v[52:67], v[88:91], v[92:95], v[52:67]
    v_mfma_f32_32x32x16_bf16 v[68:83], v[88:91], v[96:99], v[68:83]
    ds_read_b128 v[84:87], v16 offset:32
    ds_read_b128 v[88:91], v16 offset:4640
    ds_read_b128 v[92:95], v17 offset:32
    ds_read_b128 v[96:99], v17 offset:4640
    s_waitcnt lgkmcnt(0)
    v_mfma_f32_32x32x16_bf16 v[20:35], v[84:87], v[92:95], v[20:35]
    v_mfma_f32_32x32x16_bf16 v[36:51], v[84:87], v[96:99], v[36:51]
    v_mfma_f32_32x32x16_bf16 v[52:67], v[88:91], v[92:95], v[52:67]
    v_mfma_f32_32x32x16_bf16 v[68:83], v[88:91], v[96:99], v[68:83]
    ds_read_b128 v[84:87], v16 offset:64
    ds_read_b128 v[88:91], v16 offset:4672
    ds_read_b128 v[92:95], v17 offset:64
    ds_read_b128 v[96:99], v17 offset:4672
    s_waitcnt lgkmcnt(0)
    v_mfma_f32_32x32x16_bf16 v[20:35], v[84:87], v[92:95], v[20:35]
    v_mfma_f32_32x32x16_bf16 v[36:51], v[84:87], v[96:99], v[36:51]
    v_mfma_f32_32x32x16_bf16 v[52:67], v[88:91], v[92:95], v[52:67]
    v_mfma_f32_32x32x16_bf16 v[68:83], v[88:91], v[96:99], v[68:83]
    ds_read_b128 v[84:87], v16 offset:96
    ds_read_b128 v[88:91], v16 offset:4704
    ds_read_b128 v[92:95], v17 offset:96
    ds_read_b128 v[96:99], v17 offset:4704
    s_waitcnt lgkmcnt(0)
    v_mfma_f32_32x32x16_bf16 v[20:35], v[84:87], v[92:95], v[20:35]
    v_mfma_f32_32x32x16_bf16 v[36:51], v[84:87], v[96:99], v[36:51]
    v_mfma_f32_32x32x16_bf16 v[52:67], v[88:91], v[92:95], v[52:67]
    v_mfma_f32_32x32x16_bf16 v[68:83], v[88:91], v[96:99], v[68:83]
    s_waitcnt vmcnt(0)
    ds_write_b128 v3, v[100:103] offset:0
    ds_write_b128 v3, v[104:107] offset:4608
    ds_write_b128 v3, v[108:111] offset:9216
    ds_write_b128 v3, v[112:115] offset:13824
    ds_write_b128 v3, v[116:119] offset:18432
    ds_write_b128 v3, v[120:123] offset:23040
    ds_write_b128 v3, v[124:127] offset:27648
    ds_write_b128 v3, v[128:131] offset:32256
    s_waitcnt lgkmcnt(0)
    s_barrier
    s_mov_b32 s27, 384
    buffer_load_dwordx4 v[100:103], v1, s[8:11], s27 offen
    v_add_u32 v13, 28672, v1
    buffer_load_dwordx4 v[104:107], v13, s[8:11], s27 offen
    v_add_u32 v13, 57344, v1
    buffer_load_dwordx4 v[108:111], v13, s[8:11], s27 offen
    v_add_u32 v13, 86016, v1
    buffer_load_dwordx4 v[112:115], v13, s[8:11], s27 offen
    buffer_load_dwordx4 v[116:119], v2, s[12:15], s27 offen
    v_add_u32 v14, 28672, v2
    buffer_load_dwordx4 v[120:123], v14, s[12:15], s27 offen
    v_add_u32 v14, 57344, v2
    buffer_load_dwordx4 v[124:127], v14, s[12:15], s27 offen
    v_add_u32 v14, 86016, v2
    buffer_load_dwordx4 v[128:131], v14, s[12:15], s27 offen
    ds_read_b128 v[84:87], v11 offset:0
    ds_read_b128 v[88:91], v11 offset:4608
    ds_read_b128 v[92:95], v12 offset:0
    ds_read_b128 v[96:99], v12 offset:4608
    s_waitcnt lgkmcnt(0)
    v_mfma_f32_32x32x16_bf16 v[20:35], v[84:87], v[92:95], v[20:35]
    v_mfma_f32_32x32x16_bf16 v[36:51], v[84:87], v[96:99], v[36:51]
    v_mfma_f32_32x32x16_bf16 v[52:67], v[88:91], v[92:95], v[52:67]
    v_mfma_f32_32x32x16_bf16 v[68:83], v[88:91], v[96:99], v[68:83]
    ds_read_b128 v[84:87], v11 offset:32
    ds_read_b128 v[88:91], v11 offset:4640
    ds_read_b128 v[92:95], v12 offset:32
    ds_read_b128 v[96:99], v12 offset:4640
    s_waitcnt lgkmcnt(0)
    v_mfma_f32_32x32x16_bf16 v[20:35], v[84:87], v[92:95], v[20:35]
    v_mfma_f32_32x32x16_bf16 v[36:51], v[84:87], v[96:99], v[36:51]
    v_mfma_f32_32x32x16_bf16 v[52:67], v[88:91], v[92:95], v[52:67]
    v_mfma_f32_32x32x16_bf16 v[68:83], v[88:91], v[96:99], v[68:83]
    ds_read_b128 v[84:87], v11 offset:64
    ds_read_b128 v[88:91], v11 offset:4672
    ds_read_b128 v[92:95], v12 offset:64
    ds_read_b128 v[96:99], v12 offset:4672
    s_waitcnt lgkmcnt(0)
    v_mfma_f32_32x32x16_bf16 v[20:35], v[84:87], v[92:95], v[20:35]
    v_mfma_f32_32x32x16_bf16 v[36:51], v[84:87], v[96:99], v[36:51]
    v_mfma_f32_32x32x16_bf16 v[52:67], v[88:91], v[92:95], v[52:67]
    v_mfma_f32_32x32x16_bf16 v[68:83], v[88:91], v[96:99], v[68:83]
    ds_read_b128 v[84:87], v11 offset:96
    ds_read_b128 v[88:91], v11 offset:4704
    ds_read_b128 v[92:95], v12 offset:96
    ds_read_b128 v[96:99], v12 offset:4704
    s_waitcnt lgkmcnt(0)
    v_mfma_f32_32x32x16_bf16 v[20:35], v[84:87], v[92:95], v[20:35]
    v_mfma_f32_32x32x16_bf16 v[36:51], v[84:87], v[96:99], v[36:51]
    v_mfma_f32_32x32x16_bf16 v[52:67], v[88:91], v[92:95], v[52:67]
    v_mfma_f32_32x32x16_bf16 v[68:83], v[88:91], v[96:99], v[68:83]
    s_waitcnt vmcnt(0)
    ds_write_b128 v15, v[100:103] offset:0
    ds_write_b128 v15, v[104:107] offset:4608
    ds_write_b128 v15, v[108:111] offset:9216
    ds_write_b128 v15, v[112:115] offset:13824
    ds_write_b128 v15, v[116:119] offset:18432
    ds_write_b128 v15, v[120:123] offset:23040
    ds_write_b128 v15, v[124:127] offset:27648
    ds_write_b128 v15, v[128:131] offset:32256
    s_waitcnt lgkmcnt(0)
    s_barrier
    s_mov_b32 s27, 512
    buffer_load_dwordx4 v[100:103], v1, s[8:11], s27 offen
    v_add_u32 v13, 28672, v1
    buffer_load_dwordx4 v[104:107], v13, s[8:11], s27 offen
    v_add_u32 v13, 57344, v1
    buffer_load_dwordx4 v[108:111], v13, s[8:11], s27 offen
    v_add_u32 v13, 86016, v1
    buffer_load_dwordx4 v[112:115], v13, s[8:11], s27 offen
    buffer_load_dwordx4 v[116:119], v2, s[12:15], s27 offen
    v_add_u32 v14, 28672, v2
    buffer_load_dwordx4 v[120:123], v14, s[12:15], s27 offen
    v_add_u32 v14, 57344, v2
    buffer_load_dwordx4 v[124:127], v14, s[12:15], s27 offen
    v_add_u32 v14, 86016, v2
    buffer_load_dwordx4 v[128:131], v14, s[12:15], s27 offen
    ds_read_b128 v[84:87], v16 offset:0
    ds_read_b128 v[88:91], v16 offset:4608
    ds_read_b128 v[92:95], v17 offset:0
    ds_read_b128 v[96:99], v17 offset:4608
    s_waitcnt lgkmcnt(0)
    v_mfma_f32_32x32x16_bf16 v[20:35], v[84:87], v[92:95], v[20:35]
    v_mfma_f32_32x32x16_bf16 v[36:51], v[84:87], v[96:99], v[36:51]
    v_mfma_f32_32x32x16_bf16 v[52:67], v[88:91], v[92:95], v[52:67]
    v_mfma_f32_32x32x16_bf16 v[68:83], v[88:91], v[96:99], v[68:83]
    ds_read_b128 v[84:87], v16 offset:32
    ds_read_b128 v[88:91], v16 offset:4640
    ds_read_b128 v[92:95], v17 offset:32
    ds_read_b128 v[96:99], v17 offset:4640
    s_waitcnt lgkmcnt(0)
    v_mfma_f32_32x32x16_bf16 v[20:35], v[84:87], v[92:95], v[20:35]
    v_mfma_f32_32x32x16_bf16 v[36:51], v[84:87], v[96:99], v[36:51]
    v_mfma_f32_32x32x16_bf16 v[52:67], v[88:91], v[92:95], v[52:67]
    v_mfma_f32_32x32x16_bf16 v[68:83], v[88:91], v[96:99], v[68:83]
    ds_read_b128 v[84:87], v16 offset:64
    ds_read_b128 v[88:91], v16 offset:4672
    ds_read_b128 v[92:95], v17 offset:64
    ds_read_b128 v[96:99], v17 offset:4672
    s_waitcnt lgkmcnt(0)
    v_mfma_f32_32x32x16_bf16 v[20:35], v[84:87], v[92:95], v[20:35]
    v_mfma_f32_32x32x16_bf16 v[36:51], v[84:87], v[96:99], v[36:51]
    v_mfma_f32_32x32x16_bf16 v[52:67], v[88:91], v[92:95], v[52:67]
    v_mfma_f32_32x32x16_bf16 v[68:83], v[88:91], v[96:99], v[68:83]
    ds_read_b128 v[84:87], v16 offset:96
    ds_read_b128 v[88:91], v16 offset:4704
    ds_read_b128 v[92:95], v17 offset:96
    ds_read_b128 v[96:99], v17 offset:4704
    s_waitcnt lgkmcnt(0)
    v_mfma_f32_32x32x16_bf16 v[20:35], v[84:87], v[92:95], v[20:35]
    v_mfma_f32_32x32x16_bf16 v[36:51], v[84:87], v[96:99], v[36:51]
    v_mfma_f32_32x32x16_bf16 v[52:67], v[88:91], v[92:95], v[52:67]
    v_mfma_f32_32x32x16_bf16 v[68:83], v[88:91], v[96:99], v[68:83]
    s_waitcnt vmcnt(0)
    ds_write_b128 v3, v[100:103] offset:0
    ds_write_b128 v3, v[104:107] offset:4608
    ds_write_b128 v3, v[108:111] offset:9216
    ds_write_b128 v3, v[112:115] offset:13824
    ds_write_b128 v3, v[116:119] offset:18432
    ds_write_b128 v3, v[120:123] offset:23040
    ds_write_b128 v3, v[124:127] offset:27648
    ds_write_b128 v3, v[128:131] offset:32256
    s_waitcnt lgkmcnt(0)
    s_barrier
    s_mov_b32 s27, 640
    buffer_load_dwordx4 v[100:103], v1, s[8:11], s27 offen
    v_add_u32 v13, 28672, v1
    buffer_load_dwordx4 v[104:107], v13, s[8:11], s27 offen
    v_add_u32 v13, 57344, v1
    buffer_load_dwordx4 v[108:111], v13, s[8:11], s27 offen
    v_add_u32 v13, 86016, v1
    buffer_load_dwordx4 v[112:115], v13, s[8:11], s27 offen
    buffer_load_dwordx4 v[116:119], v2, s[12:15], s27 offen
    v_add_u32 v14, 28672, v2
    buffer_load_dwordx4 v[120:123], v14, s[12:15], s27 offen
    v_add_u32 v14, 57344, v2
    buffer_load_dwordx4 v[124:127], v14, s[12:15], s27 offen
    v_add_u32 v14, 86016, v2
    buffer_load_dwordx4 v[128:131], v14, s[12:15], s27 offen
    ds_read_b128 v[84:87], v11 offset:0
    ds_read_b128 v[88:91], v11 offset:4608
    ds_read_b128 v[92:95], v12 offset:0
    ds_read_b128 v[96:99], v12 offset:4608
    s_waitcnt lgkmcnt(0)
    v_mfma_f32_32x32x16_bf16 v[20:35], v[84:87], v[92:95], v[20:35]
    v_mfma_f32_32x32x16_bf16 v[36:51], v[84:87], v[96:99], v[36:51]
    v_mfma_f32_32x32x16_bf16 v[52:67], v[88:91], v[92:95], v[52:67]
    v_mfma_f32_32x32x16_bf16 v[68:83], v[88:91], v[96:99], v[68:83]
    ds_read_b128 v[84:87], v11 offset:32
    ds_read_b128 v[88:91], v11 offset:4640
    ds_read_b128 v[92:95], v12 offset:32
    ds_read_b128 v[96:99], v12 offset:4640
    s_waitcnt lgkmcnt(0)
    v_mfma_f32_32x32x16_bf16 v[20:35], v[84:87], v[92:95], v[20:35]
    v_mfma_f32_32x32x16_bf16 v[36:51], v[84:87], v[96:99], v[36:51]
    v_mfma_f32_32x32x16_bf16 v[52:67], v[88:91], v[92:95], v[52:67]
    v_mfma_f32_32x32x16_bf16 v[68:83], v[88:91], v[96:99], v[68:83]
    ds_read_b128 v[84:87], v11 offset:64
    ds_read_b128 v[88:91], v11 offset:4672
    ds_read_b128 v[92:95], v12 offset:64
    ds_read_b128 v[96:99], v12 offset:4672
    s_waitcnt lgkmcnt(0)
    v_mfma_f32_32x32x16_bf16 v[20:35], v[84:87], v[92:95], v[20:35]
    v_mfma_f32_32x32x16_bf16 v[36:51], v[84:87], v[96:99], v[36:51]
    v_mfma_f32_32x32x16_bf16 v[52:67], v[88:91], v[92:95], v[52:67]
    v_mfma_f32_32x32x16_bf16 v[68:83], v[88:91], v[96:99], v[68:83]
    ds_read_b128 v[84:87], v11 offset:96
    ds_read_b128 v[88:91], v11 offset:4704
    ds_read_b128 v[92:95], v12 offset:96
    ds_read_b128 v[96:99], v12 offset:4704
    s_waitcnt lgkmcnt(0)
    v_mfma_f32_32x32x16_bf16 v[20:35], v[84:87], v[92:95], v[20:35]
    v_mfma_f32_32x32x16_bf16 v[36:51], v[84:87], v[96:99], v[36:51]
    v_mfma_f32_32x32x16_bf16 v[52:67], v[88:91], v[92:95], v[52:67]
    v_mfma_f32_32x32x16_bf16 v[68:83], v[88:91], v[96:99], v[68:83]
    s_waitcnt vmcnt(0)
    ds_write_b128 v15, v[100:103] offset:0
    ds_write_b128 v15, v[104:107] offset:4608
    ds_write_b128 v15, v[108:111] offset:9216
    ds_write_b128 v15, v[112:115] offset:13824
    ds_write_b128 v15, v[116:119] offset:18432
    ds_write_b128 v15, v[120:123] offset:23040
    ds_write_b128 v15, v[124:127] offset:27648
    ds_write_b128 v15, v[128:131] offset:32256
    s_waitcnt lgkmcnt(0)
    s_barrier
    s_mov_b32 s27, 768
    buffer_load_dwordx4 v[100:103], v1, s[8:11], s27 offen
    v_add_u32 v13, 28672, v1
    buffer_load_dwordx4 v[104:107], v13, s[8:11], s27 offen
    v_add_u32 v13, 57344, v1
    buffer_load_dwordx4 v[108:111], v13, s[8:11], s27 offen
    v_add_u32 v13, 86016, v1
    buffer_load_dwordx4 v[112:115], v13, s[8:11], s27 offen
    buffer_load_dwordx4 v[116:119], v2, s[12:15], s27 offen
    v_add_u32 v14, 28672, v2
    buffer_load_dwordx4 v[120:123], v14, s[12:15], s27 offen
    v_add_u32 v14, 57344, v2
    buffer_load_dwordx4 v[124:127], v14, s[12:15], s27 offen
    v_add_u32 v14, 86016, v2
    buffer_load_dwordx4 v[128:131], v14, s[12:15], s27 offen
    ds_read_b128 v[84:87], v16 offset:0
    ds_read_b128 v[88:91], v16 offset:4608
    ds_read_b128 v[92:95], v17 offset:0
    ds_read_b128 v[96:99], v17 offset:4608
    s_waitcnt lgkmcnt(0)
    v_mfma_f32_32x32x16_bf16 v[20:35], v[84:87], v[92:95], v[20:35]
    v_mfma_f32_32x32x16_bf16 v[36:51], v[84:87], v[96:99], v[36:51]
    v_mfma_f32_32x32x16_bf16 v[52:67], v[88:91], v[92:95], v[52:67]
    v_mfma_f32_32x32x16_bf16 v[68:83], v[88:91], v[96:99], v[68:83]
    ds_read_b128 v[84:87], v16 offset:32
    ds_read_b128 v[88:91], v16 offset:4640
    ds_read_b128 v[92:95], v17 offset:32
    ds_read_b128 v[96:99], v17 offset:4640
    s_waitcnt lgkmcnt(0)
    v_mfma_f32_32x32x16_bf16 v[20:35], v[84:87], v[92:95], v[20:35]
    v_mfma_f32_32x32x16_bf16 v[36:51], v[84:87], v[96:99], v[36:51]
    v_mfma_f32_32x32x16_bf16 v[52:67], v[88:91], v[92:95], v[52:67]
    v_mfma_f32_32x32x16_bf16 v[68:83], v[88:91], v[96:99], v[68:83]
    ds_read_b128 v[84:87], v16 offset:64
    ds_read_b128 v[88:91], v16 offset:4672
    ds_read_b128 v[92:95], v17 offset:64
    ds_read_b128 v[96:99], v17 offset:4672
    s_waitcnt lgkmcnt(0)
    v_mfma_f32_32x32x16_bf16 v[20:35], v[84:87], v[92:95], v[20:35]
    v_mfma_f32_32x32x16_bf16 v[36:51], v[84:87], v[96:99], v[36:51]
    v_mfma_f32_32x32x16_bf16 v[52:67], v[88:91], v[92:95], v[52:67]
    v_mfma_f32_32x32x16_bf16 v[68:83], v[88:91], v[96:99], v[68:83]
    ds_read_b128 v[84:87], v16 offset:96
    ds_read_b128 v[88:91], v16 offset:4704
    ds_read_b128 v[92:95], v17 offset:96
    ds_read_b128 v[96:99], v17 offset:4704
    s_waitcnt lgkmcnt(0)
    v_mfma_f32_32x32x16_bf16 v[20:35], v[84:87], v[92:95], v[20:35]
    v_mfma_f32_32x32x16_bf16 v[36:51], v[84:87], v[96:99], v[36:51]
    v_mfma_f32_32x32x16_bf16 v[52:67], v[88:91], v[92:95], v[52:67]
    v_mfma_f32_32x32x16_bf16 v[68:83], v[88:91], v[96:99], v[68:83]
    s_waitcnt vmcnt(0)
    ds_write_b128 v3, v[100:103] offset:0
    ds_write_b128 v3, v[104:107] offset:4608
    ds_write_b128 v3, v[108:111] offset:9216
    ds_write_b128 v3, v[112:115] offset:13824
    ds_write_b128 v3, v[116:119] offset:18432
    ds_write_b128 v3, v[120:123] offset:23040
    ds_write_b128 v3, v[124:127] offset:27648
    ds_write_b128 v3, v[128:131] offset:32256
    s_waitcnt lgkmcnt(0)
    s_barrier
    ds_read_b128 v[84:87], v11 offset:0
    ds_read_b128 v[88:91], v11 offset:4608
    ds_read_b128 v[92:95], v12 offset:0
    ds_read_b128 v[96:99], v12 offset:4608
    s_waitcnt lgkmcnt(0)
    v_mfma_f32_32x32x16_bf16 v[20:35], v[84:87], v[92:95], v[20:35]
    v_mfma_f32_32x32x16_bf16 v[36:51], v[84:87], v[96:99], v[36:51]
    v_mfma_f32_32x32x16_bf16 v[52:67], v[88:91], v[92:95], v[52:67]
    v_mfma_f32_32x32x16_bf16 v[68:83], v[88:91], v[96:99], v[68:83]
    ds_read_b128 v[84:87], v11 offset:32
    ds_read_b128 v[88:91], v11 offset:4640
    ds_read_b128 v[92:95], v12 offset:32
    ds_read_b128 v[96:99], v12 offset:4640
    s_waitcnt lgkmcnt(0)
    v_mfma_f32_32x32x16_bf16 v[20:35], v[84:87], v[92:95], v[20:35]
    v_mfma_f32_32x32x16_bf16 v[36:51], v[84:87], v[96:99], v[36:51]
    v_mfma_f32_32x32x16_bf16 v[52:67], v[88:91], v[92:95], v[52:67]
    v_mfma_f32_32x32x16_bf16 v[68:83], v[88:91], v[96:99], v[68:83]
    ds_read_b128 v[84:87], v11 offset:64
    ds_read_b128 v[88:91], v11 offset:4672
    ds_read_b128 v[92:95], v12 offset:64
    ds_read_b128 v[96:99], v12 offset:4672
    s_waitcnt lgkmcnt(0)
    v_mfma_f32_32x32x16_bf16 v[20:35], v[84:87], v[92:95], v[20:35]
    v_mfma_f32_32x32x16_bf16 v[36:51], v[84:87], v[96:99], v[36:51]
    v_mfma_f32_32x32x16_bf16 v[52:67], v[88:91], v[92:95], v[52:67]
    v_mfma_f32_32x32x16_bf16 v[68:83], v[88:91], v[96:99], v[68:83]
    ds_read_b128 v[84:87], v11 offset:96
    ds_read_b128 v[88:91], v11 offset:4704
    ds_read_b128 v[92:95], v12 offset:96
    ds_read_b128 v[96:99], v12 offset:4704
    s_waitcnt lgkmcnt(0)
    v_mfma_f32_32x32x16_bf16 v[20:35], v[84:87], v[92:95], v[20:35]
    v_mfma_f32_32x32x16_bf16 v[36:51], v[84:87], v[96:99], v[36:51]
    v_mfma_f32_32x32x16_bf16 v[52:67], v[88:91], v[92:95], v[52:67]
    v_mfma_f32_32x32x16_bf16 v[68:83], v[88:91], v[96:99], v[68:83]
    s_nop 15
    s_nop 7
    s_mul_i32 s24, s22, 128
    v_mul_u32_u24 v1, 64, v6
    v_add_u32 v1, v1, v8
    v_add_u32 v1, s24, v1
    s_mov_b32 s26, 14336
    v_mul_lo_u32 v1, v1, s26
    s_mul_i32 s24, s21, 128
    v_mul_u32_u24 v2, 64, v7
    v_lshl_add_u32 v2, v9, 2, v2
    v_add_u32 v2, s24, v2
    v_lshlrev_b32 v2, 1, v2
    s_mul_i32 s25, s20, 0
    v_add_u32 v1, v1, v2
    v_add_u32 v1, s25, v1
    v_cvt_pk_bf16_f32 v86, v20, v21
    v_cvt_pk_bf16_f32 v87, v22, v23
    buffer_store_dwordx2 v[86:87], v1, s[16:19], 0 offen offset:0
    s_waitcnt vmcnt(0)
    v_cvt_pk_bf16_f32 v86, v24, v25
    v_cvt_pk_bf16_f32 v87, v26, v27
    buffer_store_dwordx2 v[86:87], v1, s[16:19], 0 offen offset:16
    s_waitcnt vmcnt(0)
    v_cvt_pk_bf16_f32 v86, v28, v29
    v_cvt_pk_bf16_f32 v87, v30, v31
    buffer_store_dwordx2 v[86:87], v1, s[16:19], 0 offen offset:32
    s_waitcnt vmcnt(0)
    v_cvt_pk_bf16_f32 v86, v32, v33
    v_cvt_pk_bf16_f32 v87, v34, v35
    buffer_store_dwordx2 v[86:87], v1, s[16:19], 0 offen offset:48
    s_waitcnt vmcnt(0)
    v_cvt_pk_bf16_f32 v86, v36, v37
    v_cvt_pk_bf16_f32 v87, v38, v39
    s_mov_b32 s26, 458752
    buffer_store_dwordx2 v[86:87], v1, s[16:19], s26 offen offset:0
    s_waitcnt vmcnt(0)
    v_cvt_pk_bf16_f32 v86, v40, v41
    v_cvt_pk_bf16_f32 v87, v42, v43
    s_mov_b32 s26, 458752
    buffer_store_dwordx2 v[86:87], v1, s[16:19], s26 offen offset:16
    s_waitcnt vmcnt(0)
    v_cvt_pk_bf16_f32 v86, v44, v45
    v_cvt_pk_bf16_f32 v87, v46, v47
    s_mov_b32 s26, 458752
    buffer_store_dwordx2 v[86:87], v1, s[16:19], s26 offen offset:32
    s_waitcnt vmcnt(0)
    v_cvt_pk_bf16_f32 v86, v48, v49
    v_cvt_pk_bf16_f32 v87, v50, v51
    s_mov_b32 s26, 458752
    buffer_store_dwordx2 v[86:87], v1, s[16:19], s26 offen offset:48
    s_waitcnt vmcnt(0)
    v_cvt_pk_bf16_f32 v86, v52, v53
    v_cvt_pk_bf16_f32 v87, v54, v55
    buffer_store_dwordx2 v[86:87], v1, s[16:19], 0 offen offset:64
    s_waitcnt vmcnt(0)
    v_cvt_pk_bf16_f32 v86, v56, v57
    v_cvt_pk_bf16_f32 v87, v58, v59
    buffer_store_dwordx2 v[86:87], v1, s[16:19], 0 offen offset:80
    s_waitcnt vmcnt(0)
    v_cvt_pk_bf16_f32 v86, v60, v61
    v_cvt_pk_bf16_f32 v87, v62, v63
    buffer_store_dwordx2 v[86:87], v1, s[16:19], 0 offen offset:96
    s_waitcnt vmcnt(0)
    v_cvt_pk_bf16_f32 v86, v64, v65
    v_cvt_pk_bf16_f32 v87, v66, v67
    buffer_store_dwordx2 v[86:87], v1, s[16:19], 0 offen offset:112
    s_waitcnt vmcnt(0)
    v_cvt_pk_bf16_f32 v86, v68, v69
    v_cvt_pk_bf16_f32 v87, v70, v71
    s_mov_b32 s26, 458752
    buffer_store_dwordx2 v[86:87], v1, s[16:19], s26 offen offset:64
    s_waitcnt vmcnt(0)
    v_cvt_pk_bf16_f32 v86, v72, v73
    v_cvt_pk_bf16_f32 v87, v74, v75
    s_mov_b32 s26, 458752
    buffer_store_dwordx2 v[86:87], v1, s[16:19], s26 offen offset:80
    s_waitcnt vmcnt(0)
    v_cvt_pk_bf16_f32 v86, v76, v77
    v_cvt_pk_bf16_f32 v87, v78, v79
    s_mov_b32 s26, 458752
    buffer_store_dwordx2 v[86:87], v1, s[16:19], s26 offen offset:96
    s_waitcnt vmcnt(0)
    v_cvt_pk_bf16_f32 v86, v80, v81
    v_cvt_pk_bf16_f32 v87, v82, v83
    s_mov_b32 s26, 458752
    buffer_store_dwordx2 v[86:87], v1, s[16:19], s26 offen offset:112
    s_waitcnt vmcnt(0)
x_gu_done:
    s_endpgm
chain_kernel_done2:
    s_endpgm
.text
.globl parallel_sum__memory_aug_recurrent_mem_tr__dense_activation_gelu__prompt_kernel
.p2align 8
.type parallel_sum__memory_aug_recurrent_mem_tr__dense_activation_gelu__prompt_kernel,@function
parallel_sum__memory_aug_recurrent_mem_tr__dense_activation_gelu__prompt_kernel:
    s_cmp_ge_u32 s2, 256
    s_cbranch_scc1 parallel_sum__memory_aug_recurrent_mem_tr__dense_activation_gelu__prompt_kernel_done
    s_lshr_b32 s41, s2, 2
    s_and_b32 s47, s2, 3
    s_load_dwordx2 s[8:9], s[0:1], 112
    s_waitcnt lgkmcnt(0)
    s_and_b32 s9, s9, 0xffff
    s_mov_b32 s10, 0x1c0000
    s_mov_b32 s11, 0x00020000
    s_load_dwordx2 s[12:13], s[0:1], 112
    s_waitcnt lgkmcnt(0)
    s_add_u32 s12, s12, 0x6000000
    s_addc_u32 s13, s13, 0
    s_and_b32 s13, s13, 0xffff
    s_mov_b32 s14, 0x200000
    s_mov_b32 s15, 0x00020000
    s_load_dwordx2 s[24:25], s[0:1], 8
    s_waitcnt lgkmcnt(0)
    s_and_b32 s25, s25, 0xffff
    s_mov_b32 s26, 0x1c00
    s_mov_b32 s27, 0x00020000
    s_load_dwordx2 s[16:17], s[0:1], 112
    s_waitcnt lgkmcnt(0)
    s_add_u32 s16, s16, 0x2200000
    s_addc_u32 s17, s17, 0
    s_and_b32 s17, s17, 0xffff
    s_mov_b32 s18, 0x1c00000
    s_mov_b32 s19, 0x00020000
    s_load_dwordx2 s[20:21], s[0:1], 112
    s_waitcnt lgkmcnt(0)
    s_add_u32 s20, s20, 0x4000000
    s_addc_u32 s21, s21, 0
    s_and_b32 s21, s21, 0xffff
    s_mov_b32 s22, 0x1c00000
    s_mov_b32 s23, 0x00020000
    s_load_dwordx2 s[28:29], s[0:1], 112
    s_waitcnt lgkmcnt(0)
    s_add_u32 s28, s28, 0x6800000
    s_addc_u32 s29, s29, 0
    s_and_b32 s29, s29, 0xffff
    s_mov_b32 s30, 0x700000
    s_mov_b32 s31, 0x00020000
    v_and_b32 v1, 63, v0
    v_lshrrev_b32 v2, 6, v0
    v_and_b32 v3, 15, v0
    v_bfe_u32 v4, v0, 4, 2
    v_lshlrev_b32 v5, 4, v0
    v_mov_b32 v8, 0
    v_mov_b32 v9, 0
    v_mov_b32 v10, 0
    v_mov_b32 v11, 0
    ds_write_b128 v5, v[8:11] offset:29184
    ds_write_b128 v5, v[8:11] offset:33280
    ds_write_b128 v5, v[8:11] offset:37376
    s_waitcnt lgkmcnt(0)
    s_barrier
    s_mul_i32 s46, s41, 28672
    v_add_u32 v6, 0, v0
    s_mov_b32 s44, 0x4924925
    v_mul_hi_u32 v7, v6, s44
    v_mul_u32_u24 v8, 56, v7
    v_sub_u32 v8, v6, v8
    v_mul_u32_u24 v7, 912, v7
    v_lshl_add_u32 v9, v8, 4, v7
    buffer_load_dwordx4 v[12:15], v5, s[8:11], s46 offen offset:0
    s_waitcnt vmcnt(0)
    ds_write_b128 v9, v[12:15]
    v_add_u32 v6, 256, v0
    s_mov_b32 s44, 0x4924925
    v_mul_hi_u32 v7, v6, s44
    v_mul_u32_u24 v8, 56, v7
    v_sub_u32 v8, v6, v8
    v_mul_u32_u24 v7, 912, v7
    v_lshl_add_u32 v9, v8, 4, v7
    s_add_u32 s39, s46, 4096
    buffer_load_dwordx4 v[12:15], v5, s[8:11], s39 offen offset:0
    s_waitcnt vmcnt(0)
    ds_write_b128 v9, v[12:15]
    v_add_u32 v6, 512, v0
    s_mov_b32 s44, 0x4924925
    v_mul_hi_u32 v7, v6, s44
    v_mul_u32_u24 v8, 56, v7
    v_sub_u32 v8, v6, v8
    v_mul_u32_u24 v7, 912, v7
    v_lshl_add_u32 v9, v8, 4, v7
    s_add_u32 s39, s46, 8192
    buffer_load_dwordx4 v[12:15], v5, s[8:11], s39 offen offset:0
    s_waitcnt vmcnt(0)
    ds_write_b128 v9, v[12:15]
    v_add_u32 v6, 768, v0
    s_mov_b32 s44, 0x4924925
    v_mul_hi_u32 v7, v6, s44
    v_mul_u32_u24 v8, 56, v7
    v_sub_u32 v8, v6, v8
    v_mul_u32_u24 v7, 912, v7
    v_lshl_add_u32 v9, v8, 4, v7
    s_add_u32 s39, s46, 12288
    buffer_load_dwordx4 v[12:15], v5, s[8:11], s39 offen offset:0
    s_waitcnt vmcnt(0)
    ds_write_b128 v9, v[12:15]
    v_add_u32 v6, 1024, v0
    s_mov_b32 s44, 0x4924925
    v_mul_hi_u32 v7, v6, s44
    v_mul_u32_u24 v8, 56, v7
    v_sub_u32 v8, v6, v8
    v_mul_u32_u24 v7, 912, v7
    v_lshl_add_u32 v9, v8, 4, v7
    s_add_u32 s39, s46, 16384
    buffer_load_dwordx4 v[12:15], v5, s[8:11], s39 offen offset:0
    s_waitcnt vmcnt(0)
    ds_write_b128 v9, v[12:15]
    v_add_u32 v6, 1280, v0
    s_mov_b32 s44, 0x4924925
    v_mul_hi_u32 v7, v6, s44
    v_mul_u32_u24 v8, 56, v7
    v_sub_u32 v8, v6, v8
    v_mul_u32_u24 v7, 912, v7
    v_lshl_add_u32 v9, v8, 4, v7
    s_add_u32 s39, s46, 20480
    buffer_load_dwordx4 v[12:15], v5, s[8:11], s39 offen offset:0
    s_waitcnt vmcnt(0)
    ds_write_b128 v9, v[12:15]
    v_add_u32 v6, 1536, v0
    s_mov_b32 s44, 0x4924925
    v_mul_hi_u32 v7, v6, s44
    v_mul_u32_u24 v8, 56, v7
    v_sub_u32 v8, v6, v8
    v_mul_u32_u24 v7, 912, v7
    v_lshl_add_u32 v9, v8, 4, v7
    s_add_u32 s39, s46, 24576
    buffer_load_dwordx4 v[12:15], v5, s[8:11], s39 offen offset:0
    s_waitcnt vmcnt(0)
    ds_write_b128 v9, v[12:15]
    v_lshlrev_b32 v50, 3, v0
    v_lshlrev_b32 v51, 2, v0
    s_lshl_b32 s42, s41, 14
    v_add_u32 v6, 0, v0
    s_mov_b32 s44, 0x124924a
    v_mul_hi_u32 v7, v6, s44
    v_mul_u32_u24 v8, 224, v7
    v_sub_u32 v8, v6, v8
    v_mul_u32_u24 v7, 912, v7
    v_lshl_add_u32 v9, v8, 2, v7
    s_cmp_lg_u32 s41, 0
    s_cbranch_scc1 fm_13_a
    buffer_load_dword v12, v51, s[24:27], 0 offen offset:0
    s_branch fm_13_b
fm_13_a:
    buffer_load_dword v12, v50, s[12:15], s42 offen offset:0
fm_13_b:
    s_waitcnt vmcnt(0)
    ds_write_b32 v9, v12 offset:29184
    v_add_u32 v6, 256, v0
    s_mov_b32 s44, 0x124924a
    v_mul_hi_u32 v7, v6, s44
    v_mul_u32_u24 v8, 224, v7
    v_sub_u32 v8, v6, v8
    v_mul_u32_u24 v7, 912, v7
    v_lshl_add_u32 v9, v8, 2, v7
    s_cmp_lg_u32 s41, 0
    s_cbranch_scc1 fm_14_a
    buffer_load_dword v12, v51, s[24:27], 0 offen offset:1024
    s_branch fm_14_b
fm_14_a:
    buffer_load_dword v12, v50, s[12:15], s42 offen offset:2048
fm_14_b:
    s_waitcnt vmcnt(0)
    ds_write_b32 v9, v12 offset:29184
    v_add_u32 v6, 512, v0
    s_mov_b32 s44, 0x124924a
    v_mul_hi_u32 v7, v6, s44
    v_mul_u32_u24 v8, 224, v7
    v_sub_u32 v8, v6, v8
    v_mul_u32_u24 v7, 912, v7
    v_lshl_add_u32 v9, v8, 2, v7
    s_cmp_lg_u32 s41, 0
    s_cbranch_scc1 fm_15_a
    buffer_load_dword v12, v51, s[24:27], 0 offen offset:2048
    s_branch fm_15_b
fm_15_a:
    s_add_u32 s39, s42, 4096
    buffer_load_dword v12, v50, s[12:15], s39 offen offset:0
fm_15_b:
    s_waitcnt vmcnt(0)
    ds_write_b32 v9, v12 offset:29184
    v_add_u32 v6, 768, v0
    s_mov_b32 s44, 0x124924a
    v_mul_hi_u32 v7, v6, s44
    v_mul_u32_u24 v8, 224, v7
    v_sub_u32 v8, v6, v8
    v_mul_u32_u24 v7, 912, v7
    v_lshl_add_u32 v9, v8, 2, v7
    s_cmp_lg_u32 s41, 0
    s_cbranch_scc1 fm_16_a
    buffer_load_dword v12, v51, s[24:27], 0 offen offset:3072
    s_branch fm_16_b
fm_16_a:
    s_add_u32 s39, s42, 4096
    buffer_load_dword v12, v50, s[12:15], s39 offen offset:2048
fm_16_b:
    s_waitcnt vmcnt(0)
    ds_write_b32 v9, v12 offset:29184
    v_add_u32 v6, 1024, v0
    s_mov_b32 s44, 0x124924a
    v_mul_hi_u32 v7, v6, s44
    v_mul_u32_u24 v8, 224, v7
    v_sub_u32 v8, v6, v8
    v_mul_u32_u24 v7, 912, v7
    v_lshl_add_u32 v9, v8, 2, v7
    s_cmp_lg_u32 s41, 0
    s_cbranch_scc1 fm_17_a
    s_add_u32 s39, 0, 4096
    buffer_load_dword v12, v51, s[24:27], s39 offen offset:0
    s_branch fm_17_b
fm_17_a:
    s_add_u32 s39, s42, 8192
    buffer_load_dword v12, v50, s[12:15], s39 offen offset:0
fm_17_b:
    s_waitcnt vmcnt(0)
    ds_write_b32 v9, v12 offset:29184
    v_add_u32 v6, 1280, v0
    s_mov_b32 s44, 0x124924a
    v_mul_hi_u32 v7, v6, s44
    v_mul_u32_u24 v8, 224, v7
    v_sub_u32 v8, v6, v8
    v_mul_u32_u24 v7, 912, v7
    v_lshl_add_u32 v9, v8, 2, v7
    s_cmp_lg_u32 s41, 0
    s_cbranch_scc1 fm_18_a
    s_add_u32 s39, 0, 4096
    buffer_load_dword v12, v51, s[24:27], s39 offen offset:1024
    s_branch fm_18_b
fm_18_a:
    s_add_u32 s39, s42, 8192
    buffer_load_dword v12, v50, s[12:15], s39 offen offset:2048
fm_18_b:
    s_waitcnt vmcnt(0)
    ds_write_b32 v9, v12 offset:29184
    v_add_u32 v6, 1536, v0
    s_mov_b32 s44, 0x124924a
    v_mul_hi_u32 v7, v6, s44
    v_mul_u32_u24 v8, 224, v7
    v_sub_u32 v8, v6, v8
    v_mul_u32_u24 v7, 912, v7
    v_lshl_add_u32 v9, v8, 2, v7
    s_cmp_lg_u32 s41, 0
    s_cbranch_scc1 fm_19_a
    s_add_u32 s39, 0, 4096
    buffer_load_dword v12, v51, s[24:27], s39 offen offset:2048
    s_branch fm_19_b
fm_19_a:
    s_add_u32 s39, s42, 12288
    buffer_load_dword v12, v50, s[12:15], s39 offen offset:0
fm_19_b:
    s_waitcnt vmcnt(0)
    ds_write_b32 v9, v12 offset:29184
    s_waitcnt lgkmcnt(0)
    s_barrier
    v_mul_u32_u24 v40, 912, v3
    v_lshl_add_u32 v40, v4, 4, v40
    s_lshl_b32 s44, s41, 5
    v_add_u32 v41, s44, v3
    s_mov_b32 s45, 14336
    v_mul_lo_u32 v41, v41, s45
    v_lshl_add_u32 v41, v4, 4, v41
    v_mul_u32_u24 v6, 3584, v2
    v_add_u32 v41, v41, v6
    s_mul_i32 s44, s47, 112
    v_mul_u32_u24 v42, 1792, v2
    v_add_u32 v42, v42, v3
    v_add_u32 v42, s44, v42
    v_mov_b32 v43, v42
    v_lshlrev_b32 v42, 12, v42
    v_lshl_add_u32 v42, v4, 3, v42
    s_lshl_b32 s44, s41, 6
    v_add_u32 v42, s44, v42
    v_lshlrev_b32 v43, 4, v43
    v_lshl_add_u32 v43, v4, 3, v43
    s_mul_i32 s44, s41, 114688
    v_add_u32 v43, s44, v43
    v_cmp_lt_u32 vcc, 1, v4
    v_mov_b32 v6, 0x7f000000
    s_nop 1
    v_cndmask_b32 v44, 0, v6, vcc
    v_add_u32 v43, v43, v44
    v_mov_b32 v128, 0
    v_mov_b32 v129, 0
    v_mov_b32 v130, 0
    v_mov_b32 v131, 0
    v_mov_b32 v132, 0
    v_mov_b32 v133, 0
    v_mov_b32 v134, 0
    v_mov_b32 v135, 0
    v_mov_b32 v136, 0
    v_mov_b32 v137, 0
    v_mov_b32 v138, 0
    v_mov_b32 v139, 0
    v_mov_b32 v140, 0
    v_mov_b32 v141, 0
    v_mov_b32 v142, 0
    v_mov_b32 v143, 0
    v_mov_b32 v144, 0
    v_mov_b32 v145, 0
    v_mov_b32 v146, 0
    v_mov_b32 v147, 0
    v_mov_b32 v148, 0
    v_mov_b32 v149, 0
    v_mov_b32 v150, 0
    v_mov_b32 v151, 0
    v_mov_b32 v152, 0
    v_mov_b32 v153, 0
    v_mov_b32 v154, 0
    v_mov_b32 v155, 0
    v_mov_b32 v156, 0
    v_mov_b32 v157, 0
    v_mov_b32 v158, 0
    v_mov_b32 v159, 0
    v_mov_b32 v160, 0
    v_mov_b32 v161, 0
    v_mov_b32 v162, 0
    v_mov_b32 v163, 0
    v_mov_b32 v164, 0
    v_mov_b32 v165, 0
    v_mov_b32 v166, 0
    v_mov_b32 v167, 0
    v_mov_b32 v168, 0
    v_mov_b32 v169, 0
    v_mov_b32 v170, 0
    v_mov_b32 v171, 0
    v_mov_b32 v172, 0
    v_mov_b32 v173, 0
    v_mov_b32 v174, 0
    v_mov_b32 v175, 0
    v_mov_b32 v176, 0
    v_mov_b32 v177, 0
    v_mov_b32 v178, 0
    v_mov_b32 v179, 0
    v_mov_b32 v180, 0
    v_mov_b32 v181, 0
    v_mov_b32 v182, 0
    v_mov_b32 v183, 0
    v_mov_b32 v118, 0xff800000
    v_mov_b32 v8, 0
    v_mov_b32 v9, 0
    v_mov_b32 v10, 0
    v_mov_b32 v11, 0
    v_mov_b32 v12, 0
    v_mov_b32 v13, 0
    v_mov_b32 v14, 0
    v_mov_b32 v15, 0
    v_mov_b32 v16, 0
    v_mov_b32 v17, 0
    v_mov_b32 v18, 0
    v_mov_b32 v19, 0
    v_mov_b32 v20, 0
    v_mov_b32 v21, 0
    v_mov_b32 v22, 0
    v_mov_b32 v23, 0
    v_mov_b32 v24, 0
    v_mov_b32 v25, 0
    v_mov_b32 v26, 0
    v_mov_b32 v27, 0
    v_mov_b32 v28, 0
    v_mov_b32 v29, 0
    v_mov_b32 v30, 0
    v_mov_b32 v31, 0
    s_mov_b32 s45, 0
    buffer_load_dwordx4 v[184:187], v41, s[16:19], s45 offen offset:0
    s_mov_b32 s45, 229376
    buffer_load_dwordx4 v[188:191], v41, s[16:19], s45 offen offset:0
    s_mov_b32 s45, 0
    buffer_load_dwordx4 v[192:195], v41, s[16:19], s45 offen offset:64
    s_mov_b32 s45, 229376
    buffer_load_dwordx4 v[196:199], v41, s[16:19], s45 offen offset:64
    s_mov_b32 s45, 0
    buffer_load_dwordx4 v[200:203], v41, s[16:19], s45 offen offset:128
    s_mov_b32 s45, 229376
    buffer_load_dwordx4 v[204:207], v41, s[16:19], s45 offen offset:128
    s_mov_b32 s45, 0
    buffer_load_dwordx4 v[208:211], v41, s[16:19], s45 offen offset:192
    s_mov_b32 s45, 229376
    buffer_load_dwordx4 v[212:215], v41, s[16:19], s45 offen offset:192
    s_mov_b32 s45, 0
    buffer_load_dwordx4 v[216:219], v41, s[16:19], s45 offen offset:256
    s_mov_b32 s45, 229376
    buffer_load_dwordx4 v[220:223], v41, s[16:19], s45 offen offset:256
    s_mov_b32 s45, 0
    buffer_load_dwordx4 v[224:227], v41, s[16:19], s45 offen offset:320
    s_mov_b32 s45, 229376
    buffer_load_dwordx4 v[228:231], v41, s[16:19], s45 offen offset:320
    s_mov_b32 s45, 0
    buffer_load_dwordx4 v[232:235], v41, s[16:19], s45 offen offset:384
    s_mov_b32 s45, 229376
    buffer_load_dwordx4 v[236:239], v41, s[16:19], s45 offen offset:384
    ds_read_b128 v[68:71], v40 offset:0
    ds_read_b128 v[72:75], v40 offset:14592
    ds_read_b128 v[76:79], v40 offset:29184
    s_waitcnt vmcnt(12) lgkmcnt(0)
    v_mfma_f32_16x16x32_bf16 v[8:11], v[68:71], v[184:187], v[8:11]
    v_mfma_f32_16x16x32_bf16 v[12:15], v[68:71], v[188:191], v[12:15]
    v_mfma_f32_16x16x32_bf16 v[16:19], v[72:75], v[184:187], v[16:19]
    v_mfma_f32_16x16x32_bf16 v[20:23], v[72:75], v[188:191], v[20:23]
    v_mfma_f32_16x16x32_bf16 v[24:27], v[76:79], v[184:187], v[24:27]
    v_mfma_f32_16x16x32_bf16 v[28:31], v[76:79], v[188:191], v[28:31]
    ds_read_b128 v[68:71], v40 offset:64
    ds_read_b128 v[72:75], v40 offset:14656
    ds_read_b128 v[76:79], v40 offset:29248
    s_waitcnt vmcnt(10) lgkmcnt(0)
    v_mfma_f32_16x16x32_bf16 v[8:11], v[68:71], v[192:195], v[8:11]
    v_mfma_f32_16x16x32_bf16 v[12:15], v[68:71], v[196:199], v[12:15]
    v_mfma_f32_16x16x32_bf16 v[16:19], v[72:75], v[192:195], v[16:19]
    v_mfma_f32_16x16x32_bf16 v[20:23], v[72:75], v[196:199], v[20:23]
    v_mfma_f32_16x16x32_bf16 v[24:27], v[76:79], v[192:195], v[24:27]
    v_mfma_f32_16x16x32_bf16 v[28:31], v[76:79], v[196:199], v[28:31]
    ds_read_b128 v[68:71], v40 offset:128
    ds_read_b128 v[72:75], v40 offset:14720
    ds_read_b128 v[76:79], v40 offset:29312
    s_waitcnt vmcnt(8) lgkmcnt(0)
    v_mfma_f32_16x16x32_bf16 v[8:11], v[68:71], v[200:203], v[8:11]
    v_mfma_f32_16x16x32_bf16 v[12:15], v[68:71], v[204:207], v[12:15]
    v_mfma_f32_16x16x32_bf16 v[16:19], v[72:75], v[200:203], v[16:19]
    v_mfma_f32_16x16x32_bf16 v[20:23], v[72:75], v[204:207], v[20:23]
    v_mfma_f32_16x16x32_bf16 v[24:27], v[76:79], v[200:203], v[24:27]
    v_mfma_f32_16x16x32_bf16 v[28:31], v[76:79], v[204:207], v[28:31]
    ds_read_b128 v[68:71], v40 offset:192
    ds_read_b128 v[72:75], v40 offset:14784
    ds_read_b128 v[76:79], v40 offset:29376
    s_waitcnt vmcnt(6) lgkmcnt(0)
    v_mfma_f32_16x16x32_bf16 v[8:11], v[68:71], v[208:211], v[8:11]
    v_mfma_f32_16x16x32_bf16 v[12:15], v[68:71], v[212:215], v[12:15]
    v_mfma_f32_16x16x32_bf16 v[16:19], v[72:75], v[208:211], v[16:19]
    v_mfma_f32_16x16x32_bf16 v[20:23], v[72:75], v[212:215], v[20:23]
    v_mfma_f32_16x16x32_bf16 v[24:27], v[76:79], v[208:211], v[24:27]
    v_mfma_f32_16x16x32_bf16 v[28:31], v[76:79], v[212:215], v[28:31]
    ds_read_b128 v[68:71], v40 offset:256
    ds_read_b128 v[72:75], v40 offset:14848
    ds_read_b128 v[76:79], v40 offset:29440
    s_waitcnt vmcnt(4) lgkmcnt(0)
    v_mfma_f32_16x16x32_bf16 v[8:11], v[68:71], v[216:219], v[8:11]
    v_mfma_f32_16x16x32_bf16 v[12:15], v[68:71], v[220:223], v[12:15]
    v_mfma_f32_16x16x32_bf16 v[16:19], v[72:75], v[216:219], v[16:19]
    v_mfma_f32_16x16x32_bf16 v[20:23], v[72:75], v[220:223], v[20:23]
    v_mfma_f32_16x16x32_bf16 v[24:27], v[76:79], v[216:219], v[24:27]
    v_mfma_f32_16x16x32_bf16 v[28:31], v[76:79], v[220:223], v[28:31]
    ds_read_b128 v[68:71], v40 offset:320
    ds_read_b128 v[72:75], v40 offset:14912
    ds_read_b128 v[76:79], v40 offset:29504
    s_waitcnt vmcnt(2) lgkmcnt(0)
    v_mfma_f32_16x16x32_bf16 v[8:11], v[68:71], v[224:227], v[8:11]
    v_mfma_f32_16x16x32_bf16 v[12:15], v[68:71], v[228:231], v[12:15]
    v_mfma_f32_16x16x32_bf16 v[16:19], v[72:75], v[224:227], v[16:19]
    v_mfma_f32_16x16x32_bf16 v[20:23], v[72:75], v[228:231], v[20:23]
    v_mfma_f32_16x16x32_bf16 v[24:27], v[76:79], v[224:227], v[24:27]
    v_mfma_f32_16x16x32_bf16 v[28:31], v[76:79], v[228:231], v[28:31]
    ds_read_b128 v[68:71], v40 offset:384
    ds_read_b128 v[72:75], v40 offset:14976
    ds_read_b128 v[76:79], v40 offset:29568
    s_waitcnt vmcnt(0) lgkmcnt(0)
    v_mfma_f32_16x16x32_bf16 v[8:11], v[68:71], v[232:235], v[8:11]
    v_mfma_f32_16x16x32_bf16 v[12:15], v[68:71], v[236:239], v[12:15]
    v_mfma_f32_16x16x32_bf16 v[16:19], v[72:75], v[232:235], v[16:19]
    v_mfma_f32_16x16x32_bf16 v[20:23], v[72:75], v[236:239], v[20:23]
    v_mfma_f32_16x16x32_bf16 v[24:27], v[76:79], v[232:235], v[24:27]
    v_mfma_f32_16x16x32_bf16 v[28:31], v[76:79], v[236:239], v[28:31]
    s_mov_b32 s45, 0
    buffer_load_dwordx4 v[184:187], v41, s[16:19], s45 offen offset:448
    s_mov_b32 s45, 229376
    buffer_load_dwordx4 v[188:191], v41, s[16:19], s45 offen offset:448
    s_mov_b32 s45, 0
    buffer_load_dwordx4 v[192:195], v41, s[16:19], s45 offen offset:512
    s_mov_b32 s45, 229376
    buffer_load_dwordx4 v[196:199], v41, s[16:19], s45 offen offset:512
    s_mov_b32 s45, 0
    buffer_load_dwordx4 v[200:203], v41, s[16:19], s45 offen offset:576
    s_mov_b32 s45, 229376
    buffer_load_dwordx4 v[204:207], v41, s[16:19], s45 offen offset:576
    s_mov_b32 s45, 0
    buffer_load_dwordx4 v[208:211], v41, s[16:19], s45 offen offset:640
    s_mov_b32 s45, 229376
    buffer_load_dwordx4 v[212:215], v41, s[16:19], s45 offen offset:640
    s_mov_b32 s45, 0
    buffer_load_dwordx4 v[216:219], v41, s[16:19], s45 offen offset:704
    s_mov_b32 s45, 229376
    buffer_load_dwordx4 v[220:223], v41, s[16:19], s45 offen offset:704
    s_mov_b32 s45, 0
    buffer_load_dwordx4 v[224:227], v41, s[16:19], s45 offen offset:768
    s_mov_b32 s45, 229376
    buffer_load_dwordx4 v[228:231], v41, s[16:19], s45 offen offset:768
    s_mov_b32 s45, 0
    buffer_load_dwordx4 v[232:235], v41, s[16:19], s45 offen offset:832
    s_mov_b32 s45, 229376
    buffer_load_dwordx4 v[236:239], v41, s[16:19], s45 offen offset:832
    ds_read_b128 v[68:71], v40 offset:448
    ds_read_b128 v[72:75], v40 offset:15040
    ds_read_b128 v[76:79], v40 offset:29632
    s_waitcnt vmcnt(12) lgkmcnt(0)
    v_mfma_f32_16x16x32_bf16 v[8:11], v[68:71], v[184:187], v[8:11]
    v_mfma_f32_16x16x32_bf16 v[12:15], v[68:71], v[188:191], v[12:15]
    v_mfma_f32_16x16x32_bf16 v[16:19], v[72:75], v[184:187], v[16:19]
    v_mfma_f32_16x16x32_bf16 v[20:23], v[72:75], v[188:191], v[20:23]
    v_mfma_f32_16x16x32_bf16 v[24:27], v[76:79], v[184:187], v[24:27]
    v_mfma_f32_16x16x32_bf16 v[28:31], v[76:79], v[188:191], v[28:31]
    ds_read_b128 v[68:71], v40 offset:512
    ds_read_b128 v[72:75], v40 offset:15104
    ds_read_b128 v[76:79], v40 offset:29696
    s_waitcnt vmcnt(10) lgkmcnt(0)
    v_mfma_f32_16x16x32_bf16 v[8:11], v[68:71], v[192:195], v[8:11]
    v_mfma_f32_16x16x32_bf16 v[12:15], v[68:71], v[196:199], v[12:15]
    v_mfma_f32_16x16x32_bf16 v[16:19], v[72:75], v[192:195], v[16:19]
    v_mfma_f32_16x16x32_bf16 v[20:23], v[72:75], v[196:199], v[20:23]
    v_mfma_f32_16x16x32_bf16 v[24:27], v[76:79], v[192:195], v[24:27]
    v_mfma_f32_16x16x32_bf16 v[28:31], v[76:79], v[196:199], v[28:31]
    ds_read_b128 v[68:71], v40 offset:576
    ds_read_b128 v[72:75], v40 offset:15168
    ds_read_b128 v[76:79], v40 offset:29760
    s_waitcnt vmcnt(8) lgkmcnt(0)
    v_mfma_f32_16x16x32_bf16 v[8:11], v[68:71], v[200:203], v[8:11]
    v_mfma_f32_16x16x32_bf16 v[12:15], v[68:71], v[204:207], v[12:15]
    v_mfma_f32_16x16x32_bf16 v[16:19], v[72:75], v[200:203], v[16:19]
    v_mfma_f32_16x16x32_bf16 v[20:23], v[72:75], v[204:207], v[20:23]
    v_mfma_f32_16x16x32_bf16 v[24:27], v[76:79], v[200:203], v[24:27]
    v_mfma_f32_16x16x32_bf16 v[28:31], v[76:79], v[204:207], v[28:31]
    ds_read_b128 v[68:71], v40 offset:640
    ds_read_b128 v[72:75], v40 offset:15232
    ds_read_b128 v[76:79], v40 offset:29824
    s_waitcnt vmcnt(6) lgkmcnt(0)
    v_mfma_f32_16x16x32_bf16 v[8:11], v[68:71], v[208:211], v[8:11]
    v_mfma_f32_16x16x32_bf16 v[12:15], v[68:71], v[212:215], v[12:15]
    v_mfma_f32_16x16x32_bf16 v[16:19], v[72:75], v[208:211], v[16:19]
    v_mfma_f32_16x16x32_bf16 v[20:23], v[72:75], v[212:215], v[20:23]
    v_mfma_f32_16x16x32_bf16 v[24:27], v[76:79], v[208:211], v[24:27]
    v_mfma_f32_16x16x32_bf16 v[28:31], v[76:79], v[212:215], v[28:31]
    ds_read_b128 v[68:71], v40 offset:704
    ds_read_b128 v[72:75], v40 offset:15296
    ds_read_b128 v[76:79], v40 offset:29888
    s_waitcnt vmcnt(4) lgkmcnt(0)
    v_mfma_f32_16x16x32_bf16 v[8:11], v[68:71], v[216:219], v[8:11]
    v_mfma_f32_16x16x32_bf16 v[12:15], v[68:71], v[220:223], v[12:15]
    v_mfma_f32_16x16x32_bf16 v[16:19], v[72:75], v[216:219], v[16:19]
    v_mfma_f32_16x16x32_bf16 v[20:23], v[72:75], v[220:223], v[20:23]
    v_mfma_f32_16x16x32_bf16 v[24:27], v[76:79], v[216:219], v[24:27]
    v_mfma_f32_16x16x32_bf16 v[28:31], v[76:79], v[220:223], v[28:31]
    ds_read_b128 v[68:71], v40 offset:768
    ds_read_b128 v[72:75], v40 offset:15360
    ds_read_b128 v[76:79], v40 offset:29952
    s_waitcnt vmcnt(2) lgkmcnt(0)
    v_mfma_f32_16x16x32_bf16 v[8:11], v[68:71], v[224:227], v[8:11]
    v_mfma_f32_16x16x32_bf16 v[12:15], v[68:71], v[228:231], v[12:15]
    v_mfma_f32_16x16x32_bf16 v[16:19], v[72:75], v[224:227], v[16:19]
    v_mfma_f32_16x16x32_bf16 v[20:23], v[72:75], v[228:231], v[20:23]
    v_mfma_f32_16x16x32_bf16 v[24:27], v[76:79], v[224:227], v[24:27]
    v_mfma_f32_16x16x32_bf16 v[28:31], v[76:79], v[228:231], v[28:31]
    ds_read_b128 v[68:71], v40 offset:832
    ds_read_b128 v[72:75], v40 offset:15424
    ds_read_b128 v[76:79], v40 offset:30016
    s_waitcnt vmcnt(0) lgkmcnt(0)
    v_mfma_f32_16x16x32_bf16 v[8:11], v[68:71], v[232:235], v[8:11]
    v_mfma_f32_16x16x32_bf16 v[12:15], v[68:71], v[236:239], v[12:15]
    v_mfma_f32_16x16x32_bf16 v[16:19], v[72:75], v[232:235], v[16:19]
    v_mfma_f32_16x16x32_bf16 v[20:23], v[72:75], v[236:239], v[20:23]
    v_mfma_f32_16x16x32_bf16 v[24:27], v[76:79], v[232:235], v[24:27]
    v_mfma_f32_16x16x32_bf16 v[28:31], v[76:79], v[236:239], v[28:31]
    s_mov_b32 s45, 0
    buffer_load_dwordx2 v[184:185], v42, s[20:23], s45 offen
    buffer_load_dwordx2 v[186:187], v42, s[20:23], s45 offen offset:32
    s_mov_b32 s45, 0
    buffer_load_dwordx2 v[188:189], v43, s[28:31], s45 offen
    v_mov_b32 v190, 0
    v_mov_b32 v191, 0
    s_mov_b32 s45, 65536
    buffer_load_dwordx2 v[192:193], v42, s[20:23], s45 offen
    buffer_load_dwordx2 v[194:195], v42, s[20:23], s45 offen offset:32
    s_mov_b32 s45, 256
    buffer_load_dwordx2 v[196:197], v43, s[28:31], s45 offen
    v_mov_b32 v198, 0
    v_mov_b32 v199, 0
    s_mov_b32 s45, 131072
    buffer_load_dwordx2 v[200:201], v42, s[20:23], s45 offen
    buffer_load_dwordx2 v[202:203], v42, s[20:23], s45 offen offset:32
    s_mov_b32 s45, 512
    buffer_load_dwordx2 v[204:205], v43, s[28:31], s45 offen
    v_mov_b32 v206, 0
    v_mov_b32 v207, 0
    s_mov_b32 s45, 196608
    buffer_load_dwordx2 v[208:209], v42, s[20:23], s45 offen
    buffer_load_dwordx2 v[210:211], v42, s[20:23], s45 offen offset:32
    s_mov_b32 s45, 768
    buffer_load_dwordx2 v[212:213], v43, s[28:31], s45 offen
    v_mov_b32 v214, 0
    v_mov_b32 v215, 0
    s_mov_b32 s45, 262144
    buffer_load_dwordx2 v[216:217], v42, s[20:23], s45 offen
    buffer_load_dwordx2 v[218:219], v42, s[20:23], s45 offen offset:32
    s_mov_b32 s45, 1024
    buffer_load_dwordx2 v[220:221], v43, s[28:31], s45 offen
    v_mov_b32 v222, 0
    v_mov_b32 v223, 0
    s_mov_b32 s45, 327680
    buffer_load_dwordx2 v[224:225], v42, s[20:23], s45 offen
    buffer_load_dwordx2 v[226:227], v42, s[20:23], s45 offen offset:32
    s_mov_b32 s45, 1280
    buffer_load_dwordx2 v[228:229], v43, s[28:31], s45 offen
    v_mov_b32 v230, 0
    v_mov_b32 v231, 0
    s_mov_b32 s45, 393216
    buffer_load_dwordx2 v[232:233], v42, s[20:23], s45 offen
    buffer_load_dwordx2 v[234:235], v42, s[20:23], s45 offen offset:32
    s_mov_b32 s45, 1536
    buffer_load_dwordx2 v[236:237], v43, s[28:31], s45 offen
    v_mov_b32 v238, 0
    v_mov_b32 v239, 0
    s_nop 7
    v_lshl_add_u32 v6, v4, 2, 0
    v_add_u32 v7, 0, v3
    v_cmp_le_u32 vcc, v6, v7
    s_nop 1
    v_cndmask_b32 v8, v118, v8, vcc
    v_lshl_add_u32 v6, v4, 2, 1
    v_add_u32 v7, 0, v3
    v_cmp_le_u32 vcc, v6, v7
    s_nop 1
    v_cndmask_b32 v9, v118, v9, vcc
    v_lshl_add_u32 v6, v4, 2, 2
    v_add_u32 v7, 0, v3
    v_cmp_le_u32 vcc, v6, v7
    s_nop 1
    v_cndmask_b32 v10, v118, v10, vcc
    v_lshl_add_u32 v6, v4, 2, 3
    v_add_u32 v7, 0, v3
    v_cmp_le_u32 vcc, v6, v7
    s_nop 1
    v_cndmask_b32 v11, v118, v11, vcc
    v_lshl_add_u32 v6, v4, 2, 16
    v_add_u32 v7, 0, v3
    v_cmp_le_u32 vcc, v6, v7
    s_nop 1
    v_cndmask_b32 v16, v118, v16, vcc
    v_lshl_add_u32 v6, v4, 2, 17
    v_add_u32 v7, 0, v3
    v_cmp_le_u32 vcc, v6, v7
    s_nop 1
    v_cndmask_b32 v17, v118, v17, vcc
    v_lshl_add_u32 v6, v4, 2, 18
    v_add_u32 v7, 0, v3
    v_cmp_le_u32 vcc, v6, v7
    s_nop 1
    v_cndmask_b32 v18, v118, v18, vcc
    v_lshl_add_u32 v6, v4, 2, 19
    v_add_u32 v7, 0, v3
    v_cmp_le_u32 vcc, v6, v7
    s_nop 1
    v_cndmask_b32 v19, v118, v19, vcc
    v_cmp_gt_u32 vcc, 2, v4
    s_nop 1
    v_cndmask_b32 v24, v118, v24, vcc
    v_cmp_gt_u32 vcc, 2, v4
    s_nop 1
    v_cndmask_b32 v25, v118, v25, vcc
    v_cmp_gt_u32 vcc, 2, v4
    s_nop 1
    v_cndmask_b32 v26, v118, v26, vcc
    v_cmp_gt_u32 vcc, 2, v4
    s_nop 1
    v_cndmask_b32 v27, v118, v27, vcc
    v_max_f32 v32, v8, v9
    v_max_f32 v32, v32, v10
    v_max_f32 v32, v32, v11
    v_max_f32 v32, v32, v16
    v_max_f32 v32, v32, v17
    v_max_f32 v32, v32, v18
    v_max_f32 v32, v32, v19
    v_max_f32 v32, v32, v24
    v_max_f32 v32, v32, v25
    v_max_f32 v32, v32, v26
    v_max_f32 v32, v32, v27
    v_xor_b32 v33, 16, v1
    v_lshlrev_b32 v33, 2, v33
    ds_bpermute_b32 v34, v33, v32
    s_waitcnt lgkmcnt(0)
    v_max_f32 v32, v32, v34
    v_xor_b32 v33, 32, v1
    v_lshlrev_b32 v33, 2, v33
    ds_bpermute_b32 v34, v33, v32
    s_waitcnt lgkmcnt(0)
    v_max_f32 v32, v32, v34
    v_sub_f32 v8, v8, v32
    v_mul_f32 v8, 0x3fb8aa3b, v8
    v_exp_f32 v8, v8
    v_sub_f32 v9, v9, v32
    v_mul_f32 v9, 0x3fb8aa3b, v9
    v_exp_f32 v9, v9
    v_sub_f32 v10, v10, v32
    v_mul_f32 v10, 0x3fb8aa3b, v10
    v_exp_f32 v10, v10
    v_sub_f32 v11, v11, v32
    v_mul_f32 v11, 0x3fb8aa3b, v11
    v_exp_f32 v11, v11
    v_sub_f32 v16, v16, v32
    v_mul_f32 v16, 0x3fb8aa3b, v16
    v_exp_f32 v16, v16
    v_sub_f32 v17, v17, v32
    v_mul_f32 v17, 0x3fb8aa3b, v17
    v_exp_f32 v17, v17
    v_sub_f32 v18, v18, v32
    v_mul_f32 v18, 0x3fb8aa3b, v18
    v_exp_f32 v18, v18
    v_sub_f32 v19, v19, v32
    v_mul_f32 v19, 0x3fb8aa3b, v19
    v_exp_f32 v19, v19
    v_sub_f32 v24, v24, v32
    v_mul_f32 v24, 0x3fb8aa3b, v24
    v_exp_f32 v24, v24
    v_sub_f32 v25, v25, v32
    v_mul_f32 v25, 0x3fb8aa3b, v25
    v_exp_f32 v25, v25
    v_sub_f32 v26, v26, v32
    v_mul_f32 v26, 0x3fb8aa3b, v26
    v_exp_f32 v26, v26
    v_sub_f32 v27, v27, v32
    v_mul_f32 v27, 0x3fb8aa3b, v27
    v_exp_f32 v27, v27
    s_nop 0
    v_add_f32 v32, v8, v9
    v_add_f32 v32, v32, v10
    v_add_f32 v32, v32, v11
    v_add_f32 v32, v32, v16
    v_add_f32 v32, v32, v17
    v_add_f32 v32, v32, v18
    v_add_f32 v32, v32, v19
    v_add_f32 v32, v32, v24
    v_add_f32 v32, v32, v25
    v_add_f32 v32, v32, v26
    v_add_f32 v32, v32, v27
    v_xor_b32 v33, 16, v1
    v_lshlrev_b32 v33, 2, v33
    ds_bpermute_b32 v34, v33, v32
    s_waitcnt lgkmcnt(0)
    v_add_f32 v32, v32, v34
    v_xor_b32 v33, 32, v1
    v_lshlrev_b32 v33, 2, v33
    ds_bpermute_b32 v34, v33, v32
    s_waitcnt lgkmcnt(0)
    v_add_f32 v32, v32, v34
    v_rcp_f32 v32, v32
    s_nop 0
    v_mul_f32 v8, v8, v32
    v_mul_f32 v9, v9, v32
    v_mul_f32 v10, v10, v32
    v_mul_f32 v11, v11, v32
    v_mul_f32 v16, v16, v32
    v_mul_f32 v17, v17, v32
    v_mul_f32 v18, v18, v32
    v_mul_f32 v19, v19, v32
    v_mul_f32 v24, v24, v32
    v_mul_f32 v25, v25, v32
    v_mul_f32 v26, v26, v32
    v_mul_f32 v27, v27, v32
    v_cvt_pk_bf16_f32 v80, v8, v9
    v_cvt_pk_bf16_f32 v81, v10, v11
    v_cvt_pk_bf16_f32 v82, v16, v17
    v_cvt_pk_bf16_f32 v83, v18, v19
    v_cvt_pk_bf16_f32 v84, v24, v25
    v_cvt_pk_bf16_f32 v85, v26, v27
    v_mov_b32 v86, 0
    v_mov_b32 v87, 0
    v_lshl_add_u32 v6, v4, 2, 0
    v_add_u32 v7, 16, v3
    v_cmp_le_u32 vcc, v6, v7
    s_nop 1
    v_cndmask_b32 v12, v118, v12, vcc
    v_lshl_add_u32 v6, v4, 2, 1
    v_add_u32 v7, 16, v3
    v_cmp_le_u32 vcc, v6, v7
    s_nop 1
    v_cndmask_b32 v13, v118, v13, vcc
    v_lshl_add_u32 v6, v4, 2, 2
    v_add_u32 v7, 16, v3
    v_cmp_le_u32 vcc, v6, v7
    s_nop 1
    v_cndmask_b32 v14, v118, v14, vcc
    v_lshl_add_u32 v6, v4, 2, 3
    v_add_u32 v7, 16, v3
    v_cmp_le_u32 vcc, v6, v7
    s_nop 1
    v_cndmask_b32 v15, v118, v15, vcc
    v_lshl_add_u32 v6, v4, 2, 16
    v_add_u32 v7, 16, v3
    v_cmp_le_u32 vcc, v6, v7
    s_nop 1
    v_cndmask_b32 v20, v118, v20, vcc
    v_lshl_add_u32 v6, v4, 2, 17
    v_add_u32 v7, 16, v3
    v_cmp_le_u32 vcc, v6, v7
    s_nop 1
    v_cndmask_b32 v21, v118, v21, vcc
    v_lshl_add_u32 v6, v4, 2, 18
    v_add_u32 v7, 16, v3
    v_cmp_le_u32 vcc, v6, v7
    s_nop 1
    v_cndmask_b32 v22, v118, v22, vcc
    v_lshl_add_u32 v6, v4, 2, 19
    v_add_u32 v7, 16, v3
    v_cmp_le_u32 vcc, v6, v7
    s_nop 1
    v_cndmask_b32 v23, v118, v23, vcc
    v_cmp_gt_u32 vcc, 2, v4
    s_nop 1
    v_cndmask_b32 v28, v118, v28, vcc
    v_cmp_gt_u32 vcc, 2, v4
    s_nop 1
    v_cndmask_b32 v29, v118, v29, vcc
    v_cmp_gt_u32 vcc, 2, v4
    s_nop 1
    v_cndmask_b32 v30, v118, v30, vcc
    v_cmp_gt_u32 vcc, 2, v4
    s_nop 1
    v_cndmask_b32 v31, v118, v31, vcc
    v_max_f32 v32, v12, v13
    v_max_f32 v32, v32, v14
    v_max_f32 v32, v32, v15
    v_max_f32 v32, v32, v20
    v_max_f32 v32, v32, v21
    v_max_f32 v32, v32, v22
    v_max_f32 v32, v32, v23
    v_max_f32 v32, v32, v28
    v_max_f32 v32, v32, v29
    v_max_f32 v32, v32, v30
    v_max_f32 v32, v32, v31
    v_xor_b32 v33, 16, v1
    v_lshlrev_b32 v33, 2, v33
    ds_bpermute_b32 v34, v33, v32
    s_waitcnt lgkmcnt(0)
    v_max_f32 v32, v32, v34
    v_xor_b32 v33, 32, v1
    v_lshlrev_b32 v33, 2, v33
    ds_bpermute_b32 v34, v33, v32
    s_waitcnt lgkmcnt(0)
    v_max_f32 v32, v32, v34
    v_sub_f32 v12, v12, v32
    v_mul_f32 v12, 0x3fb8aa3b, v12
    v_exp_f32 v12, v12
    v_sub_f32 v13, v13, v32
    v_mul_f32 v13, 0x3fb8aa3b, v13
    v_exp_f32 v13, v13
    v_sub_f32 v14, v14, v32
    v_mul_f32 v14, 0x3fb8aa3b, v14
    v_exp_f32 v14, v14
    v_sub_f32 v15, v15, v32
    v_mul_f32 v15, 0x3fb8aa3b, v15
    v_exp_f32 v15, v15
    v_sub_f32 v20, v20, v32
    v_mul_f32 v20, 0x3fb8aa3b, v20
    v_exp_f32 v20, v20
    v_sub_f32 v21, v21, v32
    v_mul_f32 v21, 0x3fb8aa3b, v21
    v_exp_f32 v21, v21
    v_sub_f32 v22, v22, v32
    v_mul_f32 v22, 0x3fb8aa3b, v22
    v_exp_f32 v22, v22
    v_sub_f32 v23, v23, v32
    v_mul_f32 v23, 0x3fb8aa3b, v23
    v_exp_f32 v23, v23
    v_sub_f32 v28, v28, v32
    v_mul_f32 v28, 0x3fb8aa3b, v28
    v_exp_f32 v28, v28
    v_sub_f32 v29, v29, v32
    v_mul_f32 v29, 0x3fb8aa3b, v29
    v_exp_f32 v29, v29
    v_sub_f32 v30, v30, v32
    v_mul_f32 v30, 0x3fb8aa3b, v30
    v_exp_f32 v30, v30
    v_sub_f32 v31, v31, v32
    v_mul_f32 v31, 0x3fb8aa3b, v31
    v_exp_f32 v31, v31
    s_nop 0
    v_add_f32 v32, v12, v13
    v_add_f32 v32, v32, v14
    v_add_f32 v32, v32, v15
    v_add_f32 v32, v32, v20
    v_add_f32 v32, v32, v21
    v_add_f32 v32, v32, v22
    v_add_f32 v32, v32, v23
    v_add_f32 v32, v32, v28
    v_add_f32 v32, v32, v29
    v_add_f32 v32, v32, v30
    v_add_f32 v32, v32, v31
    v_xor_b32 v33, 16, v1
    v_lshlrev_b32 v33, 2, v33
    ds_bpermute_b32 v34, v33, v32
    s_waitcnt lgkmcnt(0)
    v_add_f32 v32, v32, v34
    v_xor_b32 v33, 32, v1
    v_lshlrev_b32 v33, 2, v33
    ds_bpermute_b32 v34, v33, v32
    s_waitcnt lgkmcnt(0)
    v_add_f32 v32, v32, v34
    v_rcp_f32 v32, v32
    s_nop 0
    v_mul_f32 v12, v12, v32
    v_mul_f32 v13, v13, v32
    v_mul_f32 v14, v14, v32
    v_mul_f32 v15, v15, v32
    v_mul_f32 v20, v20, v32
    v_mul_f32 v21, v21, v32
    v_mul_f32 v22, v22, v32
    v_mul_f32 v23, v23, v32
    v_mul_f32 v28, v28, v32
    v_mul_f32 v29, v29, v32
    v_mul_f32 v30, v30, v32
    v_mul_f32 v31, v31, v32
    v_cvt_pk_bf16_f32 v88, v12, v13
    v_cvt_pk_bf16_f32 v89, v14, v15
    v_cvt_pk_bf16_f32 v90, v20, v21
    v_cvt_pk_bf16_f32 v91, v22, v23
    v_cvt_pk_bf16_f32 v92, v28, v29
    v_cvt_pk_bf16_f32 v93, v30, v31
    v_mov_b32 v94, 0
    v_mov_b32 v95, 0
    s_waitcnt vmcnt(0)
    v_mfma_f32_16x16x32_bf16 v[128:131], v[184:187], v[80:83], v[128:131]
    v_mfma_f32_16x16x32_bf16 v[128:131], v[188:191], v[84:87], v[128:131]
    v_mfma_f32_16x16x32_bf16 v[132:135], v[184:187], v[88:91], v[132:135]
    v_mfma_f32_16x16x32_bf16 v[132:135], v[188:191], v[92:95], v[132:135]
    v_mfma_f32_16x16x32_bf16 v[136:139], v[192:195], v[80:83], v[136:139]
    v_mfma_f32_16x16x32_bf16 v[136:139], v[196:199], v[84:87], v[136:139]
    v_mfma_f32_16x16x32_bf16 v[140:143], v[192:195], v[88:91], v[140:143]
    v_mfma_f32_16x16x32_bf16 v[140:143], v[196:199], v[92:95], v[140:143]
    v_mfma_f32_16x16x32_bf16 v[144:147], v[200:203], v[80:83], v[144:147]
    v_mfma_f32_16x16x32_bf16 v[144:147], v[204:207], v[84:87], v[144:147]
    v_mfma_f32_16x16x32_bf16 v[148:151], v[200:203], v[88:91], v[148:151]
    v_mfma_f32_16x16x32_bf16 v[148:151], v[204:207], v[92:95], v[148:151]
    v_mfma_f32_16x16x32_bf16 v[152:155], v[208:211], v[80:83], v[152:155]
    v_mfma_f32_16x16x32_bf16 v[152:155], v[212:215], v[84:87], v[152:155]
    v_mfma_f32_16x16x32_bf16 v[156:159], v[208:211], v[88:91], v[156:159]
    v_mfma_f32_16x16x32_bf16 v[156:159], v[212:215], v[92:95], v[156:159]
    v_mfma_f32_16x16x32_bf16 v[160:163], v[216:219], v[80:83], v[160:163]
    v_mfma_f32_16x16x32_bf16 v[160:163], v[220:223], v[84:87], v[160:163]
    v_mfma_f32_16x16x32_bf16 v[164:167], v[216:219], v[88:91], v[164:167]
    v_mfma_f32_16x16x32_bf16 v[164:167], v[220:223], v[92:95], v[164:167]
    v_mfma_f32_16x16x32_bf16 v[168:171], v[224:227], v[80:83], v[168:171]
    v_mfma_f32_16x16x32_bf16 v[168:171], v[228:231], v[84:87], v[168:171]
    v_mfma_f32_16x16x32_bf16 v[172:175], v[224:227], v[88:91], v[172:175]
    v_mfma_f32_16x16x32_bf16 v[172:175], v[228:231], v[92:95], v[172:175]
    v_mfma_f32_16x16x32_bf16 v[176:179], v[232:235], v[80:83], v[176:179]
    v_mfma_f32_16x16x32_bf16 v[176:179], v[236:239], v[84:87], v[176:179]
    v_mfma_f32_16x16x32_bf16 v[180:183], v[232:235], v[88:91], v[180:183]
    v_mfma_f32_16x16x32_bf16 v[180:183], v[236:239], v[92:95], v[180:183]
    v_mov_b32 v8, 0
    v_mov_b32 v9, 0
    v_mov_b32 v10, 0
    v_mov_b32 v11, 0
    v_mov_b32 v12, 0
    v_mov_b32 v13, 0
    v_mov_b32 v14, 0
    v_mov_b32 v15, 0
    v_mov_b32 v16, 0
    v_mov_b32 v17, 0
    v_mov_b32 v18, 0
    v_mov_b32 v19, 0
    v_mov_b32 v20, 0
    v_mov_b32 v21, 0
    v_mov_b32 v22, 0
    v_mov_b32 v23, 0
    v_mov_b32 v24, 0
    v_mov_b32 v25, 0
    v_mov_b32 v26, 0
    v_mov_b32 v27, 0
    v_mov_b32 v28, 0
    v_mov_b32 v29, 0
    v_mov_b32 v30, 0
    v_mov_b32 v31, 0
    s_mov_b32 s45, 896
    buffer_load_dwordx4 v[184:187], v41, s[16:19], s45 offen offset:0
    s_mov_b32 s45, 230272
    buffer_load_dwordx4 v[188:191], v41, s[16:19], s45 offen offset:0
    s_mov_b32 s45, 896
    buffer_load_dwordx4 v[192:195], v41, s[16:19], s45 offen offset:64
    s_mov_b32 s45, 230272
    buffer_load_dwordx4 v[196:199], v41, s[16:19], s45 offen offset:64
    s_mov_b32 s45, 896
    buffer_load_dwordx4 v[200:203], v41, s[16:19], s45 offen offset:128
    s_mov_b32 s45, 230272
    buffer_load_dwordx4 v[204:207], v41, s[16:19], s45 offen offset:128
    s_mov_b32 s45, 896
    buffer_load_dwordx4 v[208:211], v41, s[16:19], s45 offen offset:192
    s_mov_b32 s45, 230272
    buffer_load_dwordx4 v[212:215], v41, s[16:19], s45 offen offset:192
    s_mov_b32 s45, 896
    buffer_load_dwordx4 v[216:219], v41, s[16:19], s45 offen offset:256
    s_mov_b32 s45, 230272
    buffer_load_dwordx4 v[220:223], v41, s[16:19], s45 offen offset:256
    s_mov_b32 s45, 896
    buffer_load_dwordx4 v[224:227], v41, s[16:19], s45 offen offset:320
    s_mov_b32 s45, 230272
    buffer_load_dwordx4 v[228:231], v41, s[16:19], s45 offen offset:320
    s_mov_b32 s45, 896
    buffer_load_dwordx4 v[232:235], v41, s[16:19], s45 offen offset:384
    s_mov_b32 s45, 230272
    buffer_load_dwordx4 v[236:239], v41, s[16:19], s45 offen offset:384
    ds_read_b128 v[68:71], v40 offset:0
    ds_read_b128 v[72:75], v40 offset:14592
    ds_read_b128 v[76:79], v40 offset:29184
    s_waitcnt vmcnt(12) lgkmcnt(0)
    v_mfma_f32_16x16x32_bf16 v[8:11], v[68:71], v[184:187], v[8:11]
    v_mfma_f32_16x16x32_bf16 v[12:15], v[68:71], v[188:191], v[12:15]
    v_mfma_f32_16x16x32_bf16 v[16:19], v[72:75], v[184:187], v[16:19]
    v_mfma_f32_16x16x32_bf16 v[20:23], v[72:75], v[188:191], v[20:23]
    v_mfma_f32_16x16x32_bf16 v[24:27], v[76:79], v[184:187], v[24:27]
    v_mfma_f32_16x16x32_bf16 v[28:31], v[76:79], v[188:191], v[28:31]
    ds_read_b128 v[68:71], v40 offset:64
    ds_read_b128 v[72:75], v40 offset:14656
    ds_read_b128 v[76:79], v40 offset:29248
    s_waitcnt vmcnt(10) lgkmcnt(0)
    v_mfma_f32_16x16x32_bf16 v[8:11], v[68:71], v[192:195], v[8:11]
    v_mfma_f32_16x16x32_bf16 v[12:15], v[68:71], v[196:199], v[12:15]
    v_mfma_f32_16x16x32_bf16 v[16:19], v[72:75], v[192:195], v[16:19]
    v_mfma_f32_16x16x32_bf16 v[20:23], v[72:75], v[196:199], v[20:23]
    v_mfma_f32_16x16x32_bf16 v[24:27], v[76:79], v[192:195], v[24:27]
    v_mfma_f32_16x16x32_bf16 v[28:31], v[76:79], v[196:199], v[28:31]
    ds_read_b128 v[68:71], v40 offset:128
    ds_read_b128 v[72:75], v40 offset:14720
    ds_read_b128 v[76:79], v40 offset:29312
    s_waitcnt vmcnt(8) lgkmcnt(0)
    v_mfma_f32_16x16x32_bf16 v[8:11], v[68:71], v[200:203], v[8:11]
    v_mfma_f32_16x16x32_bf16 v[12:15], v[68:71], v[204:207], v[12:15]
    v_mfma_f32_16x16x32_bf16 v[16:19], v[72:75], v[200:203], v[16:19]
    v_mfma_f32_16x16x32_bf16 v[20:23], v[72:75], v[204:207], v[20:23]
    v_mfma_f32_16x16x32_bf16 v[24:27], v[76:79], v[200:203], v[24:27]
    v_mfma_f32_16x16x32_bf16 v[28:31], v[76:79], v[204:207], v[28:31]
    ds_read_b128 v[68:71], v40 offset:192
    ds_read_b128 v[72:75], v40 offset:14784
    ds_read_b128 v[76:79], v40 offset:29376
    s_waitcnt vmcnt(6) lgkmcnt(0)
    v_mfma_f32_16x16x32_bf16 v[8:11], v[68:71], v[208:211], v[8:11]
    v_mfma_f32_16x16x32_bf16 v[12:15], v[68:71], v[212:215], v[12:15]
    v_mfma_f32_16x16x32_bf16 v[16:19], v[72:75], v[208:211], v[16:19]
    v_mfma_f32_16x16x32_bf16 v[20:23], v[72:75], v[212:215], v[20:23]
    v_mfma_f32_16x16x32_bf16 v[24:27], v[76:79], v[208:211], v[24:27]
    v_mfma_f32_16x16x32_bf16 v[28:31], v[76:79], v[212:215], v[28:31]
    ds_read_b128 v[68:71], v40 offset:256
    ds_read_b128 v[72:75], v40 offset:14848
    ds_read_b128 v[76:79], v40 offset:29440
    s_waitcnt vmcnt(4) lgkmcnt(0)
    v_mfma_f32_16x16x32_bf16 v[8:11], v[68:71], v[216:219], v[8:11]
    v_mfma_f32_16x16x32_bf16 v[12:15], v[68:71], v[220:223], v[12:15]
    v_mfma_f32_16x16x32_bf16 v[16:19], v[72:75], v[216:219], v[16:19]
    v_mfma_f32_16x16x32_bf16 v[20:23], v[72:75], v[220:223], v[20:23]
    v_mfma_f32_16x16x32_bf16 v[24:27], v[76:79], v[216:219], v[24:27]
    v_mfma_f32_16x16x32_bf16 v[28:31], v[76:79], v[220:223], v[28:31]
    ds_read_b128 v[68:71], v40 offset:320
    ds_read_b128 v[72:75], v40 offset:14912
    ds_read_b128 v[76:79], v40 offset:29504
    s_waitcnt vmcnt(2) lgkmcnt(0)
    v_mfma_f32_16x16x32_bf16 v[8:11], v[68:71], v[224:227], v[8:11]
    v_mfma_f32_16x16x32_bf16 v[12:15], v[68:71], v[228:231], v[12:15]
    v_mfma_f32_16x16x32_bf16 v[16:19], v[72:75], v[224:227], v[16:19]
    v_mfma_f32_16x16x32_bf16 v[20:23], v[72:75], v[228:231], v[20:23]
    v_mfma_f32_16x16x32_bf16 v[24:27], v[76:79], v[224:227], v[24:27]
    v_mfma_f32_16x16x32_bf16 v[28:31], v[76:79], v[228:231], v[28:31]
    ds_read_b128 v[68:71], v40 offset:384
    ds_read_b128 v[72:75], v40 offset:14976
    ds_read_b128 v[76:79], v40 offset:29568
    s_waitcnt vmcnt(0) lgkmcnt(0)
    v_mfma_f32_16x16x32_bf16 v[8:11], v[68:71], v[232:235], v[8:11]
    v_mfma_f32_16x16x32_bf16 v[12:15], v[68:71], v[236:239], v[12:15]
    v_mfma_f32_16x16x32_bf16 v[16:19], v[72:75], v[232:235], v[16:19]
    v_mfma_f32_16x16x32_bf16 v[20:23], v[72:75], v[236:239], v[20:23]
    v_mfma_f32_16x16x32_bf16 v[24:27], v[76:79], v[232:235], v[24:27]
    v_mfma_f32_16x16x32_bf16 v[28:31], v[76:79], v[236:239], v[28:31]
    s_mov_b32 s45, 896
    buffer_load_dwordx4 v[184:187], v41, s[16:19], s45 offen offset:448
    s_mov_b32 s45, 230272
    buffer_load_dwordx4 v[188:191], v41, s[16:19], s45 offen offset:448
    s_mov_b32 s45, 896
    buffer_load_dwordx4 v[192:195], v41, s[16:19], s45 offen offset:512
    s_mov_b32 s45, 230272
    buffer_load_dwordx4 v[196:199], v41, s[16:19], s45 offen offset:512
    s_mov_b32 s45, 896
    buffer_load_dwordx4 v[200:203], v41, s[16:19], s45 offen offset:576
    s_mov_b32 s45, 230272
    buffer_load_dwordx4 v[204:207], v41, s[16:19], s45 offen offset:576
    s_mov_b32 s45, 896
    buffer_load_dwordx4 v[208:211], v41, s[16:19], s45 offen offset:640
    s_mov_b32 s45, 230272
    buffer_load_dwordx4 v[212:215], v41, s[16:19], s45 offen offset:640
    s_mov_b32 s45, 896
    buffer_load_dwordx4 v[216:219], v41, s[16:19], s45 offen offset:704
    s_mov_b32 s45, 230272
    buffer_load_dwordx4 v[220:223], v41, s[16:19], s45 offen offset:704
    s_mov_b32 s45, 896
    buffer_load_dwordx4 v[224:227], v41, s[16:19], s45 offen offset:768
    s_mov_b32 s45, 230272
    buffer_load_dwordx4 v[228:231], v41, s[16:19], s45 offen offset:768
    s_mov_b32 s45, 896
    buffer_load_dwordx4 v[232:235], v41, s[16:19], s45 offen offset:832
    s_mov_b32 s45, 230272
    buffer_load_dwordx4 v[236:239], v41, s[16:19], s45 offen offset:832
    ds_read_b128 v[68:71], v40 offset:448
    ds_read_b128 v[72:75], v40 offset:15040
    ds_read_b128 v[76:79], v40 offset:29632
    s_waitcnt vmcnt(12) lgkmcnt(0)
    v_mfma_f32_16x16x32_bf16 v[8:11], v[68:71], v[184:187], v[8:11]
    v_mfma_f32_16x16x32_bf16 v[12:15], v[68:71], v[188:191], v[12:15]
    v_mfma_f32_16x16x32_bf16 v[16:19], v[72:75], v[184:187], v[16:19]
    v_mfma_f32_16x16x32_bf16 v[20:23], v[72:75], v[188:191], v[20:23]
    v_mfma_f32_16x16x32_bf16 v[24:27], v[76:79], v[184:187], v[24:27]
    v_mfma_f32_16x16x32_bf16 v[28:31], v[76:79], v[188:191], v[28:31]
    ds_read_b128 v[68:71], v40 offset:512
    ds_read_b128 v[72:75], v40 offset:15104
    ds_read_b128 v[76:79], v40 offset:29696
    s_waitcnt vmcnt(10) lgkmcnt(0)
    v_mfma_f32_16x16x32_bf16 v[8:11], v[68:71], v[192:195], v[8:11]
    v_mfma_f32_16x16x32_bf16 v[12:15], v[68:71], v[196:199], v[12:15]
    v_mfma_f32_16x16x32_bf16 v[16:19], v[72:75], v[192:195], v[16:19]
    v_mfma_f32_16x16x32_bf16 v[20:23], v[72:75], v[196:199], v[20:23]
    v_mfma_f32_16x16x32_bf16 v[24:27], v[76:79], v[192:195], v[24:27]
    v_mfma_f32_16x16x32_bf16 v[28:31], v[76:79], v[196:199], v[28:31]
    ds_read_b128 v[68:71], v40 offset:576
    ds_read_b128 v[72:75], v40 offset:15168
    ds_read_b128 v[76:79], v40 offset:29760
    s_waitcnt vmcnt(8) lgkmcnt(0)
    v_mfma_f32_16x16x32_bf16 v[8:11], v[68:71], v[200:203], v[8:11]
    v_mfma_f32_16x16x32_bf16 v[12:15], v[68:71], v[204:207], v[12:15]
    v_mfma_f32_16x16x32_bf16 v[16:19], v[72:75], v[200:203], v[16:19]
    v_mfma_f32_16x16x32_bf16 v[20:23], v[72:75], v[204:207], v[20:23]
    v_mfma_f32_16x16x32_bf16 v[24:27], v[76:79], v[200:203], v[24:27]
    v_mfma_f32_16x16x32_bf16 v[28:31], v[76:79], v[204:207], v[28:31]
    ds_read_b128 v[68:71], v40 offset:640
    ds_read_b128 v[72:75], v40 offset:15232
    ds_read_b128 v[76:79], v40 offset:29824
    s_waitcnt vmcnt(6) lgkmcnt(0)
    v_mfma_f32_16x16x32_bf16 v[8:11], v[68:71], v[208:211], v[8:11]
    v_mfma_f32_16x16x32_bf16 v[12:15], v[68:71], v[212:215], v[12:15]
    v_mfma_f32_16x16x32_bf16 v[16:19], v[72:75], v[208:211], v[16:19]
    v_mfma_f32_16x16x32_bf16 v[20:23], v[72:75], v[212:215], v[20:23]
    v_mfma_f32_16x16x32_bf16 v[24:27], v[76:79], v[208:211], v[24:27]
    v_mfma_f32_16x16x32_bf16 v[28:31], v[76:79], v[212:215], v[28:31]
    ds_read_b128 v[68:71], v40 offset:704
    ds_read_b128 v[72:75], v40 offset:15296
    ds_read_b128 v[76:79], v40 offset:29888
    s_waitcnt vmcnt(4) lgkmcnt(0)
    v_mfma_f32_16x16x32_bf16 v[8:11], v[68:71], v[216:219], v[8:11]
    v_mfma_f32_16x16x32_bf16 v[12:15], v[68:71], v[220:223], v[12:15]
    v_mfma_f32_16x16x32_bf16 v[16:19], v[72:75], v[216:219], v[16:19]
    v_mfma_f32_16x16x32_bf16 v[20:23], v[72:75], v[220:223], v[20:23]
    v_mfma_f32_16x16x32_bf16 v[24:27], v[76:79], v[216:219], v[24:27]
    v_mfma_f32_16x16x32_bf16 v[28:31], v[76:79], v[220:223], v[28:31]
    ds_read_b128 v[68:71], v40 offset:768
    ds_read_b128 v[72:75], v40 offset:15360
    ds_read_b128 v[76:79], v40 offset:29952
    s_waitcnt vmcnt(2) lgkmcnt(0)
    v_mfma_f32_16x16x32_bf16 v[8:11], v[68:71], v[224:227], v[8:11]
    v_mfma_f32_16x16x32_bf16 v[12:15], v[68:71], v[228:231], v[12:15]
    v_mfma_f32_16x16x32_bf16 v[16:19], v[72:75], v[224:227], v[16:19]
    v_mfma_f32_16x16x32_bf16 v[20:23], v[72:75], v[228:231], v[20:23]
    v_mfma_f32_16x16x32_bf16 v[24:27], v[76:79], v[224:227], v[24:27]
    v_mfma_f32_16x16x32_bf16 v[28:31], v[76:79], v[228:231], v[28:31]
    ds_read_b128 v[68:71], v40 offset:832
    ds_read_b128 v[72:75], v40 offset:15424
    ds_read_b128 v[76:79], v40 offset:30016
    s_waitcnt vmcnt(0) lgkmcnt(0)
    v_mfma_f32_16x16x32_bf16 v[8:11], v[68:71], v[232:235], v[8:11]
    v_mfma_f32_16x16x32_bf16 v[12:15], v[68:71], v[236:239], v[12:15]
    v_mfma_f32_16x16x32_bf16 v[16:19], v[72:75], v[232:235], v[16:19]
    v_mfma_f32_16x16x32_bf16 v[20:23], v[72:75], v[236:239], v[20:23]
    v_mfma_f32_16x16x32_bf16 v[24:27], v[76:79], v[232:235], v[24:27]
    v_mfma_f32_16x16x32_bf16 v[28:31], v[76:79], v[236:239], v[28:31]
    s_mov_b32 s45, 1835008
    buffer_load_dwordx2 v[184:185], v42, s[20:23], s45 offen
    buffer_load_dwordx2 v[186:187], v42, s[20:23], s45 offen offset:32
    s_mov_b32 s45, 7168
    buffer_load_dwordx2 v[188:189], v43, s[28:31], s45 offen
    v_mov_b32 v190, 0
    v_mov_b32 v191, 0
    s_mov_b32 s45, 1900544
    buffer_load_dwordx2 v[192:193], v42, s[20:23], s45 offen
    buffer_load_dwordx2 v[194:195], v42, s[20:23], s45 offen offset:32
    s_mov_b32 s45, 7424
    buffer_load_dwordx2 v[196:197], v43, s[28:31], s45 offen
    v_mov_b32 v198, 0
    v_mov_b32 v199, 0
    s_mov_b32 s45, 1966080
    buffer_load_dwordx2 v[200:201], v42, s[20:23], s45 offen
    buffer_load_dwordx2 v[202:203], v42, s[20:23], s45 offen offset:32
    s_mov_b32 s45, 7680
    buffer_load_dwordx2 v[204:205], v43, s[28:31], s45 offen
    v_mov_b32 v206, 0
    v_mov_b32 v207, 0
    s_mov_b32 s45, 2031616
    buffer_load_dwordx2 v[208:209], v42, s[20:23], s45 offen
    buffer_load_dwordx2 v[210:211], v42, s[20:23], s45 offen offset:32
    s_mov_b32 s45, 7936
    buffer_load_dwordx2 v[212:213], v43, s[28:31], s45 offen
    v_mov_b32 v214, 0
    v_mov_b32 v215, 0
    s_mov_b32 s45, 2097152
    buffer_load_dwordx2 v[216:217], v42, s[20:23], s45 offen
    buffer_load_dwordx2 v[218:219], v42, s[20:23], s45 offen offset:32
    s_mov_b32 s45, 8192
    buffer_load_dwordx2 v[220:221], v43, s[28:31], s45 offen
    v_mov_b32 v222, 0
    v_mov_b32 v223, 0
    s_mov_b32 s45, 2162688
    buffer_load_dwordx2 v[224:225], v42, s[20:23], s45 offen
    buffer_load_dwordx2 v[226:227], v42, s[20:23], s45 offen offset:32
    s_mov_b32 s45, 8448
    buffer_load_dwordx2 v[228:229], v43, s[28:31], s45 offen
    v_mov_b32 v230, 0
    v_mov_b32 v231, 0
    s_mov_b32 s45, 2228224
    buffer_load_dwordx2 v[232:233], v42, s[20:23], s45 offen
    buffer_load_dwordx2 v[234:235], v42, s[20:23], s45 offen offset:32
    s_mov_b32 s45, 8704
    buffer_load_dwordx2 v[236:237], v43, s[28:31], s45 offen
    v_mov_b32 v238, 0
    v_mov_b32 v239, 0
    s_nop 7
    v_lshl_add_u32 v6, v4, 2, 0
    v_add_u32 v7, 0, v3
    v_cmp_le_u32 vcc, v6, v7
    s_nop 1
    v_cndmask_b32 v8, v118, v8, vcc
    v_lshl_add_u32 v6, v4, 2, 1
    v_add_u32 v7, 0, v3
    v_cmp_le_u32 vcc, v6, v7
    s_nop 1
    v_cndmask_b32 v9, v118, v9, vcc
    v_lshl_add_u32 v6, v4, 2, 2
    v_add_u32 v7, 0, v3
    v_cmp_le_u32 vcc, v6, v7
    s_nop 1
    v_cndmask_b32 v10, v118, v10, vcc
    v_lshl_add_u32 v6, v4, 2, 3
    v_add_u32 v7, 0, v3
    v_cmp_le_u32 vcc, v6, v7
    s_nop 1
    v_cndmask_b32 v11, v118, v11, vcc
    v_lshl_add_u32 v6, v4, 2, 16
    v_add_u32 v7, 0, v3
    v_cmp_le_u32 vcc, v6, v7
    s_nop 1
    v_cndmask_b32 v16, v118, v16, vcc
    v_lshl_add_u32 v6, v4, 2, 17
    v_add_u32 v7, 0, v3
    v_cmp_le_u32 vcc, v6, v7
    s_nop 1
    v_cndmask_b32 v17, v118, v17, vcc
    v_lshl_add_u32 v6, v4, 2, 18
    v_add_u32 v7, 0, v3
    v_cmp_le_u32 vcc, v6, v7
    s_nop 1
    v_cndmask_b32 v18, v118, v18, vcc
    v_lshl_add_u32 v6, v4, 2, 19
    v_add_u32 v7, 0, v3
    v_cmp_le_u32 vcc, v6, v7
    s_nop 1
    v_cndmask_b32 v19, v118, v19, vcc
    v_cmp_gt_u32 vcc, 2, v4
    s_nop 1
    v_cndmask_b32 v24, v118, v24, vcc
    v_cmp_gt_u32 vcc, 2, v4
    s_nop 1
    v_cndmask_b32 v25, v118, v25, vcc
    v_cmp_gt_u32 vcc, 2, v4
    s_nop 1
    v_cndmask_b32 v26, v118, v26, vcc
    v_cmp_gt_u32 vcc, 2, v4
    s_nop 1
    v_cndmask_b32 v27, v118, v27, vcc
    v_max_f32 v32, v8, v9
    v_max_f32 v32, v32, v10
    v_max_f32 v32, v32, v11
    v_max_f32 v32, v32, v16
    v_max_f32 v32, v32, v17
    v_max_f32 v32, v32, v18
    v_max_f32 v32, v32, v19
    v_max_f32 v32, v32, v24
    v_max_f32 v32, v32, v25
    v_max_f32 v32, v32, v26
    v_max_f32 v32, v32, v27
    v_xor_b32 v33, 16, v1
    v_lshlrev_b32 v33, 2, v33
    ds_bpermute_b32 v34, v33, v32
    s_waitcnt lgkmcnt(0)
    v_max_f32 v32, v32, v34
    v_xor_b32 v33, 32, v1
    v_lshlrev_b32 v33, 2, v33
    ds_bpermute_b32 v34, v33, v32
    s_waitcnt lgkmcnt(0)
    v_max_f32 v32, v32, v34
    v_sub_f32 v8, v8, v32
    v_mul_f32 v8, 0x3fb8aa3b, v8
    v_exp_f32 v8, v8
    v_sub_f32 v9, v9, v32
    v_mul_f32 v9, 0x3fb8aa3b, v9
    v_exp_f32 v9, v9
    v_sub_f32 v10, v10, v32
    v_mul_f32 v10, 0x3fb8aa3b, v10
    v_exp_f32 v10, v10
    v_sub_f32 v11, v11, v32
    v_mul_f32 v11, 0x3fb8aa3b, v11
    v_exp_f32 v11, v11
    v_sub_f32 v16, v16, v32
    v_mul_f32 v16, 0x3fb8aa3b, v16
    v_exp_f32 v16, v16
    v_sub_f32 v17, v17, v32
    v_mul_f32 v17, 0x3fb8aa3b, v17
    v_exp_f32 v17, v17
    v_sub_f32 v18, v18, v32
    v_mul_f32 v18, 0x3fb8aa3b, v18
    v_exp_f32 v18, v18
    v_sub_f32 v19, v19, v32
    v_mul_f32 v19, 0x3fb8aa3b, v19
    v_exp_f32 v19, v19
    v_sub_f32 v24, v24, v32
    v_mul_f32 v24, 0x3fb8aa3b, v24
    v_exp_f32 v24, v24
    v_sub_f32 v25, v25, v32
    v_mul_f32 v25, 0x3fb8aa3b, v25
    v_exp_f32 v25, v25
    v_sub_f32 v26, v26, v32
    v_mul_f32 v26, 0x3fb8aa3b, v26
    v_exp_f32 v26, v26
    v_sub_f32 v27, v27, v32
    v_mul_f32 v27, 0x3fb8aa3b, v27
    v_exp_f32 v27, v27
    s_nop 0
    v_add_f32 v32, v8, v9
    v_add_f32 v32, v32, v10
    v_add_f32 v32, v32, v11
    v_add_f32 v32, v32, v16
    v_add_f32 v32, v32, v17
    v_add_f32 v32, v32, v18
    v_add_f32 v32, v32, v19
    v_add_f32 v32, v32, v24
    v_add_f32 v32, v32, v25
    v_add_f32 v32, v32, v26
    v_add_f32 v32, v32, v27
    v_xor_b32 v33, 16, v1
    v_lshlrev_b32 v33, 2, v33
    ds_bpermute_b32 v34, v33, v32
    s_waitcnt lgkmcnt(0)
    v_add_f32 v32, v32, v34
    v_xor_b32 v33, 32, v1
    v_lshlrev_b32 v33, 2, v33
    ds_bpermute_b32 v34, v33, v32
    s_waitcnt lgkmcnt(0)
    v_add_f32 v32, v32, v34
    v_rcp_f32 v32, v32
    s_nop 0
    v_mul_f32 v8, v8, v32
    v_mul_f32 v9, v9, v32
    v_mul_f32 v10, v10, v32
    v_mul_f32 v11, v11, v32
    v_mul_f32 v16, v16, v32
    v_mul_f32 v17, v17, v32
    v_mul_f32 v18, v18, v32
    v_mul_f32 v19, v19, v32
    v_mul_f32 v24, v24, v32
    v_mul_f32 v25, v25, v32
    v_mul_f32 v26, v26, v32
    v_mul_f32 v27, v27, v32
    v_cvt_pk_bf16_f32 v80, v8, v9
    v_cvt_pk_bf16_f32 v81, v10, v11
    v_cvt_pk_bf16_f32 v82, v16, v17
    v_cvt_pk_bf16_f32 v83, v18, v19
    v_cvt_pk_bf16_f32 v84, v24, v25
    v_cvt_pk_bf16_f32 v85, v26, v27
    v_mov_b32 v86, 0
    v_mov_b32 v87, 0
    v_lshl_add_u32 v6, v4, 2, 0
    v_add_u32 v7, 16, v3
    v_cmp_le_u32 vcc, v6, v7
    s_nop 1
    v_cndmask_b32 v12, v118, v12, vcc
    v_lshl_add_u32 v6, v4, 2, 1
    v_add_u32 v7, 16, v3
    v_cmp_le_u32 vcc, v6, v7
    s_nop 1
    v_cndmask_b32 v13, v118, v13, vcc
    v_lshl_add_u32 v6, v4, 2, 2
    v_add_u32 v7, 16, v3
    v_cmp_le_u32 vcc, v6, v7
    s_nop 1
    v_cndmask_b32 v14, v118, v14, vcc
    v_lshl_add_u32 v6, v4, 2, 3
    v_add_u32 v7, 16, v3
    v_cmp_le_u32 vcc, v6, v7
    s_nop 1
    v_cndmask_b32 v15, v118, v15, vcc
    v_lshl_add_u32 v6, v4, 2, 16
    v_add_u32 v7, 16, v3
    v_cmp_le_u32 vcc, v6, v7
    s_nop 1
    v_cndmask_b32 v20, v118, v20, vcc
    v_lshl_add_u32 v6, v4, 2, 17
    v_add_u32 v7, 16, v3
    v_cmp_le_u32 vcc, v6, v7
    s_nop 1
    v_cndmask_b32 v21, v118, v21, vcc
    v_lshl_add_u32 v6, v4, 2, 18
    v_add_u32 v7, 16, v3
    v_cmp_le_u32 vcc, v6, v7
    s_nop 1
    v_cndmask_b32 v22, v118, v22, vcc
    v_lshl_add_u32 v6, v4, 2, 19
    v_add_u32 v7, 16, v3
    v_cmp_le_u32 vcc, v6, v7
    s_nop 1
    v_cndmask_b32 v23, v118, v23, vcc
    v_cmp_gt_u32 vcc, 2, v4
    s_nop 1
    v_cndmask_b32 v28, v118, v28, vcc
    v_cmp_gt_u32 vcc, 2, v4
    s_nop 1
    v_cndmask_b32 v29, v118, v29, vcc
    v_cmp_gt_u32 vcc, 2, v4
    s_nop 1
    v_cndmask_b32 v30, v118, v30, vcc
    v_cmp_gt_u32 vcc, 2, v4
    s_nop 1
    v_cndmask_b32 v31, v118, v31, vcc
    v_max_f32 v32, v12, v13
    v_max_f32 v32, v32, v14
    v_max_f32 v32, v32, v15
    v_max_f32 v32, v32, v20
    v_max_f32 v32, v32, v21
    v_max_f32 v32, v32, v22
    v_max_f32 v32, v32, v23
    v_max_f32 v32, v32, v28
    v_max_f32 v32, v32, v29
    v_max_f32 v32, v32, v30
    v_max_f32 v32, v32, v31
    v_xor_b32 v33, 16, v1
    v_lshlrev_b32 v33, 2, v33
    ds_bpermute_b32 v34, v33, v32
    s_waitcnt lgkmcnt(0)
    v_max_f32 v32, v32, v34
    v_xor_b32 v33, 32, v1
    v_lshlrev_b32 v33, 2, v33
    ds_bpermute_b32 v34, v33, v32
    s_waitcnt lgkmcnt(0)
    v_max_f32 v32, v32, v34
    v_sub_f32 v12, v12, v32
    v_mul_f32 v12, 0x3fb8aa3b, v12
    v_exp_f32 v12, v12
    v_sub_f32 v13, v13, v32
    v_mul_f32 v13, 0x3fb8aa3b, v13
    v_exp_f32 v13, v13
    v_sub_f32 v14, v14, v32
    v_mul_f32 v14, 0x3fb8aa3b, v14
    v_exp_f32 v14, v14
    v_sub_f32 v15, v15, v32
    v_mul_f32 v15, 0x3fb8aa3b, v15
    v_exp_f32 v15, v15
    v_sub_f32 v20, v20, v32
    v_mul_f32 v20, 0x3fb8aa3b, v20
    v_exp_f32 v20, v20
    v_sub_f32 v21, v21, v32
    v_mul_f32 v21, 0x3fb8aa3b, v21
    v_exp_f32 v21, v21
    v_sub_f32 v22, v22, v32
    v_mul_f32 v22, 0x3fb8aa3b, v22
    v_exp_f32 v22, v22
    v_sub_f32 v23, v23, v32
    v_mul_f32 v23, 0x3fb8aa3b, v23
    v_exp_f32 v23, v23
    v_sub_f32 v28, v28, v32
    v_mul_f32 v28, 0x3fb8aa3b, v28
    v_exp_f32 v28, v28
    v_sub_f32 v29, v29, v32
    v_mul_f32 v29, 0x3fb8aa3b, v29
    v_exp_f32 v29, v29
    v_sub_f32 v30, v30, v32
    v_mul_f32 v30, 0x3fb8aa3b, v30
    v_exp_f32 v30, v30
    v_sub_f32 v31, v31, v32
    v_mul_f32 v31, 0x3fb8aa3b, v31
    v_exp_f32 v31, v31
    s_nop 0
    v_add_f32 v32, v12, v13
    v_add_f32 v32, v32, v14
    v_add_f32 v32, v32, v15
    v_add_f32 v32, v32, v20
    v_add_f32 v32, v32, v21
    v_add_f32 v32, v32, v22
    v_add_f32 v32, v32, v23
    v_add_f32 v32, v32, v28
    v_add_f32 v32, v32, v29
    v_add_f32 v32, v32, v30
    v_add_f32 v32, v32, v31
    v_xor_b32 v33, 16, v1
    v_lshlrev_b32 v33, 2, v33
    ds_bpermute_b32 v34, v33, v32
    s_waitcnt lgkmcnt(0)
    v_add_f32 v32, v32, v34
    v_xor_b32 v33, 32, v1
    v_lshlrev_b32 v33, 2, v33
    ds_bpermute_b32 v34, v33, v32
    s_waitcnt lgkmcnt(0)
    v_add_f32 v32, v32, v34
    v_rcp_f32 v32, v32
    s_nop 0
    v_mul_f32 v12, v12, v32
    v_mul_f32 v13, v13, v32
    v_mul_f32 v14, v14, v32
    v_mul_f32 v15, v15, v32
    v_mul_f32 v20, v20, v32
    v_mul_f32 v21, v21, v32
    v_mul_f32 v22, v22, v32
    v_mul_f32 v23, v23, v32
    v_mul_f32 v28, v28, v32
    v_mul_f32 v29, v29, v32
    v_mul_f32 v30, v30, v32
    v_mul_f32 v31, v31, v32
    v_cvt_pk_bf16_f32 v88, v12, v13
    v_cvt_pk_bf16_f32 v89, v14, v15
    v_cvt_pk_bf16_f32 v90, v20, v21
    v_cvt_pk_bf16_f32 v91, v22, v23
    v_cvt_pk_bf16_f32 v92, v28, v29
    v_cvt_pk_bf16_f32 v93, v30, v31
    v_mov_b32 v94, 0
    v_mov_b32 v95, 0
    s_waitcnt vmcnt(0)
    v_mfma_f32_16x16x32_bf16 v[128:131], v[184:187], v[80:83], v[128:131]
    v_mfma_f32_16x16x32_bf16 v[128:131], v[188:191], v[84:87], v[128:131]
    v_mfma_f32_16x16x32_bf16 v[132:135], v[184:187], v[88:91], v[132:135]
    v_mfma_f32_16x16x32_bf16 v[132:135], v[188:191], v[92:95], v[132:135]
    v_mfma_f32_16x16x32_bf16 v[136:139], v[192:195], v[80:83], v[136:139]
    v_mfma_f32_16x16x32_bf16 v[136:139], v[196:199], v[84:87], v[136:139]
    v_mfma_f32_16x16x32_bf16 v[140:143], v[192:195], v[88:91], v[140:143]
    v_mfma_f32_16x16x32_bf16 v[140:143], v[196:199], v[92:95], v[140:143]
    v_mfma_f32_16x16x32_bf16 v[144:147], v[200:203], v[80:83], v[144:147]
    v_mfma_f32_16x16x32_bf16 v[144:147], v[204:207], v[84:87], v[144:147]
    v_mfma_f32_16x16x32_bf16 v[148:151], v[200:203], v[88:91], v[148:151]
    v_mfma_f32_16x16x32_bf16 v[148:151], v[204:207], v[92:95], v[148:151]
    v_mfma_f32_16x16x32_bf16 v[152:155], v[208:211], v[80:83], v[152:155]
    v_mfma_f32_16x16x32_bf16 v[152:155], v[212:215], v[84:87], v[152:155]
    v_mfma_f32_16x16x32_bf16 v[156:159], v[208:211], v[88:91], v[156:159]
    v_mfma_f32_16x16x32_bf16 v[156:159], v[212:215], v[92:95], v[156:159]
    v_mfma_f32_16x16x32_bf16 v[160:163], v[216:219], v[80:83], v[160:163]
    v_mfma_f32_16x16x32_bf16 v[160:163], v[220:223], v[84:87], v[160:163]
    v_mfma_f32_16x16x32_bf16 v[164:167], v[216:219], v[88:91], v[164:167]
    v_mfma_f32_16x16x32_bf16 v[164:167], v[220:223], v[92:95], v[164:167]
    v_mfma_f32_16x16x32_bf16 v[168:171], v[224:227], v[80:83], v[168:171]
    v_mfma_f32_16x16x32_bf16 v[168:171], v[228:231], v[84:87], v[168:171]
    v_mfma_f32_16x16x32_bf16 v[172:175], v[224:227], v[88:91], v[172:175]
    v_mfma_f32_16x16x32_bf16 v[172:175], v[228:231], v[92:95], v[172:175]
    v_mfma_f32_16x16x32_bf16 v[176:179], v[232:235], v[80:83], v[176:179]
    v_mfma_f32_16x16x32_bf16 v[176:179], v[236:239], v[84:87], v[176:179]
    v_mfma_f32_16x16x32_bf16 v[180:183], v[232:235], v[88:91], v[180:183]
    v_mfma_f32_16x16x32_bf16 v[180:183], v[236:239], v[92:95], v[180:183]
    v_mov_b32 v8, 0
    v_mov_b32 v9, 0
    v_mov_b32 v10, 0
    v_mov_b32 v11, 0
    v_mov_b32 v12, 0
    v_mov_b32 v13, 0
    v_mov_b32 v14, 0
    v_mov_b32 v15, 0
    v_mov_b32 v16, 0
    v_mov_b32 v17, 0
    v_mov_b32 v18, 0
    v_mov_b32 v19, 0
    v_mov_b32 v20, 0
    v_mov_b32 v21, 0
    v_mov_b32 v22, 0
    v_mov_b32 v23, 0
    v_mov_b32 v24, 0
    v_mov_b32 v25, 0
    v_mov_b32 v26, 0
    v_mov_b32 v27, 0
    v_mov_b32 v28, 0
    v_mov_b32 v29, 0
    v_mov_b32 v30, 0
    v_mov_b32 v31, 0
    s_mov_b32 s45, 1792
    buffer_load_dwordx4 v[184:187], v41, s[16:19], s45 offen offset:0
    s_mov_b32 s45, 231168
    buffer_load_dwordx4 v[188:191], v41, s[16:19], s45 offen offset:0
    s_mov_b32 s45, 1792
    buffer_load_dwordx4 v[192:195], v41, s[16:19], s45 offen offset:64
    s_mov_b32 s45, 231168
    buffer_load_dwordx4 v[196:199], v41, s[16:19], s45 offen offset:64
    s_mov_b32 s45, 1792
    buffer_load_dwordx4 v[200:203], v41, s[16:19], s45 offen offset:128
    s_mov_b32 s45, 231168
    buffer_load_dwordx4 v[204:207], v41, s[16:19], s45 offen offset:128
    s_mov_b32 s45, 1792
    buffer_load_dwordx4 v[208:211], v41, s[16:19], s45 offen offset:192
    s_mov_b32 s45, 231168
    buffer_load_dwordx4 v[212:215], v41, s[16:19], s45 offen offset:192
    s_mov_b32 s45, 1792
    buffer_load_dwordx4 v[216:219], v41, s[16:19], s45 offen offset:256
    s_mov_b32 s45, 231168
    buffer_load_dwordx4 v[220:223], v41, s[16:19], s45 offen offset:256
    s_mov_b32 s45, 1792
    buffer_load_dwordx4 v[224:227], v41, s[16:19], s45 offen offset:320
    s_mov_b32 s45, 231168
    buffer_load_dwordx4 v[228:231], v41, s[16:19], s45 offen offset:320
    s_mov_b32 s45, 1792
    buffer_load_dwordx4 v[232:235], v41, s[16:19], s45 offen offset:384
    s_mov_b32 s45, 231168
    buffer_load_dwordx4 v[236:239], v41, s[16:19], s45 offen offset:384
    ds_read_b128 v[68:71], v40 offset:0
    ds_read_b128 v[72:75], v40 offset:14592
    ds_read_b128 v[76:79], v40 offset:29184
    s_waitcnt vmcnt(12) lgkmcnt(0)
    v_mfma_f32_16x16x32_bf16 v[8:11], v[68:71], v[184:187], v[8:11]
    v_mfma_f32_16x16x32_bf16 v[12:15], v[68:71], v[188:191], v[12:15]
    v_mfma_f32_16x16x32_bf16 v[16:19], v[72:75], v[184:187], v[16:19]
    v_mfma_f32_16x16x32_bf16 v[20:23], v[72:75], v[188:191], v[20:23]
    v_mfma_f32_16x16x32_bf16 v[24:27], v[76:79], v[184:187], v[24:27]
    v_mfma_f32_16x16x32_bf16 v[28:31], v[76:79], v[188:191], v[28:31]
    ds_read_b128 v[68:71], v40 offset:64
    ds_read_b128 v[72:75], v40 offset:14656
    ds_read_b128 v[76:79], v40 offset:29248
    s_waitcnt vmcnt(10) lgkmcnt(0)
    v_mfma_f32_16x16x32_bf16 v[8:11], v[68:71], v[192:195], v[8:11]
    v_mfma_f32_16x16x32_bf16 v[12:15], v[68:71], v[196:199], v[12:15]
    v_mfma_f32_16x16x32_bf16 v[16:19], v[72:75], v[192:195], v[16:19]
    v_mfma_f32_16x16x32_bf16 v[20:23], v[72:75], v[196:199], v[20:23]
    v_mfma_f32_16x16x32_bf16 v[24:27], v[76:79], v[192:195], v[24:27]
    v_mfma_f32_16x16x32_bf16 v[28:31], v[76:79], v[196:199], v[28:31]
    ds_read_b128 v[68:71], v40 offset:128
    ds_read_b128 v[72:75], v40 offset:14720
    ds_read_b128 v[76:79], v40 offset:29312
    s_waitcnt vmcnt(8) lgkmcnt(0)
    v_mfma_f32_16x16x32_bf16 v[8:11], v[68:71], v[200:203], v[8:11]
    v_mfma_f32_16x16x32_bf16 v[12:15], v[68:71], v[204:207], v[12:15]
    v_mfma_f32_16x16x32_bf16 v[16:19], v[72:75], v[200:203], v[16:19]
    v_mfma_f32_16x16x32_bf16 v[20:23], v[72:75], v[204:207], v[20:23]
    v_mfma_f32_16x16x32_bf16 v[24:27], v[76:79], v[200:203], v[24:27]
    v_mfma_f32_16x16x32_bf16 v[28:31], v[76:79], v[204:207], v[28:31]
    ds_read_b128 v[68:71], v40 offset:192
    ds_read_b128 v[72:75], v40 offset:14784
    ds_read_b128 v[76:79], v40 offset:29376
    s_waitcnt vmcnt(6) lgkmcnt(0)
    v_mfma_f32_16x16x32_bf16 v[8:11], v[68:71], v[208:211], v[8:11]
    v_mfma_f32_16x16x32_bf16 v[12:15], v[68:71], v[212:215], v[12:15]
    v_mfma_f32_16x16x32_bf16 v[16:19], v[72:75], v[208:211], v[16:19]
    v_mfma_f32_16x16x32_bf16 v[20:23], v[72:75], v[212:215], v[20:23]
    v_mfma_f32_16x16x32_bf16 v[24:27], v[76:79], v[208:211], v[24:27]
    v_mfma_f32_16x16x32_bf16 v[28:31], v[76:79], v[212:215], v[28:31]
    ds_read_b128 v[68:71], v40 offset:256
    ds_read_b128 v[72:75], v40 offset:14848
    ds_read_b128 v[76:79], v40 offset:29440
    s_waitcnt vmcnt(4) lgkmcnt(0)
    v_mfma_f32_16x16x32_bf16 v[8:11], v[68:71], v[216:219], v[8:11]
    v_mfma_f32_16x16x32_bf16 v[12:15], v[68:71], v[220:223], v[12:15]
    v_mfma_f32_16x16x32_bf16 v[16:19], v[72:75], v[216:219], v[16:19]
    v_mfma_f32_16x16x32_bf16 v[20:23], v[72:75], v[220:223], v[20:23]
    v_mfma_f32_16x16x32_bf16 v[24:27], v[76:79], v[216:219], v[24:27]
    v_mfma_f32_16x16x32_bf16 v[28:31], v[76:79], v[220:223], v[28:31]
    ds_read_b128 v[68:71], v40 offset:320
    ds_read_b128 v[72:75], v40 offset:14912
    ds_read_b128 v[76:79], v40 offset:29504
    s_waitcnt vmcnt(2) lgkmcnt(0)
    v_mfma_f32_16x16x32_bf16 v[8:11], v[68:71], v[224:227], v[8:11]
    v_mfma_f32_16x16x32_bf16 v[12:15], v[68:71], v[228:231], v[12:15]
    v_mfma_f32_16x16x32_bf16 v[16:19], v[72:75], v[224:227], v[16:19]
    v_mfma_f32_16x16x32_bf16 v[20:23], v[72:75], v[228:231], v[20:23]
    v_mfma_f32_16x16x32_bf16 v[24:27], v[76:79], v[224:227], v[24:27]
    v_mfma_f32_16x16x32_bf16 v[28:31], v[76:79], v[228:231], v[28:31]
    ds_read_b128 v[68:71], v40 offset:384
    ds_read_b128 v[72:75], v40 offset:14976
    ds_read_b128 v[76:79], v40 offset:29568
    s_waitcnt vmcnt(0) lgkmcnt(0)
    v_mfma_f32_16x16x32_bf16 v[8:11], v[68:71], v[232:235], v[8:11]
    v_mfma_f32_16x16x32_bf16 v[12:15], v[68:71], v[236:239], v[12:15]
    v_mfma_f32_16x16x32_bf16 v[16:19], v[72:75], v[232:235], v[16:19]
    v_mfma_f32_16x16x32_bf16 v[20:23], v[72:75], v[236:239], v[20:23]
    v_mfma_f32_16x16x32_bf16 v[24:27], v[76:79], v[232:235], v[24:27]
    v_mfma_f32_16x16x32_bf16 v[28:31], v[76:79], v[236:239], v[28:31]
    s_mov_b32 s45, 1792
    buffer_load_dwordx4 v[184:187], v41, s[16:19], s45 offen offset:448
    s_mov_b32 s45, 231168
    buffer_load_dwordx4 v[188:191], v41, s[16:19], s45 offen offset:448
    s_mov_b32 s45, 1792
    buffer_load_dwordx4 v[192:195], v41, s[16:19], s45 offen offset:512
    s_mov_b32 s45, 231168
    buffer_load_dwordx4 v[196:199], v41, s[16:19], s45 offen offset:512
    s_mov_b32 s45, 1792
    buffer_load_dwordx4 v[200:203], v41, s[16:19], s45 offen offset:576
    s_mov_b32 s45, 231168
    buffer_load_dwordx4 v[204:207], v41, s[16:19], s45 offen offset:576
    s_mov_b32 s45, 1792
    buffer_load_dwordx4 v[208:211], v41, s[16:19], s45 offen offset:640
    s_mov_b32 s45, 231168
    buffer_load_dwordx4 v[212:215], v41, s[16:19], s45 offen offset:640
    s_mov_b32 s45, 1792
    buffer_load_dwordx4 v[216:219], v41, s[16:19], s45 offen offset:704
    s_mov_b32 s45, 231168
    buffer_load_dwordx4 v[220:223], v41, s[16:19], s45 offen offset:704
    s_mov_b32 s45, 1792
    buffer_load_dwordx4 v[224:227], v41, s[16:19], s45 offen offset:768
    s_mov_b32 s45, 231168
    buffer_load_dwordx4 v[228:231], v41, s[16:19], s45 offen offset:768
    s_mov_b32 s45, 1792
    buffer_load_dwordx4 v[232:235], v41, s[16:19], s45 offen offset:832
    s_mov_b32 s45, 231168
    buffer_load_dwordx4 v[236:239], v41, s[16:19], s45 offen offset:832
    ds_read_b128 v[68:71], v40 offset:448
    ds_read_b128 v[72:75], v40 offset:15040
    ds_read_b128 v[76:79], v40 offset:29632
    s_waitcnt vmcnt(12) lgkmcnt(0)
    v_mfma_f32_16x16x32_bf16 v[8:11], v[68:71], v[184:187], v[8:11]
    v_mfma_f32_16x16x32_bf16 v[12:15], v[68:71], v[188:191], v[12:15]
    v_mfma_f32_16x16x32_bf16 v[16:19], v[72:75], v[184:187], v[16:19]
    v_mfma_f32_16x16x32_bf16 v[20:23], v[72:75], v[188:191], v[20:23]
    v_mfma_f32_16x16x32_bf16 v[24:27], v[76:79], v[184:187], v[24:27]
    v_mfma_f32_16x16x32_bf16 v[28:31], v[76:79], v[188:191], v[28:31]
    ds_read_b128 v[68:71], v40 offset:512
    ds_read_b128 v[72:75], v40 offset:15104
    ds_read_b128 v[76:79], v40 offset:29696
    s_waitcnt vmcnt(10) lgkmcnt(0)
    v_mfma_f32_16x16x32_bf16 v[8:11], v[68:71], v[192:195], v[8:11]
    v_mfma_f32_16x16x32_bf16 v[12:15], v[68:71], v[196:199], v[12:15]
    v_mfma_f32_16x16x32_bf16 v[16:19], v[72:75], v[192:195], v[16:19]
    v_mfma_f32_16x16x32_bf16 v[20:23], v[72:75], v[196:199], v[20:23]
    v_mfma_f32_16x16x32_bf16 v[24:27], v[76:79], v[192:195], v[24:27]
    v_mfma_f32_16x16x32_bf16 v[28:31], v[76:79], v[196:199], v[28:31]
    ds_read_b128 v[68:71], v40 offset:576
    ds_read_b128 v[72:75], v40 offset:15168
    ds_read_b128 v[76:79], v40 offset:29760
    s_waitcnt vmcnt(8) lgkmcnt(0)
    v_mfma_f32_16x16x32_bf16 v[8:11], v[68:71], v[200:203], v[8:11]
    v_mfma_f32_16x16x32_bf16 v[12:15], v[68:71], v[204:207], v[12:15]
    v_mfma_f32_16x16x32_bf16 v[16:19], v[72:75], v[200:203], v[16:19]
    v_mfma_f32_16x16x32_bf16 v[20:23], v[72:75], v[204:207], v[20:23]
    v_mfma_f32_16x16x32_bf16 v[24:27], v[76:79], v[200:203], v[24:27]
    v_mfma_f32_16x16x32_bf16 v[28:31], v[76:79], v[204:207], v[28:31]
    ds_read_b128 v[68:71], v40 offset:640
    ds_read_b128 v[72:75], v40 offset:15232
    ds_read_b128 v[76:79], v40 offset:29824
    s_waitcnt vmcnt(6) lgkmcnt(0)
    v_mfma_f32_16x16x32_bf16 v[8:11], v[68:71], v[208:211], v[8:11]
    v_mfma_f32_16x16x32_bf16 v[12:15], v[68:71], v[212:215], v[12:15]
    v_mfma_f32_16x16x32_bf16 v[16:19], v[72:75], v[208:211], v[16:19]
    v_mfma_f32_16x16x32_bf16 v[20:23], v[72:75], v[212:215], v[20:23]
    v_mfma_f32_16x16x32_bf16 v[24:27], v[76:79], v[208:211], v[24:27]
    v_mfma_f32_16x16x32_bf16 v[28:31], v[76:79], v[212:215], v[28:31]
    ds_read_b128 v[68:71], v40 offset:704
    ds_read_b128 v[72:75], v40 offset:15296
    ds_read_b128 v[76:79], v40 offset:29888
    s_waitcnt vmcnt(4) lgkmcnt(0)
    v_mfma_f32_16x16x32_bf16 v[8:11], v[68:71], v[216:219], v[8:11]
    v_mfma_f32_16x16x32_bf16 v[12:15], v[68:71], v[220:223], v[12:15]
    v_mfma_f32_16x16x32_bf16 v[16:19], v[72:75], v[216:219], v[16:19]
    v_mfma_f32_16x16x32_bf16 v[20:23], v[72:75], v[220:223], v[20:23]
    v_mfma_f32_16x16x32_bf16 v[24:27], v[76:79], v[216:219], v[24:27]
    v_mfma_f32_16x16x32_bf16 v[28:31], v[76:79], v[220:223], v[28:31]
    ds_read_b128 v[68:71], v40 offset:768
    ds_read_b128 v[72:75], v40 offset:15360
    ds_read_b128 v[76:79], v40 offset:29952
    s_waitcnt vmcnt(2) lgkmcnt(0)
    v_mfma_f32_16x16x32_bf16 v[8:11], v[68:71], v[224:227], v[8:11]
    v_mfma_f32_16x16x32_bf16 v[12:15], v[68:71], v[228:231], v[12:15]
    v_mfma_f32_16x16x32_bf16 v[16:19], v[72:75], v[224:227], v[16:19]
    v_mfma_f32_16x16x32_bf16 v[20:23], v[72:75], v[228:231], v[20:23]
    v_mfma_f32_16x16x32_bf16 v[24:27], v[76:79], v[224:227], v[24:27]
    v_mfma_f32_16x16x32_bf16 v[28:31], v[76:79], v[228:231], v[28:31]
    ds_read_b128 v[68:71], v40 offset:832
    ds_read_b128 v[72:75], v40 offset:15424
    ds_read_b128 v[76:79], v40 offset:30016
    s_waitcnt vmcnt(0) lgkmcnt(0)
    v_mfma_f32_16x16x32_bf16 v[8:11], v[68:71], v[232:235], v[8:11]
    v_mfma_f32_16x16x32_bf16 v[12:15], v[68:71], v[236:239], v[12:15]
    v_mfma_f32_16x16x32_bf16 v[16:19], v[72:75], v[232:235], v[16:19]
    v_mfma_f32_16x16x32_bf16 v[20:23], v[72:75], v[236:239], v[20:23]
    v_mfma_f32_16x16x32_bf16 v[24:27], v[76:79], v[232:235], v[24:27]
    v_mfma_f32_16x16x32_bf16 v[28:31], v[76:79], v[236:239], v[28:31]
    s_mov_b32 s45, 3670016
    buffer_load_dwordx2 v[184:185], v42, s[20:23], s45 offen
    buffer_load_dwordx2 v[186:187], v42, s[20:23], s45 offen offset:32
    s_mov_b32 s45, 14336
    buffer_load_dwordx2 v[188:189], v43, s[28:31], s45 offen
    v_mov_b32 v190, 0
    v_mov_b32 v191, 0
    s_mov_b32 s45, 3735552
    buffer_load_dwordx2 v[192:193], v42, s[20:23], s45 offen
    buffer_load_dwordx2 v[194:195], v42, s[20:23], s45 offen offset:32
    s_mov_b32 s45, 14592
    buffer_load_dwordx2 v[196:197], v43, s[28:31], s45 offen
    v_mov_b32 v198, 0
    v_mov_b32 v199, 0
    s_mov_b32 s45, 3801088
    buffer_load_dwordx2 v[200:201], v42, s[20:23], s45 offen
    buffer_load_dwordx2 v[202:203], v42, s[20:23], s45 offen offset:32
    s_mov_b32 s45, 14848
    buffer_load_dwordx2 v[204:205], v43, s[28:31], s45 offen
    v_mov_b32 v206, 0
    v_mov_b32 v207, 0
    s_mov_b32 s45, 3866624
    buffer_load_dwordx2 v[208:209], v42, s[20:23], s45 offen
    buffer_load_dwordx2 v[210:211], v42, s[20:23], s45 offen offset:32
    s_mov_b32 s45, 15104
    buffer_load_dwordx2 v[212:213], v43, s[28:31], s45 offen
    v_mov_b32 v214, 0
    v_mov_b32 v215, 0
    s_mov_b32 s45, 3932160
    buffer_load_dwordx2 v[216:217], v42, s[20:23], s45 offen
    buffer_load_dwordx2 v[218:219], v42, s[20:23], s45 offen offset:32
    s_mov_b32 s45, 15360
    buffer_load_dwordx2 v[220:221], v43, s[28:31], s45 offen
    v_mov_b32 v222, 0
    v_mov_b32 v223, 0
    s_mov_b32 s45, 3997696
    buffer_load_dwordx2 v[224:225], v42, s[20:23], s45 offen
    buffer_load_dwordx2 v[226:227], v42, s[20:23], s45 offen offset:32
    s_mov_b32 s45, 15616
    buffer_load_dwordx2 v[228:229], v43, s[28:31], s45 offen
    v_mov_b32 v230, 0
    v_mov_b32 v231, 0
    s_mov_b32 s45, 4063232
    buffer_load_dwordx2 v[232:233], v42, s[20:23], s45 offen
    buffer_load_dwordx2 v[234:235], v42, s[20:23], s45 offen offset:32
    s_mov_b32 s45, 15872
    buffer_load_dwordx2 v[236:237], v43, s[28:31], s45 offen
    v_mov_b32 v238, 0
    v_mov_b32 v239, 0
    s_nop 7
    v_lshl_add_u32 v6, v4, 2, 0
    v_add_u32 v7, 0, v3
    v_cmp_le_u32 vcc, v6, v7
    s_nop 1
    v_cndmask_b32 v8, v118, v8, vcc
    v_lshl_add_u32 v6, v4, 2, 1
    v_add_u32 v7, 0, v3
    v_cmp_le_u32 vcc, v6, v7
    s_nop 1
    v_cndmask_b32 v9, v118, v9, vcc
    v_lshl_add_u32 v6, v4, 2, 2
    v_add_u32 v7, 0, v3
    v_cmp_le_u32 vcc, v6, v7
    s_nop 1
    v_cndmask_b32 v10, v118, v10, vcc
    v_lshl_add_u32 v6, v4, 2, 3
    v_add_u32 v7, 0, v3
    v_cmp_le_u32 vcc, v6, v7
    s_nop 1
    v_cndmask_b32 v11, v118, v11, vcc
    v_lshl_add_u32 v6, v4, 2, 16
    v_add_u32 v7, 0, v3
    v_cmp_le_u32 vcc, v6, v7
    s_nop 1
    v_cndmask_b32 v16, v118, v16, vcc
    v_lshl_add_u32 v6, v4, 2, 17
    v_add_u32 v7, 0, v3
    v_cmp_le_u32 vcc, v6, v7
    s_nop 1
    v_cndmask_b32 v17, v118, v17, vcc
    v_lshl_add_u32 v6, v4, 2, 18
    v_add_u32 v7, 0, v3
    v_cmp_le_u32 vcc, v6, v7
    s_nop 1
    v_cndmask_b32 v18, v118, v18, vcc
    v_lshl_add_u32 v6, v4, 2, 19
    v_add_u32 v7, 0, v3
    v_cmp_le_u32 vcc, v6, v7
    s_nop 1
    v_cndmask_b32 v19, v118, v19, vcc
    v_cmp_gt_u32 vcc, 2, v4
    s_nop 1
    v_cndmask_b32 v24, v118, v24, vcc
    v_cmp_gt_u32 vcc, 2, v4
    s_nop 1
    v_cndmask_b32 v25, v118, v25, vcc
    v_cmp_gt_u32 vcc, 2, v4
    s_nop 1
    v_cndmask_b32 v26, v118, v26, vcc
    v_cmp_gt_u32 vcc, 2, v4
    s_nop 1
    v_cndmask_b32 v27, v118, v27, vcc
    v_max_f32 v32, v8, v9
    v_max_f32 v32, v32, v10
    v_max_f32 v32, v32, v11
    v_max_f32 v32, v32, v16
    v_max_f32 v32, v32, v17
    v_max_f32 v32, v32, v18
    v_max_f32 v32, v32, v19
    v_max_f32 v32, v32, v24
    v_max_f32 v32, v32, v25
    v_max_f32 v32, v32, v26
    v_max_f32 v32, v32, v27
    v_xor_b32 v33, 16, v1
    v_lshlrev_b32 v33, 2, v33
    ds_bpermute_b32 v34, v33, v32
    s_waitcnt lgkmcnt(0)
    v_max_f32 v32, v32, v34
    v_xor_b32 v33, 32, v1
    v_lshlrev_b32 v33, 2, v33
    ds_bpermute_b32 v34, v33, v32
    s_waitcnt lgkmcnt(0)
    v_max_f32 v32, v32, v34
    v_sub_f32 v8, v8, v32
    v_mul_f32 v8, 0x3fb8aa3b, v8
    v_exp_f32 v8, v8
    v_sub_f32 v9, v9, v32
    v_mul_f32 v9, 0x3fb8aa3b, v9
    v_exp_f32 v9, v9
    v_sub_f32 v10, v10, v32
    v_mul_f32 v10, 0x3fb8aa3b, v10
    v_exp_f32 v10, v10
    v_sub_f32 v11, v11, v32
    v_mul_f32 v11, 0x3fb8aa3b, v11
    v_exp_f32 v11, v11
    v_sub_f32 v16, v16, v32
    v_mul_f32 v16, 0x3fb8aa3b, v16
    v_exp_f32 v16, v16
    v_sub_f32 v17, v17, v32
    v_mul_f32 v17, 0x3fb8aa3b, v17
    v_exp_f32 v17, v17
    v_sub_f32 v18, v18, v32
    v_mul_f32 v18, 0x3fb8aa3b, v18
    v_exp_f32 v18, v18
    v_sub_f32 v19, v19, v32
    v_mul_f32 v19, 0x3fb8aa3b, v19
    v_exp_f32 v19, v19
    v_sub_f32 v24, v24, v32
    v_mul_f32 v24, 0x3fb8aa3b, v24
    v_exp_f32 v24, v24
    v_sub_f32 v25, v25, v32
    v_mul_f32 v25, 0x3fb8aa3b, v25
    v_exp_f32 v25, v25
    v_sub_f32 v26, v26, v32
    v_mul_f32 v26, 0x3fb8aa3b, v26
    v_exp_f32 v26, v26
    v_sub_f32 v27, v27, v32
    v_mul_f32 v27, 0x3fb8aa3b, v27
    v_exp_f32 v27, v27
    s_nop 0
    v_add_f32 v32, v8, v9
    v_add_f32 v32, v32, v10
    v_add_f32 v32, v32, v11
    v_add_f32 v32, v32, v16
    v_add_f32 v32, v32, v17
    v_add_f32 v32, v32, v18
    v_add_f32 v32, v32, v19
    v_add_f32 v32, v32, v24
    v_add_f32 v32, v32, v25
    v_add_f32 v32, v32, v26
    v_add_f32 v32, v32, v27
    v_xor_b32 v33, 16, v1
    v_lshlrev_b32 v33, 2, v33
    ds_bpermute_b32 v34, v33, v32
    s_waitcnt lgkmcnt(0)
    v_add_f32 v32, v32, v34
    v_xor_b32 v33, 32, v1
    v_lshlrev_b32 v33, 2, v33
    ds_bpermute_b32 v34, v33, v32
    s_waitcnt lgkmcnt(0)
    v_add_f32 v32, v32, v34
    v_rcp_f32 v32, v32
    s_nop 0
    v_mul_f32 v8, v8, v32
    v_mul_f32 v9, v9, v32
    v_mul_f32 v10, v10, v32
    v_mul_f32 v11, v11, v32
    v_mul_f32 v16, v16, v32
    v_mul_f32 v17, v17, v32
    v_mul_f32 v18, v18, v32
    v_mul_f32 v19, v19, v32
    v_mul_f32 v24, v24, v32
    v_mul_f32 v25, v25, v32
    v_mul_f32 v26, v26, v32
    v_mul_f32 v27, v27, v32
    v_cvt_pk_bf16_f32 v80, v8, v9
    v_cvt_pk_bf16_f32 v81, v10, v11
    v_cvt_pk_bf16_f32 v82, v16, v17
    v_cvt_pk_bf16_f32 v83, v18, v19
    v_cvt_pk_bf16_f32 v84, v24, v25
    v_cvt_pk_bf16_f32 v85, v26, v27
    v_mov_b32 v86, 0
    v_mov_b32 v87, 0
    v_lshl_add_u32 v6, v4, 2, 0
    v_add_u32 v7, 16, v3
    v_cmp_le_u32 vcc, v6, v7
    s_nop 1
    v_cndmask_b32 v12, v118, v12, vcc
    v_lshl_add_u32 v6, v4, 2, 1
    v_add_u32 v7, 16, v3
    v_cmp_le_u32 vcc, v6, v7
    s_nop 1
    v_cndmask_b32 v13, v118, v13, vcc
    v_lshl_add_u32 v6, v4, 2, 2
    v_add_u32 v7, 16, v3
    v_cmp_le_u32 vcc, v6, v7
    s_nop 1
    v_cndmask_b32 v14, v118, v14, vcc
    v_lshl_add_u32 v6, v4, 2, 3
    v_add_u32 v7, 16, v3
    v_cmp_le_u32 vcc, v6, v7
    s_nop 1
    v_cndmask_b32 v15, v118, v15, vcc
    v_lshl_add_u32 v6, v4, 2, 16
    v_add_u32 v7, 16, v3
    v_cmp_le_u32 vcc, v6, v7
    s_nop 1
    v_cndmask_b32 v20, v118, v20, vcc
    v_lshl_add_u32 v6, v4, 2, 17
    v_add_u32 v7, 16, v3
    v_cmp_le_u32 vcc, v6, v7
    s_nop 1
    v_cndmask_b32 v21, v118, v21, vcc
    v_lshl_add_u32 v6, v4, 2, 18
    v_add_u32 v7, 16, v3
    v_cmp_le_u32 vcc, v6, v7
    s_nop 1
    v_cndmask_b32 v22, v118, v22, vcc
    v_lshl_add_u32 v6, v4, 2, 19
    v_add_u32 v7, 16, v3
    v_cmp_le_u32 vcc, v6, v7
    s_nop 1
    v_cndmask_b32 v23, v118, v23, vcc
    v_cmp_gt_u32 vcc, 2, v4
    s_nop 1
    v_cndmask_b32 v28, v118, v28, vcc
    v_cmp_gt_u32 vcc, 2, v4
    s_nop 1
    v_cndmask_b32 v29, v118, v29, vcc
    v_cmp_gt_u32 vcc, 2, v4
    s_nop 1
    v_cndmask_b32 v30, v118, v30, vcc
    v_cmp_gt_u32 vcc, 2, v4
    s_nop 1
    v_cndmask_b32 v31, v118, v31, vcc
    v_max_f32 v32, v12, v13
    v_max_f32 v32, v32, v14
    v_max_f32 v32, v32, v15
    v_max_f32 v32, v32, v20
    v_max_f32 v32, v32, v21
    v_max_f32 v32, v32, v22
    v_max_f32 v32, v32, v23
    v_max_f32 v32, v32, v28
    v_max_f32 v32, v32, v29
    v_max_f32 v32, v32, v30
    v_max_f32 v32, v32, v31
    v_xor_b32 v33, 16, v1
    v_lshlrev_b32 v33, 2, v33
    ds_bpermute_b32 v34, v33, v32
    s_waitcnt lgkmcnt(0)
    v_max_f32 v32, v32, v34
    v_xor_b32 v33, 32, v1
    v_lshlrev_b32 v33, 2, v33
    ds_bpermute_b32 v34, v33, v32
    s_waitcnt lgkmcnt(0)
    v_max_f32 v32, v32, v34
    v_sub_f32 v12, v12, v32
    v_mul_f32 v12, 0x3fb8aa3b, v12
    v_exp_f32 v12, v12
    v_sub_f32 v13, v13, v32
    v_mul_f32 v13, 0x3fb8aa3b, v13
    v_exp_f32 v13, v13
    v_sub_f32 v14, v14, v32
    v_mul_f32 v14, 0x3fb8aa3b, v14
    v_exp_f32 v14, v14
    v_sub_f32 v15, v15, v32
    v_mul_f32 v15, 0x3fb8aa3b, v15
    v_exp_f32 v15, v15
    v_sub_f32 v20, v20, v32
    v_mul_f32 v20, 0x3fb8aa3b, v20
    v_exp_f32 v20, v20
    v_sub_f32 v21, v21, v32
    v_mul_f32 v21, 0x3fb8aa3b, v21
    v_exp_f32 v21, v21
    v_sub_f32 v22, v22, v32
    v_mul_f32 v22, 0x3fb8aa3b, v22
    v_exp_f32 v22, v22
    v_sub_f32 v23, v23, v32
    v_mul_f32 v23, 0x3fb8aa3b, v23
    v_exp_f32 v23, v23
    v_sub_f32 v28, v28, v32
    v_mul_f32 v28, 0x3fb8aa3b, v28
    v_exp_f32 v28, v28
    v_sub_f32 v29, v29, v32
    v_mul_f32 v29, 0x3fb8aa3b, v29
    v_exp_f32 v29, v29
    v_sub_f32 v30, v30, v32
    v_mul_f32 v30, 0x3fb8aa3b, v30
    v_exp_f32 v30, v30
    v_sub_f32 v31, v31, v32
    v_mul_f32 v31, 0x3fb8aa3b, v31
    v_exp_f32 v31, v31
    s_nop 0
    v_add_f32 v32, v12, v13
    v_add_f32 v32, v32, v14
    v_add_f32 v32, v32, v15
    v_add_f32 v32, v32, v20
    v_add_f32 v32, v32, v21
    v_add_f32 v32, v32, v22
    v_add_f32 v32, v32, v23
    v_add_f32 v32, v32, v28
    v_add_f32 v32, v32, v29
    v_add_f32 v32, v32, v30
    v_add_f32 v32, v32, v31
    v_xor_b32 v33, 16, v1
    v_lshlrev_b32 v33, 2, v33
    ds_bpermute_b32 v34, v33, v32
    s_waitcnt lgkmcnt(0)
    v_add_f32 v32, v32, v34
    v_xor_b32 v33, 32, v1
    v_lshlrev_b32 v33, 2, v33
    ds_bpermute_b32 v34, v33, v32
    s_waitcnt lgkmcnt(0)
    v_add_f32 v32, v32, v34
    v_rcp_f32 v32, v32
    s_nop 0
    v_mul_f32 v12, v12, v32
    v_mul_f32 v13, v13, v32
    v_mul_f32 v14, v14, v32
    v_mul_f32 v15, v15, v32
    v_mul_f32 v20, v20, v32
    v_mul_f32 v21, v21, v32
    v_mul_f32 v22, v22, v32
    v_mul_f32 v23, v23, v32
    v_mul_f32 v28, v28, v32
    v_mul_f32 v29, v29, v32
    v_mul_f32 v30, v30, v32
    v_mul_f32 v31, v31, v32
    v_cvt_pk_bf16_f32 v88, v12, v13
    v_cvt_pk_bf16_f32 v89, v14, v15
    v_cvt_pk_bf16_f32 v90, v20, v21
    v_cvt_pk_bf16_f32 v91, v22, v23
    v_cvt_pk_bf16_f32 v92, v28, v29
    v_cvt_pk_bf16_f32 v93, v30, v31
    v_mov_b32 v94, 0
    v_mov_b32 v95, 0
    s_waitcnt vmcnt(0)
    v_mfma_f32_16x16x32_bf16 v[128:131], v[184:187], v[80:83], v[128:131]
    v_mfma_f32_16x16x32_bf16 v[128:131], v[188:191], v[84:87], v[128:131]
    v_mfma_f32_16x16x32_bf16 v[132:135], v[184:187], v[88:91], v[132:135]
    v_mfma_f32_16x16x32_bf16 v[132:135], v[188:191], v[92:95], v[132:135]
    v_mfma_f32_16x16x32_bf16 v[136:139], v[192:195], v[80:83], v[136:139]
    v_mfma_f32_16x16x32_bf16 v[136:139], v[196:199], v[84:87], v[136:139]
    v_mfma_f32_16x16x32_bf16 v[140:143], v[192:195], v[88:91], v[140:143]
    v_mfma_f32_16x16x32_bf16 v[140:143], v[196:199], v[92:95], v[140:143]
    v_mfma_f32_16x16x32_bf16 v[144:147], v[200:203], v[80:83], v[144:147]
    v_mfma_f32_16x16x32_bf16 v[144:147], v[204:207], v[84:87], v[144:147]
    v_mfma_f32_16x16x32_bf16 v[148:151], v[200:203], v[88:91], v[148:151]
    v_mfma_f32_16x16x32_bf16 v[148:151], v[204:207], v[92:95], v[148:151]
    v_mfma_f32_16x16x32_bf16 v[152:155], v[208:211], v[80:83], v[152:155]
    v_mfma_f32_16x16x32_bf16 v[152:155], v[212:215], v[84:87], v[152:155]
    v_mfma_f32_16x16x32_bf16 v[156:159], v[208:211], v[88:91], v[156:159]
    v_mfma_f32_16x16x32_bf16 v[156:159], v[212:215], v[92:95], v[156:159]
    v_mfma_f32_16x16x32_bf16 v[160:163], v[216:219], v[80:83], v[160:163]
    v_mfma_f32_16x16x32_bf16 v[160:163], v[220:223], v[84:87], v[160:163]
    v_mfma_f32_16x16x32_bf16 v[164:167], v[216:219], v[88:91], v[164:167]
    v_mfma_f32_16x16x32_bf16 v[164:167], v[220:223], v[92:95], v[164:167]
    v_mfma_f32_16x16x32_bf16 v[168:171], v[224:227], v[80:83], v[168:171]
    v_mfma_f32_16x16x32_bf16 v[168:171], v[228:231], v[84:87], v[168:171]
    v_mfma_f32_16x16x32_bf16 v[172:175], v[224:227], v[88:91], v[172:175]
    v_mfma_f32_16x16x32_bf16 v[172:175], v[228:231], v[92:95], v[172:175]
    v_mfma_f32_16x16x32_bf16 v[176:179], v[232:235], v[80:83], v[176:179]
    v_mfma_f32_16x16x32_bf16 v[176:179], v[236:239], v[84:87], v[176:179]
    v_mfma_f32_16x16x32_bf16 v[180:183], v[232:235], v[88:91], v[180:183]
    v_mfma_f32_16x16x32_bf16 v[180:183], v[236:239], v[92:95], v[180:183]
    v_mov_b32 v8, 0
    v_mov_b32 v9, 0
    v_mov_b32 v10, 0
    v_mov_b32 v11, 0
    v_mov_b32 v12, 0
    v_mov_b32 v13, 0
    v_mov_b32 v14, 0
    v_mov_b32 v15, 0
    v_mov_b32 v16, 0
    v_mov_b32 v17, 0
    v_mov_b32 v18, 0
    v_mov_b32 v19, 0
    v_mov_b32 v20, 0
    v_mov_b32 v21, 0
    v_mov_b32 v22, 0
    v_mov_b32 v23, 0
    v_mov_b32 v24, 0
    v_mov_b32 v25, 0
    v_mov_b32 v26, 0
    v_mov_b32 v27, 0
    v_mov_b32 v28, 0
    v_mov_b32 v29, 0
    v_mov_b32 v30, 0
    v_mov_b32 v31, 0
    s_mov_b32 s45, 2688
    buffer_load_dwordx4 v[184:187], v41, s[16:19], s45 offen offset:0
    s_mov_b32 s45, 232064
    buffer_load_dwordx4 v[188:191], v41, s[16:19], s45 offen offset:0
    s_mov_b32 s45, 2688
    buffer_load_dwordx4 v[192:195], v41, s[16:19], s45 offen offset:64
    s_mov_b32 s45, 232064
    buffer_load_dwordx4 v[196:199], v41, s[16:19], s45 offen offset:64
    s_mov_b32 s45, 2688
    buffer_load_dwordx4 v[200:203], v41, s[16:19], s45 offen offset:128
    s_mov_b32 s45, 232064
    buffer_load_dwordx4 v[204:207], v41, s[16:19], s45 offen offset:128
    s_mov_b32 s45, 2688
    buffer_load_dwordx4 v[208:211], v41, s[16:19], s45 offen offset:192
    s_mov_b32 s45, 232064
    buffer_load_dwordx4 v[212:215], v41, s[16:19], s45 offen offset:192
    s_mov_b32 s45, 2688
    buffer_load_dwordx4 v[216:219], v41, s[16:19], s45 offen offset:256
    s_mov_b32 s45, 232064
    buffer_load_dwordx4 v[220:223], v41, s[16:19], s45 offen offset:256
    s_mov_b32 s45, 2688
    buffer_load_dwordx4 v[224:227], v41, s[16:19], s45 offen offset:320
    s_mov_b32 s45, 232064
    buffer_load_dwordx4 v[228:231], v41, s[16:19], s45 offen offset:320
    s_mov_b32 s45, 2688
    buffer_load_dwordx4 v[232:235], v41, s[16:19], s45 offen offset:384
    s_mov_b32 s45, 232064
    buffer_load_dwordx4 v[236:239], v41, s[16:19], s45 offen offset:384
    ds_read_b128 v[68:71], v40 offset:0
    ds_read_b128 v[72:75], v40 offset:14592
    ds_read_b128 v[76:79], v40 offset:29184
    s_waitcnt vmcnt(12) lgkmcnt(0)
    v_mfma_f32_16x16x32_bf16 v[8:11], v[68:71], v[184:187], v[8:11]
    v_mfma_f32_16x16x32_bf16 v[12:15], v[68:71], v[188:191], v[12:15]
    v_mfma_f32_16x16x32_bf16 v[16:19], v[72:75], v[184:187], v[16:19]
    v_mfma_f32_16x16x32_bf16 v[20:23], v[72:75], v[188:191], v[20:23]
    v_mfma_f32_16x16x32_bf16 v[24:27], v[76:79], v[184:187], v[24:27]
    v_mfma_f32_16x16x32_bf16 v[28:31], v[76:79], v[188:191], v[28:31]
    ds_read_b128 v[68:71], v40 offset:64
    ds_read_b128 v[72:75], v40 offset:14656
    ds_read_b128 v[76:79], v40 offset:29248
    s_waitcnt vmcnt(10) lgkmcnt(0)
    v_mfma_f32_16x16x32_bf16 v[8:11], v[68:71], v[192:195], v[8:11]
    v_mfma_f32_16x16x32_bf16 v[12:15], v[68:71], v[196:199], v[12:15]
    v_mfma_f32_16x16x32_bf16 v[16:19], v[72:75], v[192:195], v[16:19]
    v_mfma_f32_16x16x32_bf16 v[20:23], v[72:75], v[196:199], v[20:23]
    v_mfma_f32_16x16x32_bf16 v[24:27], v[76:79], v[192:195], v[24:27]
    v_mfma_f32_16x16x32_bf16 v[28:31], v[76:79], v[196:199], v[28:31]
    ds_read_b128 v[68:71], v40 offset:128
    ds_read_b128 v[72:75], v40 offset:14720
    ds_read_b128 v[76:79], v40 offset:29312
    s_waitcnt vmcnt(8) lgkmcnt(0)
    v_mfma_f32_16x16x32_bf16 v[8:11], v[68:71], v[200:203], v[8:11]
    v_mfma_f32_16x16x32_bf16 v[12:15], v[68:71], v[204:207], v[12:15]
    v_mfma_f32_16x16x32_bf16 v[16:19], v[72:75], v[200:203], v[16:19]
    v_mfma_f32_16x16x32_bf16 v[20:23], v[72:75], v[204:207], v[20:23]
    v_mfma_f32_16x16x32_bf16 v[24:27], v[76:79], v[200:203], v[24:27]
    v_mfma_f32_16x16x32_bf16 v[28:31], v[76:79], v[204:207], v[28:31]
    ds_read_b128 v[68:71], v40 offset:192
    ds_read_b128 v[72:75], v40 offset:14784
    ds_read_b128 v[76:79], v40 offset:29376
    s_waitcnt vmcnt(6) lgkmcnt(0)
    v_mfma_f32_16x16x32_bf16 v[8:11], v[68:71], v[208:211], v[8:11]
    v_mfma_f32_16x16x32_bf16 v[12:15], v[68:71], v[212:215], v[12:15]
    v_mfma_f32_16x16x32_bf16 v[16:19], v[72:75], v[208:211], v[16:19]
    v_mfma_f32_16x16x32_bf16 v[20:23], v[72:75], v[212:215], v[20:23]
    v_mfma_f32_16x16x32_bf16 v[24:27], v[76:79], v[208:211], v[24:27]
    v_mfma_f32_16x16x32_bf16 v[28:31], v[76:79], v[212:215], v[28:31]
    ds_read_b128 v[68:71], v40 offset:256
    ds_read_b128 v[72:75], v40 offset:14848
    ds_read_b128 v[76:79], v40 offset:29440
    s_waitcnt vmcnt(4) lgkmcnt(0)
    v_mfma_f32_16x16x32_bf16 v[8:11], v[68:71], v[216:219], v[8:11]
    v_mfma_f32_16x16x32_bf16 v[12:15], v[68:71], v[220:223], v[12:15]
    v_mfma_f32_16x16x32_bf16 v[16:19], v[72:75], v[216:219], v[16:19]
    v_mfma_f32_16x16x32_bf16 v[20:23], v[72:75], v[220:223], v[20:23]
    v_mfma_f32_16x16x32_bf16 v[24:27], v[76:79], v[216:219], v[24:27]
    v_mfma_f32_16x16x32_bf16 v[28:31], v[76:79], v[220:223], v[28:31]
    ds_read_b128 v[68:71], v40 offset:320
    ds_read_b128 v[72:75], v40 offset:14912
    ds_read_b128 v[76:79], v40 offset:29504
    s_waitcnt vmcnt(2) lgkmcnt(0)
    v_mfma_f32_16x16x32_bf16 v[8:11], v[68:71], v[224:227], v[8:11]
    v_mfma_f32_16x16x32_bf16 v[12:15], v[68:71], v[228:231], v[12:15]
    v_mfma_f32_16x16x32_bf16 v[16:19], v[72:75], v[224:227], v[16:19]
    v_mfma_f32_16x16x32_bf16 v[20:23], v[72:75], v[228:231], v[20:23]
    v_mfma_f32_16x16x32_bf16 v[24:27], v[76:79], v[224:227], v[24:27]
    v_mfma_f32_16x16x32_bf16 v[28:31], v[76:79], v[228:231], v[28:31]
    ds_read_b128 v[68:71], v40 offset:384
    ds_read_b128 v[72:75], v40 offset:14976
    ds_read_b128 v[76:79], v40 offset:29568
    s_waitcnt vmcnt(0) lgkmcnt(0)
    v_mfma_f32_16x16x32_bf16 v[8:11], v[68:71], v[232:235], v[8:11]
    v_mfma_f32_16x16x32_bf16 v[12:15], v[68:71], v[236:239], v[12:15]
    v_mfma_f32_16x16x32_bf16 v[16:19], v[72:75], v[232:235], v[16:19]
    v_mfma_f32_16x16x32_bf16 v[20:23], v[72:75], v[236:239], v[20:23]
    v_mfma_f32_16x16x32_bf16 v[24:27], v[76:79], v[232:235], v[24:27]
    v_mfma_f32_16x16x32_bf16 v[28:31], v[76:79], v[236:239], v[28:31]
    s_mov_b32 s45, 2688
    buffer_load_dwordx4 v[184:187], v41, s[16:19], s45 offen offset:448
    s_mov_b32 s45, 232064
    buffer_load_dwordx4 v[188:191], v41, s[16:19], s45 offen offset:448
    s_mov_b32 s45, 2688
    buffer_load_dwordx4 v[192:195], v41, s[16:19], s45 offen offset:512
    s_mov_b32 s45, 232064
    buffer_load_dwordx4 v[196:199], v41, s[16:19], s45 offen offset:512
    s_mov_b32 s45, 2688
    buffer_load_dwordx4 v[200:203], v41, s[16:19], s45 offen offset:576
    s_mov_b32 s45, 232064
    buffer_load_dwordx4 v[204:207], v41, s[16:19], s45 offen offset:576
    s_mov_b32 s45, 2688
    buffer_load_dwordx4 v[208:211], v41, s[16:19], s45 offen offset:640
    s_mov_b32 s45, 232064
    buffer_load_dwordx4 v[212:215], v41, s[16:19], s45 offen offset:640
    s_mov_b32 s45, 2688
    buffer_load_dwordx4 v[216:219], v41, s[16:19], s45 offen offset:704
    s_mov_b32 s45, 232064
    buffer_load_dwordx4 v[220:223], v41, s[16:19], s45 offen offset:704
    s_mov_b32 s45, 2688
    buffer_load_dwordx4 v[224:227], v41, s[16:19], s45 offen offset:768
    s_mov_b32 s45, 232064
    buffer_load_dwordx4 v[228:231], v41, s[16:19], s45 offen offset:768
    s_mov_b32 s45, 2688
    buffer_load_dwordx4 v[232:235], v41, s[16:19], s45 offen offset:832
    s_mov_b32 s45, 232064
    buffer_load_dwordx4 v[236:239], v41, s[16:19], s45 offen offset:832
    ds_read_b128 v[68:71], v40 offset:448
    ds_read_b128 v[72:75], v40 offset:15040
    ds_read_b128 v[76:79], v40 offset:29632
    s_waitcnt vmcnt(12) lgkmcnt(0)
    v_mfma_f32_16x16x32_bf16 v[8:11], v[68:71], v[184:187], v[8:11]
    v_mfma_f32_16x16x32_bf16 v[12:15], v[68:71], v[188:191], v[12:15]
    v_mfma_f32_16x16x32_bf16 v[16:19], v[72:75], v[184:187], v[16:19]
    v_mfma_f32_16x16x32_bf16 v[20:23], v[72:75], v[188:191], v[20:23]
    v_mfma_f32_16x16x32_bf16 v[24:27], v[76:79], v[184:187], v[24:27]
    v_mfma_f32_16x16x32_bf16 v[28:31], v[76:79], v[188:191], v[28:31]
    ds_read_b128 v[68:71], v40 offset:512
    ds_read_b128 v[72:75], v40 offset:15104
    ds_read_b128 v[76:79], v40 offset:29696
    s_waitcnt vmcnt(10) lgkmcnt(0)
    v_mfma_f32_16x16x32_bf16 v[8:11], v[68:71], v[192:195], v[8:11]
    v_mfma_f32_16x16x32_bf16 v[12:15], v[68:71], v[196:199], v[12:15]
    v_mfma_f32_16x16x32_bf16 v[16:19], v[72:75], v[192:195], v[16:19]
    v_mfma_f32_16x16x32_bf16 v[20:23], v[72:75], v[196:199], v[20:23]
    v_mfma_f32_16x16x32_bf16 v[24:27], v[76:79], v[192:195], v[24:27]
    v_mfma_f32_16x16x32_bf16 v[28:31], v[76:79], v[196:199], v[28:31]
    ds_read_b128 v[68:71], v40 offset:576
    ds_read_b128 v[72:75], v40 offset:15168
    ds_read_b128 v[76:79], v40 offset:29760
    s_waitcnt vmcnt(8) lgkmcnt(0)
    v_mfma_f32_16x16x32_bf16 v[8:11], v[68:71], v[200:203], v[8:11]
    v_mfma_f32_16x16x32_bf16 v[12:15], v[68:71], v[204:207], v[12:15]
    v_mfma_f32_16x16x32_bf16 v[16:19], v[72:75], v[200:203], v[16:19]
    v_mfma_f32_16x16x32_bf16 v[20:23], v[72:75], v[204:207], v[20:23]
    v_mfma_f32_16x16x32_bf16 v[24:27], v[76:79], v[200:203], v[24:27]
    v_mfma_f32_16x16x32_bf16 v[28:31], v[76:79], v[204:207], v[28:31]
    ds_read_b128 v[68:71], v40 offset:640
    ds_read_b128 v[72:75], v40 offset:15232
    ds_read_b128 v[76:79], v40 offset:29824
    s_waitcnt vmcnt(6) lgkmcnt(0)
    v_mfma_f32_16x16x32_bf16 v[8:11], v[68:71], v[208:211], v[8:11]
    v_mfma_f32_16x16x32_bf16 v[12:15], v[68:71], v[212:215], v[12:15]
    v_mfma_f32_16x16x32_bf16 v[16:19], v[72:75], v[208:211], v[16:19]
    v_mfma_f32_16x16x32_bf16 v[20:23], v[72:75], v[212:215], v[20:23]
    v_mfma_f32_16x16x32_bf16 v[24:27], v[76:79], v[208:211], v[24:27]
    v_mfma_f32_16x16x32_bf16 v[28:31], v[76:79], v[212:215], v[28:31]
    ds_read_b128 v[68:71], v40 offset:704
    ds_read_b128 v[72:75], v40 offset:15296
    ds_read_b128 v[76:79], v40 offset:29888
    s_waitcnt vmcnt(4) lgkmcnt(0)
    v_mfma_f32_16x16x32_bf16 v[8:11], v[68:71], v[216:219], v[8:11]
    v_mfma_f32_16x16x32_bf16 v[12:15], v[68:71], v[220:223], v[12:15]
    v_mfma_f32_16x16x32_bf16 v[16:19], v[72:75], v[216:219], v[16:19]
    v_mfma_f32_16x16x32_bf16 v[20:23], v[72:75], v[220:223], v[20:23]
    v_mfma_f32_16x16x32_bf16 v[24:27], v[76:79], v[216:219], v[24:27]
    v_mfma_f32_16x16x32_bf16 v[28:31], v[76:79], v[220:223], v[28:31]
    ds_read_b128 v[68:71], v40 offset:768
    ds_read_b128 v[72:75], v40 offset:15360
    ds_read_b128 v[76:79], v40 offset:29952
    s_waitcnt vmcnt(2) lgkmcnt(0)
    v_mfma_f32_16x16x32_bf16 v[8:11], v[68:71], v[224:227], v[8:11]
    v_mfma_f32_16x16x32_bf16 v[12:15], v[68:71], v[228:231], v[12:15]
    v_mfma_f32_16x16x32_bf16 v[16:19], v[72:75], v[224:227], v[16:19]
    v_mfma_f32_16x16x32_bf16 v[20:23], v[72:75], v[228:231], v[20:23]
    v_mfma_f32_16x16x32_bf16 v[24:27], v[76:79], v[224:227], v[24:27]
    v_mfma_f32_16x16x32_bf16 v[28:31], v[76:79], v[228:231], v[28:31]
    ds_read_b128 v[68:71], v40 offset:832
    ds_read_b128 v[72:75], v40 offset:15424
    ds_read_b128 v[76:79], v40 offset:30016
    s_waitcnt vmcnt(0) lgkmcnt(0)
    v_mfma_f32_16x16x32_bf16 v[8:11], v[68:71], v[232:235], v[8:11]
    v_mfma_f32_16x16x32_bf16 v[12:15], v[68:71], v[236:239], v[12:15]
    v_mfma_f32_16x16x32_bf16 v[16:19], v[72:75], v[232:235], v[16:19]
    v_mfma_f32_16x16x32_bf16 v[20:23], v[72:75], v[236:239], v[20:23]
    v_mfma_f32_16x16x32_bf16 v[24:27], v[76:79], v[232:235], v[24:27]
    v_mfma_f32_16x16x32_bf16 v[28:31], v[76:79], v[236:239], v[28:31]
    s_mov_b32 s45, 5505024
    buffer_load_dwordx2 v[184:185], v42, s[20:23], s45 offen
    buffer_load_dwordx2 v[186:187], v42, s[20:23], s45 offen offset:32
    s_mov_b32 s45, 21504
    buffer_load_dwordx2 v[188:189], v43, s[28:31], s45 offen
    v_mov_b32 v190, 0
    v_mov_b32 v191, 0
    s_mov_b32 s45, 5570560
    buffer_load_dwordx2 v[192:193], v42, s[20:23], s45 offen
    buffer_load_dwordx2 v[194:195], v42, s[20:23], s45 offen offset:32
    s_mov_b32 s45, 21760
    buffer_load_dwordx2 v[196:197], v43, s[28:31], s45 offen
    v_mov_b32 v198, 0
    v_mov_b32 v199, 0
    s_mov_b32 s45, 5636096
    buffer_load_dwordx2 v[200:201], v42, s[20:23], s45 offen
    buffer_load_dwordx2 v[202:203], v42, s[20:23], s45 offen offset:32
    s_mov_b32 s45, 22016
    buffer_load_dwordx2 v[204:205], v43, s[28:31], s45 offen
    v_mov_b32 v206, 0
    v_mov_b32 v207, 0
    s_mov_b32 s45, 5701632
    buffer_load_dwordx2 v[208:209], v42, s[20:23], s45 offen
    buffer_load_dwordx2 v[210:211], v42, s[20:23], s45 offen offset:32
    s_mov_b32 s45, 22272
    buffer_load_dwordx2 v[212:213], v43, s[28:31], s45 offen
    v_mov_b32 v214, 0
    v_mov_b32 v215, 0
    s_mov_b32 s45, 5767168
    buffer_load_dwordx2 v[216:217], v42, s[20:23], s45 offen
    buffer_load_dwordx2 v[218:219], v42, s[20:23], s45 offen offset:32
    s_mov_b32 s45, 22528
    buffer_load_dwordx2 v[220:221], v43, s[28:31], s45 offen
    v_mov_b32 v222, 0
    v_mov_b32 v223, 0
    s_mov_b32 s45, 5832704
    buffer_load_dwordx2 v[224:225], v42, s[20:23], s45 offen
    buffer_load_dwordx2 v[226:227], v42, s[20:23], s45 offen offset:32
    s_mov_b32 s45, 22784
    buffer_load_dwordx2 v[228:229], v43, s[28:31], s45 offen
    v_mov_b32 v230, 0
    v_mov_b32 v231, 0
    s_mov_b32 s45, 5898240
    buffer_load_dwordx2 v[232:233], v42, s[20:23], s45 offen
    buffer_load_dwordx2 v[234:235], v42, s[20:23], s45 offen offset:32
    s_mov_b32 s45, 23040
    buffer_load_dwordx2 v[236:237], v43, s[28:31], s45 offen
    v_mov_b32 v238, 0
    v_mov_b32 v239, 0
    s_nop 7
    v_lshl_add_u32 v6, v4, 2, 0
    v_add_u32 v7, 0, v3
    v_cmp_le_u32 vcc, v6, v7
    s_nop 1
    v_cndmask_b32 v8, v118, v8, vcc
    v_lshl_add_u32 v6, v4, 2, 1
    v_add_u32 v7, 0, v3
    v_cmp_le_u32 vcc, v6, v7
    s_nop 1
    v_cndmask_b32 v9, v118, v9, vcc
    v_lshl_add_u32 v6, v4, 2, 2
    v_add_u32 v7, 0, v3
    v_cmp_le_u32 vcc, v6, v7
    s_nop 1
    v_cndmask_b32 v10, v118, v10, vcc
    v_lshl_add_u32 v6, v4, 2, 3
    v_add_u32 v7, 0, v3
    v_cmp_le_u32 vcc, v6, v7
    s_nop 1
    v_cndmask_b32 v11, v118, v11, vcc
    v_lshl_add_u32 v6, v4, 2, 16
    v_add_u32 v7, 0, v3
    v_cmp_le_u32 vcc, v6, v7
    s_nop 1
    v_cndmask_b32 v16, v118, v16, vcc
    v_lshl_add_u32 v6, v4, 2, 17
    v_add_u32 v7, 0, v3
    v_cmp_le_u32 vcc, v6, v7
    s_nop 1
    v_cndmask_b32 v17, v118, v17, vcc
    v_lshl_add_u32 v6, v4, 2, 18
    v_add_u32 v7, 0, v3
    v_cmp_le_u32 vcc, v6, v7
    s_nop 1
    v_cndmask_b32 v18, v118, v18, vcc
    v_lshl_add_u32 v6, v4, 2, 19
    v_add_u32 v7, 0, v3
    v_cmp_le_u32 vcc, v6, v7
    s_nop 1
    v_cndmask_b32 v19, v118, v19, vcc
    v_cmp_gt_u32 vcc, 2, v4
    s_nop 1
    v_cndmask_b32 v24, v118, v24, vcc
    v_cmp_gt_u32 vcc, 2, v4
    s_nop 1
    v_cndmask_b32 v25, v118, v25, vcc
    v_cmp_gt_u32 vcc, 2, v4
    s_nop 1
    v_cndmask_b32 v26, v118, v26, vcc
    v_cmp_gt_u32 vcc, 2, v4
    s_nop 1
    v_cndmask_b32 v27, v118, v27, vcc
    v_max_f32 v32, v8, v9
    v_max_f32 v32, v32, v10
    v_max_f32 v32, v32, v11
    v_max_f32 v32, v32, v16
    v_max_f32 v32, v32, v17
    v_max_f32 v32, v32, v18
    v_max_f32 v32, v32, v19
    v_max_f32 v32, v32, v24
    v_max_f32 v32, v32, v25
    v_max_f32 v32, v32, v26
    v_max_f32 v32, v32, v27
    v_xor_b32 v33, 16, v1
    v_lshlrev_b32 v33, 2, v33
    ds_bpermute_b32 v34, v33, v32
    s_waitcnt lgkmcnt(0)
    v_max_f32 v32, v32, v34
    v_xor_b32 v33, 32, v1
    v_lshlrev_b32 v33, 2, v33
    ds_bpermute_b32 v34, v33, v32
    s_waitcnt lgkmcnt(0)
    v_max_f32 v32, v32, v34
    v_sub_f32 v8, v8, v32
    v_mul_f32 v8, 0x3fb8aa3b, v8
    v_exp_f32 v8, v8
    v_sub_f32 v9, v9, v32
    v_mul_f32 v9, 0x3fb8aa3b, v9
    v_exp_f32 v9, v9
    v_sub_f32 v10, v10, v32
    v_mul_f32 v10, 0x3fb8aa3b, v10
    v_exp_f32 v10, v10
    v_sub_f32 v11, v11, v32
    v_mul_f32 v11, 0x3fb8aa3b, v11
    v_exp_f32 v11, v11
    v_sub_f32 v16, v16, v32
    v_mul_f32 v16, 0x3fb8aa3b, v16
    v_exp_f32 v16, v16
    v_sub_f32 v17, v17, v32
    v_mul_f32 v17, 0x3fb8aa3b, v17
    v_exp_f32 v17, v17
    v_sub_f32 v18, v18, v32
    v_mul_f32 v18, 0x3fb8aa3b, v18
    v_exp_f32 v18, v18
    v_sub_f32 v19, v19, v32
    v_mul_f32 v19, 0x3fb8aa3b, v19
    v_exp_f32 v19, v19
    v_sub_f32 v24, v24, v32
    v_mul_f32 v24, 0x3fb8aa3b, v24
    v_exp_f32 v24, v24
    v_sub_f32 v25, v25, v32
    v_mul_f32 v25, 0x3fb8aa3b, v25
    v_exp_f32 v25, v25
    v_sub_f32 v26, v26, v32
    v_mul_f32 v26, 0x3fb8aa3b, v26
    v_exp_f32 v26, v26
    v_sub_f32 v27, v27, v32
    v_mul_f32 v27, 0x3fb8aa3b, v27
    v_exp_f32 v27, v27
    s_nop 0
    v_add_f32 v32, v8, v9
    v_add_f32 v32, v32, v10
    v_add_f32 v32, v32, v11
    v_add_f32 v32, v32, v16
    v_add_f32 v32, v32, v17
    v_add_f32 v32, v32, v18
    v_add_f32 v32, v32, v19
    v_add_f32 v32, v32, v24
    v_add_f32 v32, v32, v25
    v_add_f32 v32, v32, v26
    v_add_f32 v32, v32, v27
    v_xor_b32 v33, 16, v1
    v_lshlrev_b32 v33, 2, v33
    ds_bpermute_b32 v34, v33, v32
    s_waitcnt lgkmcnt(0)
    v_add_f32 v32, v32, v34
    v_xor_b32 v33, 32, v1
    v_lshlrev_b32 v33, 2, v33
    ds_bpermute_b32 v34, v33, v32
    s_waitcnt lgkmcnt(0)
    v_add_f32 v32, v32, v34
    v_rcp_f32 v32, v32
    s_nop 0
    v_mul_f32 v8, v8, v32
    v_mul_f32 v9, v9, v32
    v_mul_f32 v10, v10, v32
    v_mul_f32 v11, v11, v32
    v_mul_f32 v16, v16, v32
    v_mul_f32 v17, v17, v32
    v_mul_f32 v18, v18, v32
    v_mul_f32 v19, v19, v32
    v_mul_f32 v24, v24, v32
    v_mul_f32 v25, v25, v32
    v_mul_f32 v26, v26, v32
    v_mul_f32 v27, v27, v32
    v_cvt_pk_bf16_f32 v80, v8, v9
    v_cvt_pk_bf16_f32 v81, v10, v11
    v_cvt_pk_bf16_f32 v82, v16, v17
    v_cvt_pk_bf16_f32 v83, v18, v19
    v_cvt_pk_bf16_f32 v84, v24, v25
    v_cvt_pk_bf16_f32 v85, v26, v27
    v_mov_b32 v86, 0
    v_mov_b32 v87, 0
    v_lshl_add_u32 v6, v4, 2, 0
    v_add_u32 v7, 16, v3
    v_cmp_le_u32 vcc, v6, v7
    s_nop 1
    v_cndmask_b32 v12, v118, v12, vcc
    v_lshl_add_u32 v6, v4, 2, 1
    v_add_u32 v7, 16, v3
    v_cmp_le_u32 vcc, v6, v7
    s_nop 1
    v_cndmask_b32 v13, v118, v13, vcc
    v_lshl_add_u32 v6, v4, 2, 2
    v_add_u32 v7, 16, v3
    v_cmp_le_u32 vcc, v6, v7
    s_nop 1
    v_cndmask_b32 v14, v118, v14, vcc
    v_lshl_add_u32 v6, v4, 2, 3
    v_add_u32 v7, 16, v3
    v_cmp_le_u32 vcc, v6, v7
    s_nop 1
    v_cndmask_b32 v15, v118, v15, vcc
    v_lshl_add_u32 v6, v4, 2, 16
    v_add_u32 v7, 16, v3
    v_cmp_le_u32 vcc, v6, v7
    s_nop 1
    v_cndmask_b32 v20, v118, v20, vcc
    v_lshl_add_u32 v6, v4, 2, 17
    v_add_u32 v7, 16, v3
    v_cmp_le_u32 vcc, v6, v7
    s_nop 1
    v_cndmask_b32 v21, v118, v21, vcc
    v_lshl_add_u32 v6, v4, 2, 18
    v_add_u32 v7, 16, v3
    v_cmp_le_u32 vcc, v6, v7
    s_nop 1
    v_cndmask_b32 v22, v118, v22, vcc
    v_lshl_add_u32 v6, v4, 2, 19
    v_add_u32 v7, 16, v3
    v_cmp_le_u32 vcc, v6, v7
    s_nop 1
    v_cndmask_b32 v23, v118, v23, vcc
    v_cmp_gt_u32 vcc, 2, v4
    s_nop 1
    v_cndmask_b32 v28, v118, v28, vcc
    v_cmp_gt_u32 vcc, 2, v4
    s_nop 1
    v_cndmask_b32 v29, v118, v29, vcc
    v_cmp_gt_u32 vcc, 2, v4
    s_nop 1
    v_cndmask_b32 v30, v118, v30, vcc
    v_cmp_gt_u32 vcc, 2, v4
    s_nop 1
    v_cndmask_b32 v31, v118, v31, vcc
    v_max_f32 v32, v12, v13
    v_max_f32 v32, v32, v14
    v_max_f32 v32, v32, v15
    v_max_f32 v32, v32, v20
    v_max_f32 v32, v32, v21
    v_max_f32 v32, v32, v22
    v_max_f32 v32, v32, v23
    v_max_f32 v32, v32, v28
    v_max_f32 v32, v32, v29
    v_max_f32 v32, v32, v30
    v_max_f32 v32, v32, v31
    v_xor_b32 v33, 16, v1
    v_lshlrev_b32 v33, 2, v33
    ds_bpermute_b32 v34, v33, v32
    s_waitcnt lgkmcnt(0)
    v_max_f32 v32, v32, v34
    v_xor_b32 v33, 32, v1
    v_lshlrev_b32 v33, 2, v33
    ds_bpermute_b32 v34, v33, v32
    s_waitcnt lgkmcnt(0)
    v_max_f32 v32, v32, v34
    v_sub_f32 v12, v12, v32
    v_mul_f32 v12, 0x3fb8aa3b, v12
    v_exp_f32 v12, v12
    v_sub_f32 v13, v13, v32
    v_mul_f32 v13, 0x3fb8aa3b, v13
    v_exp_f32 v13, v13
    v_sub_f32 v14, v14, v32
    v_mul_f32 v14, 0x3fb8aa3b, v14
    v_exp_f32 v14, v14
    v_sub_f32 v15, v15, v32
    v_mul_f32 v15, 0x3fb8aa3b, v15
    v_exp_f32 v15, v15
    v_sub_f32 v20, v20, v32
    v_mul_f32 v20, 0x3fb8aa3b, v20
    v_exp_f32 v20, v20
    v_sub_f32 v21, v21, v32
    v_mul_f32 v21, 0x3fb8aa3b, v21
    v_exp_f32 v21, v21
    v_sub_f32 v22, v22, v32
    v_mul_f32 v22, 0x3fb8aa3b, v22
    v_exp_f32 v22, v22
    v_sub_f32 v23, v23, v32
    v_mul_f32 v23, 0x3fb8aa3b, v23
    v_exp_f32 v23, v23
    v_sub_f32 v28, v28, v32
    v_mul_f32 v28, 0x3fb8aa3b, v28
    v_exp_f32 v28, v28
    v_sub_f32 v29, v29, v32
    v_mul_f32 v29, 0x3fb8aa3b, v29
    v_exp_f32 v29, v29
    v_sub_f32 v30, v30, v32
    v_mul_f32 v30, 0x3fb8aa3b, v30
    v_exp_f32 v30, v30
    v_sub_f32 v31, v31, v32
    v_mul_f32 v31, 0x3fb8aa3b, v31
    v_exp_f32 v31, v31
    s_nop 0
    v_add_f32 v32, v12, v13
    v_add_f32 v32, v32, v14
    v_add_f32 v32, v32, v15
    v_add_f32 v32, v32, v20
    v_add_f32 v32, v32, v21
    v_add_f32 v32, v32, v22
    v_add_f32 v32, v32, v23
    v_add_f32 v32, v32, v28
    v_add_f32 v32, v32, v29
    v_add_f32 v32, v32, v30
    v_add_f32 v32, v32, v31
    v_xor_b32 v33, 16, v1
    v_lshlrev_b32 v33, 2, v33
    ds_bpermute_b32 v34, v33, v32
    s_waitcnt lgkmcnt(0)
    v_add_f32 v32, v32, v34
    v_xor_b32 v33, 32, v1
    v_lshlrev_b32 v33, 2, v33
    ds_bpermute_b32 v34, v33, v32
    s_waitcnt lgkmcnt(0)
    v_add_f32 v32, v32, v34
    v_rcp_f32 v32, v32
    s_nop 0
    v_mul_f32 v12, v12, v32
    v_mul_f32 v13, v13, v32
    v_mul_f32 v14, v14, v32
    v_mul_f32 v15, v15, v32
    v_mul_f32 v20, v20, v32
    v_mul_f32 v21, v21, v32
    v_mul_f32 v22, v22, v32
    v_mul_f32 v23, v23, v32
    v_mul_f32 v28, v28, v32
    v_mul_f32 v29, v29, v32
    v_mul_f32 v30, v30, v32
    v_mul_f32 v31, v31, v32
    v_cvt_pk_bf16_f32 v88, v12, v13
    v_cvt_pk_bf16_f32 v89, v14, v15
    v_cvt_pk_bf16_f32 v90, v20, v21
    v_cvt_pk_bf16_f32 v91, v22, v23
    v_cvt_pk_bf16_f32 v92, v28, v29
    v_cvt_pk_bf16_f32 v93, v30, v31
    v_mov_b32 v94, 0
    v_mov_b32 v95, 0
    s_waitcnt vmcnt(0)
    v_mfma_f32_16x16x32_bf16 v[128:131], v[184:187], v[80:83], v[128:131]
    v_mfma_f32_16x16x32_bf16 v[128:131], v[188:191], v[84:87], v[128:131]
    v_mfma_f32_16x16x32_bf16 v[132:135], v[184:187], v[88:91], v[132:135]
    v_mfma_f32_16x16x32_bf16 v[132:135], v[188:191], v[92:95], v[132:135]
    v_mfma_f32_16x16x32_bf16 v[136:139], v[192:195], v[80:83], v[136:139]
    v_mfma_f32_16x16x32_bf16 v[136:139], v[196:199], v[84:87], v[136:139]
    v_mfma_f32_16x16x32_bf16 v[140:143], v[192:195], v[88:91], v[140:143]
    v_mfma_f32_16x16x32_bf16 v[140:143], v[196:199], v[92:95], v[140:143]
    v_mfma_f32_16x16x32_bf16 v[144:147], v[200:203], v[80:83], v[144:147]
    v_mfma_f32_16x16x32_bf16 v[144:147], v[204:207], v[84:87], v[144:147]
    v_mfma_f32_16x16x32_bf16 v[148:151], v[200:203], v[88:91], v[148:151]
    v_mfma_f32_16x16x32_bf16 v[148:151], v[204:207], v[92:95], v[148:151]
    v_mfma_f32_16x16x32_bf16 v[152:155], v[208:211], v[80:83], v[152:155]
    v_mfma_f32_16x16x32_bf16 v[152:155], v[212:215], v[84:87], v[152:155]
    v_mfma_f32_16x16x32_bf16 v[156:159], v[208:211], v[88:91], v[156:159]
    v_mfma_f32_16x16x32_bf16 v[156:159], v[212:215], v[92:95], v[156:159]
    v_mfma_f32_16x16x32_bf16 v[160:163], v[216:219], v[80:83], v[160:163]
    v_mfma_f32_16x16x32_bf16 v[160:163], v[220:223], v[84:87], v[160:163]
    v_mfma_f32_16x16x32_bf16 v[164:167], v[216:219], v[88:91], v[164:167]
    v_mfma_f32_16x16x32_bf16 v[164:167], v[220:223], v[92:95], v[164:167]
    v_mfma_f32_16x16x32_bf16 v[168:171], v[224:227], v[80:83], v[168:171]
    v_mfma_f32_16x16x32_bf16 v[168:171], v[228:231], v[84:87], v[168:171]
    v_mfma_f32_16x16x32_bf16 v[172:175], v[224:227], v[88:91], v[172:175]
    v_mfma_f32_16x16x32_bf16 v[172:175], v[228:231], v[92:95], v[172:175]
    v_mfma_f32_16x16x32_bf16 v[176:179], v[232:235], v[80:83], v[176:179]
    v_mfma_f32_16x16x32_bf16 v[176:179], v[236:239], v[84:87], v[176:179]
    v_mfma_f32_16x16x32_bf16 v[180:183], v[232:235], v[88:91], v[180:183]
    v_mfma_f32_16x16x32_bf16 v[180:183], v[236:239], v[92:95], v[180:183]
    s_nop 7
    s_nop 3
    s_barrier
    v_mul_u32_u24 v5, 14848, v2
    v_mul_u32_u24 v6, 464, v3
    v_add_u32 v5, v5, v6
    v_lshl_add_u32 v5, v4, 4, v5
    ds_write_b128 v5, v[128:131] offset:0
    ds_write_b128 v5, v[132:135] offset:7424
    ds_write_b128 v5, v[136:139] offset:64
    ds_write_b128 v5, v[140:143] offset:7488
    ds_write_b128 v5, v[144:147] offset:128
    ds_write_b128 v5, v[148:151] offset:7552
    ds_write_b128 v5, v[152:155] offset:192
    ds_write_b128 v5, v[156:159] offset:7616
    ds_write_b128 v5, v[160:163] offset:256
    ds_write_b128 v5, v[164:167] offset:7680
    ds_write_b128 v5, v[168:171] offset:320
    ds_write_b128 v5, v[172:175] offset:7744
    ds_write_b128 v5, v[176:179] offset:384
    ds_write_b128 v5, v[180:183] offset:7808
    s_waitcnt lgkmcnt(0)
    s_barrier
    s_load_dwordx2 s[8:9], s[0:1], 0
    s_waitcnt lgkmcnt(0)
    s_and_b32 s9, s9, 0xffff
    s_mov_b32 s10, 0x1c0000
    s_mov_b32 s11, 0x00020000
    s_load_dwordx2 s[12:13], s[0:1], 112
    s_waitcnt lgkmcnt(0)
    s_add_u32 s12, s12, 0x2000000
    s_addc_u32 s13, s13, 0
    s_and_b32 s13, s13, 0xffff
    s_mov_b32 s14, 0x1c0000
    s_mov_b32 s15, 0x00020000
    s_load_dwordx2 s[16:17], s[0:1], 96
    s_waitcnt lgkmcnt(0)
    s_and_b32 s17, s17, 0xffff
    s_mov_b32 s18, 0x1c0000
    s_mov_b32 s19, 0x00020000
    v_add_u32 v6, 0, v0
    s_mov_b32 s44, 0x924924a
    v_mul_hi_u32 v7, v6, s44
    v_mul_u32_u24 v8, 28, v7
    v_sub_u32 v8, v6, v8
    v_cmp_gt_u32 vcc, 896, v6
    s_mov_b64 s[36:37], exec
    s_and_b64 exec, exec, vcc
    v_mul_u32_u24 v9, 464, v7
    v_lshl_add_u32 v9, v8, 4, v9
    ds_read_b128 v[12:15], v9 offset:0
    ds_read_b128 v[16:19], v9 offset:14848
    ds_read_b128 v[20:23], v9 offset:29696
    ds_read_b128 v[24:27], v9 offset:44544
    s_lshl_b32 s44, s41, 5
    v_add_u32 v10, s44, v7
    v_mul_u32_u24 v10, 896, v10
    v_lshl_add_u32 v10, v8, 3, v10
    s_mul_i32 s44, s47, 224
    v_add_u32 v10, s44, v10
    buffer_load_dwordx2 v[30:31], v10, s[8:11], 0 offen
    buffer_load_dwordx2 v[32:33], v10, s[12:15], 0 offen
    s_waitcnt vmcnt(0) lgkmcnt(0)
    v_add_f32 v12, v12, v16
    v_add_f32 v20, v20, v24
    v_add_f32 v12, v12, v20
    v_add_f32 v13, v13, v17
    v_add_f32 v21, v21, v25
    v_add_f32 v13, v13, v21
    v_add_f32 v14, v14, v18
    v_add_f32 v22, v22, v26
    v_add_f32 v14, v14, v22
    v_add_f32 v15, v15, v19
    v_add_f32 v23, v23, v27
    v_add_f32 v15, v15, v23
    v_cvt_pk_bf16_f32 v34, v12, v13
    v_cvt_pk_bf16_f32 v35, v14, v15
    v_lshlrev_b32 v12, 16, v34
    v_and_b32 v13, 0xffff0000, v34
    v_lshlrev_b32 v14, 16, v35
    v_and_b32 v15, 0xffff0000, v35
    v_lshlrev_b32 v16, 16, v30
    v_and_b32 v17, 0xffff0000, v30
    v_lshlrev_b32 v18, 16, v31
    v_and_b32 v19, 0xffff0000, v31
    v_add_f32 v12, v12, v16
    v_add_f32 v13, v13, v17
    v_add_f32 v14, v14, v18
    v_add_f32 v15, v15, v19
    v_cvt_pk_bf16_f32 v34, v12, v13
    v_cvt_pk_bf16_f32 v35, v14, v15
    v_lshlrev_b32 v12, 16, v34
    v_and_b32 v13, 0xffff0000, v34
    v_lshlrev_b32 v14, 16, v35
    v_and_b32 v15, 0xffff0000, v35
    v_lshlrev_b32 v16, 16, v32
    v_and_b32 v17, 0xffff0000, v32
    v_lshlrev_b32 v18, 16, v33
    v_and_b32 v19, 0xffff0000, v33
    v_add_f32 v12, v12, v16
    v_add_f32 v13, v13, v17
    v_add_f32 v14, v14, v18
    v_add_f32 v15, v15, v19
    v_cvt_pk_bf16_f32 v34, v12, v13
    v_cvt_pk_bf16_f32 v35, v14, v15
    buffer_store_dwordx2 v[34:35], v10, s[16:19], 0 offen
    s_mov_b64 exec, s[36:37]
    v_add_u32 v6, 256, v0
    s_mov_b32 s44, 0x924924a
    v_mul_hi_u32 v7, v6, s44
    v_mul_u32_u24 v8, 28, v7
    v_sub_u32 v8, v6, v8
    v_cmp_gt_u32 vcc, 896, v6
    s_mov_b64 s[36:37], exec
    s_and_b64 exec, exec, vcc
    v_mul_u32_u24 v9, 464, v7
    v_lshl_add_u32 v9, v8, 4, v9
    ds_read_b128 v[12:15], v9 offset:0
    ds_read_b128 v[16:19], v9 offset:14848
    ds_read_b128 v[20:23], v9 offset:29696
    ds_read_b128 v[24:27], v9 offset:44544
    s_lshl_b32 s44, s41, 5
    v_add_u32 v10, s44, v7
    v_mul_u32_u24 v10, 896, v10
    v_lshl_add_u32 v10, v8, 3, v10
    s_mul_i32 s44, s47, 224
    v_add_u32 v10, s44, v10
    buffer_load_dwordx2 v[30:31], v10, s[8:11], 0 offen
    buffer_load_dwordx2 v[32:33], v10, s[12:15], 0 offen
    s_waitcnt vmcnt(0) lgkmcnt(0)
    v_add_f32 v12, v12, v16
    v_add_f32 v20, v20, v24
    v_add_f32 v12, v12, v20
    v_add_f32 v13, v13, v17
    v_add_f32 v21, v21, v25
    v_add_f32 v13, v13, v21
    v_add_f32 v14, v14, v18
    v_add_f32 v22, v22, v26
    v_add_f32 v14, v14, v22
    v_add_f32 v15, v15, v19
    v_add_f32 v23, v23, v27
    v_add_f32 v15, v15, v23
    v_cvt_pk_bf16_f32 v34, v12, v13
    v_cvt_pk_bf16_f32 v35, v14, v15
    v_lshlrev_b32 v12, 16, v34
    v_and_b32 v13, 0xffff0000, v34
    v_lshlrev_b32 v14, 16, v35
    v_and_b32 v15, 0xffff0000, v35
    v_lshlrev_b32 v16, 16, v30
    v_and_b32 v17, 0xffff0000, v30
    v_lshlrev_b32 v18, 16, v31
    v_and_b32 v19, 0xffff0000, v31
    v_add_f32 v12, v12, v16
    v_add_f32 v13, v13, v17
    v_add_f32 v14, v14, v18
    v_add_f32 v15, v15, v19
    v_cvt_pk_bf16_f32 v34, v12, v13
    v_cvt_pk_bf16_f32 v35, v14, v15
    v_lshlrev_b32 v12, 16, v34
    v_and_b32 v13, 0xffff0000, v34
    v_lshlrev_b32 v14, 16, v35
    v_and_b32 v15, 0xffff0000, v35
    v_lshlrev_b32 v16, 16, v32
    v_and_b32 v17, 0xffff0000, v32
    v_lshlrev_b32 v18, 16, v33
    v_and_b32 v19, 0xffff0000, v33
    v_add_f32 v12, v12, v16
    v_add_f32 v13, v13, v17
    v_add_f32 v14, v14, v18
    v_add_f32 v15, v15, v19
    v_cvt_pk_bf16_f32 v34, v12, v13
    v_cvt_pk_bf16_f32 v35, v14, v15
    buffer_store_dwordx2 v[34:35], v10, s[16:19], 0 offen
    s_mov_b64 exec, s[36:37]
    v_add_u32 v6, 512, v0
    s_mov_b32 s44, 0x924924a
    v_mul_hi_u32 v7, v6, s44
    v_mul_u32_u24 v8, 28, v7
    v_sub_u32 v8, v6, v8
    v_cmp_gt_u32 vcc, 896, v6
    s_mov_b64 s[36:37], exec
    s_and_b64 exec, exec, vcc
    v_mul_u32_u24 v9, 464, v7
    v_lshl_add_u32 v9, v8, 4, v9
    ds_read_b128 v[12:15], v9 offset:0
    ds_read_b128 v[16:19], v9 offset:14848
    ds_read_b128 v[20:23], v9 offset:29696
    ds_read_b128 v[24:27], v9 offset:44544
    s_lshl_b32 s44, s41, 5
    v_add_u32 v10, s44, v7
    v_mul_u32_u24 v10, 896, v10
    v_lshl_add_u32 v10, v8, 3, v10
    s_mul_i32 s44, s47, 224
    v_add_u32 v10, s44, v10
    buffer_load_dwordx2 v[30:31], v10, s[8:11], 0 offen
    buffer_load_dwordx2 v[32:33], v10, s[12:15], 0 offen
    s_waitcnt vmcnt(0) lgkmcnt(0)
    v_add_f32 v12, v12, v16
    v_add_f32 v20, v20, v24
    v_add_f32 v12, v12, v20
    v_add_f32 v13, v13, v17
    v_add_f32 v21, v21, v25
    v_add_f32 v13, v13, v21
    v_add_f32 v14, v14, v18
    v_add_f32 v22, v22, v26
    v_add_f32 v14, v14, v22
    v_add_f32 v15, v15, v19
    v_add_f32 v23, v23, v27
    v_add_f32 v15, v15, v23
    v_cvt_pk_bf16_f32 v34, v12, v13
    v_cvt_pk_bf16_f32 v35, v14, v15
    v_lshlrev_b32 v12, 16, v34
    v_and_b32 v13, 0xffff0000, v34
    v_lshlrev_b32 v14, 16, v35
    v_and_b32 v15, 0xffff0000, v35
    v_lshlrev_b32 v16, 16, v30
    v_and_b32 v17, 0xffff0000, v30
    v_lshlrev_b32 v18, 16, v31
    v_and_b32 v19, 0xffff0000, v31
    v_add_f32 v12, v12, v16
    v_add_f32 v13, v13, v17
    v_add_f32 v14, v14, v18
    v_add_f32 v15, v15, v19
    v_cvt_pk_bf16_f32 v34, v12, v13
    v_cvt_pk_bf16_f32 v35, v14, v15
    v_lshlrev_b32 v12, 16, v34
    v_and_b32 v13, 0xffff0000, v34
    v_lshlrev_b32 v14, 16, v35
    v_and_b32 v15, 0xffff0000, v35
    v_lshlrev_b32 v16, 16, v32
    v_and_b32 v17, 0xffff0000, v32
    v_lshlrev_b32 v18, 16, v33
    v_and_b32 v19, 0xffff0000, v33
    v_add_f32 v12, v12, v16
    v_add_f32 v13, v13, v17
    v_add_f32 v14, v14, v18
    v_add_f32 v15, v15, v19
    v_cvt_pk_bf16_f32 v34, v12, v13
    v_cvt_pk_bf16_f32 v35, v14, v15
    buffer_store_dwordx2 v[34:35], v10, s[16:19], 0 offen
    s_mov_b64 exec, s[36:37]
    v_add_u32 v6, 768, v0
    s_mov_b32 s44, 0x924924a
    v_mul_hi_u32 v7, v6, s44
    v_mul_u32_u24 v8, 28, v7
    v_sub_u32 v8, v6, v8
    v_cmp_gt_u32 vcc, 896, v6
    s_mov_b64 s[36:37], exec
    s_and_b64 exec, exec, vcc
    v_mul_u32_u24 v9, 464, v7
    v_lshl_add_u32 v9, v8, 4, v9
    ds_read_b128 v[12:15], v9 offset:0
    ds_read_b128 v[16:19], v9 offset:14848
    ds_read_b128 v[20:23], v9 offset:29696
    ds_read_b128 v[24:27], v9 offset:44544
    s_lshl_b32 s44, s41, 5
    v_add_u32 v10, s44, v7
    v_mul_u32_u24 v10, 896, v10
    v_lshl_add_u32 v10, v8, 3, v10
    s_mul_i32 s44, s47, 224
    v_add_u32 v10, s44, v10
    buffer_load_dwordx2 v[30:31], v10, s[8:11], 0 offen
    buffer_load_dwordx2 v[32:33], v10, s[12:15], 0 offen
    s_waitcnt vmcnt(0) lgkmcnt(0)
    v_add_f32 v12, v12, v16
    v_add_f32 v20, v20, v24
    v_add_f32 v12, v12, v20
    v_add_f32 v13, v13, v17
    v_add_f32 v21, v21, v25
    v_add_f32 v13, v13, v21
    v_add_f32 v14, v14, v18
    v_add_f32 v22, v22, v26
    v_add_f32 v14, v14, v22
    v_add_f32 v15, v15, v19
    v_add_f32 v23, v23, v27
    v_add_f32 v15, v15, v23
    v_cvt_pk_bf16_f32 v34, v12, v13
    v_cvt_pk_bf16_f32 v35, v14, v15
    v_lshlrev_b32 v12, 16, v34
    v_and_b32 v13, 0xffff0000, v34
    v_lshlrev_b32 v14, 16, v35
    v_and_b32 v15, 0xffff0000, v35
    v_lshlrev_b32 v16, 16, v30
    v_and_b32 v17, 0xffff0000, v30
    v_lshlrev_b32 v18, 16, v31
    v_and_b32 v19, 0xffff0000, v31
    v_add_f32 v12, v12, v16
    v_add_f32 v13, v13, v17
    v_add_f32 v14, v14, v18
    v_add_f32 v15, v15, v19
    v_cvt_pk_bf16_f32 v34, v12, v13
    v_cvt_pk_bf16_f32 v35, v14, v15
    v_lshlrev_b32 v12, 16, v34
    v_and_b32 v13, 0xffff0000, v34
    v_lshlrev_b32 v14, 16, v35
    v_and_b32 v15, 0xffff0000, v35
    v_lshlrev_b32 v16, 16, v32
    v_and_b32 v17, 0xffff0000, v32
    v_lshlrev_b32 v18, 16, v33
    v_and_b32 v19, 0xffff0000, v33
    v_add_f32 v12, v12, v16
    v_add_f32 v13, v13, v17
    v_add_f32 v14, v14, v18
    v_add_f32 v15, v15, v19
    v_cvt_pk_bf16_f32 v34, v12, v13
    v_cvt_pk_bf16_f32 v35, v14, v15
    buffer_store_dwordx2 v[34:35], v10, s[16:19], 0 offen
    s_mov_b64 exec, s[36:37]
parallel_sum__memory_aug_recurrent_mem_tr__dense_activation_gelu__prompt_kernel_done:
    s_endpgm
.section .rodata,"a"
.p2align 6
.amdhsa_kernel prep_kernel
  .amdhsa_next_free_vgpr 32
  .amdhsa_next_free_sgpr 102
  .amdhsa_accum_offset 32
  .amdhsa_group_segment_fixed_size 0
  .amdhsa_kernarg_size 120
  .amdhsa_user_sgpr_count 2
  .amdhsa_user_sgpr_kernarg_segment_ptr 1
  .amdhsa_system_sgpr_workgroup_id_x 1
.end_amdhsa_kernel
.section .rodata,"a"
.p2align 6
.amdhsa_kernel g1_kernel
  .amdhsa_next_free_vgpr 132
  .amdhsa_next_free_sgpr 102
  .amdhsa_accum_offset 132
  .amdhsa_group_segment_fixed_size 0
  .amdhsa_kernarg_size 120
  .amdhsa_user_sgpr_count 2
  .amdhsa_user_sgpr_kernarg_segment_ptr 1
  .amdhsa_system_sgpr_workgroup_id_x 1
.end_amdhsa_kernel
.section .rodata,"a"
.p2align 6
.amdhsa_kernel chain_kernel
  .amdhsa_next_free_vgpr 512
  .amdhsa_next_free_sgpr 102
  .amdhsa_accum_offset 256
  .amdhsa_group_segment_fixed_size 0
  .amdhsa_kernarg_size 120
  .amdhsa_user_sgpr_count 2
  .amdhsa_user_sgpr_kernarg_segment_ptr 1
  .amdhsa_system_sgpr_workgroup_id_x 1
.end_amdhsa_kernel
.section .rodata,"a"
.p2align 6
.amdhsa_kernel parallel_sum__memory_aug_recurrent_mem_tr__dense_activation_gelu__prompt_kernel
  .amdhsa_next_free_vgpr 240
  .amdhsa_next_free_sgpr 102
  .amdhsa_accum_offset 240
  .amdhsa_group_segment_fixed_size 0
  .amdhsa_kernarg_size 120
  .amdhsa_user_sgpr_count 2
  .amdhsa_user_sgpr_kernarg_segment_ptr 1
  .amdhsa_system_sgpr_workgroup_id_x 1
.end_amdhsa_kernel
```
